```python
import torch

def _softmax(x, axis=-1):
    return torch.softmax(x, dim=axis)
def _gelu(x):
    return torch.nn.functional.gelu(x, approximate="tanh")
def _silu(x):
    return torch.nn.functional.silu(x)
def _sigmoid(x):
    return torch.sigmoid(x)
def _layernorm(x, axis=-1, eps=1e-5):
    m = x.mean(dim=axis, keepdim=True)
    v = x.var(dim=axis, keepdim=True, unbiased=False)
    return (x - m) / torch.sqrt(v + eps)
def _scatter_add(tgt, idx, src, axis=0):
    return tgt.clone().index_add_(axis, idx, src)
def _segment_sum(src, seg, n):
    out = torch.zeros((n,) + src.shape[1:], dtype=src.dtype)
    return out.index_add_(0, seg, src)
def _pad(x, pw):
    flat = tuple(v for pair in reversed(pw) for v in pair)
    return torch.nn.functional.pad(x, flat)

kernel_name = 'recurrent_scan__linear_kernel_hedgehog__dense_activation_silu__prompt'

def setup_inputs():

    _w = (lambda a: (lambda t: t.to(torch.bfloat16) if t.is_floating_point() else t)(torch.as_tensor(a)))
    def _A_setup():
        B, S, D, H = 1, 2048, 512, 32
        Dh = D // H
        return {
            "x": _w((lambda *s: torch.randn(*s, dtype=torch.bfloat16) * 0.05)(B, S, D)),
            "wqkv": _w((lambda *s: torch.randn(*s, dtype=torch.bfloat16) * 0.4)(D, 3 * D)),
            "w_phi": _w((lambda *s: torch.randn(*s, dtype=torch.bfloat16) * 0.4)(H, Dh, Dh) * (Dh ** -0.5)),
            "wo": _w((lambda *s: torch.randn(*s, dtype=torch.bfloat16) * 0.2)(D, D)),
        }
    _A_in = _A_setup()

    def _B_setup():
        B, S, D, F = 1, 2048, 512, 1792
        return {
            "x": _w((lambda *s: torch.randn(*s, dtype=torch.bfloat16) * 0.05)(B, S, D)),
            "w1": _w((lambda *s: torch.randn(*s, dtype=torch.bfloat16) * 0.4)(D, F) * (D ** -0.5)),
            "w2": _w((lambda *s: torch.randn(*s, dtype=torch.bfloat16) * 0.1)(F, D) * (F ** -0.5)),
        }
    _B_in = _B_setup()

    return {
        "A_x": _A_in["x"],
        "A_wqkv": _A_in["wqkv"],
        "A_w_phi": _A_in["w_phi"],
        "A_wo": _A_in["wo"],
        "B_x": _B_in["x"],
        "B_w1": _B_in["w1"],
        "B_w2": _B_in["w2"],
    }

def reference(A_x, A_wqkv, A_w_phi, A_wo, B_x, B_w1, B_w2):
    def _A_ref(x, wqkv, w_phi, wo):
        B, S, D = x.shape
        H = 32; Dh = D // H
        qkv = (lambda x, *d: x.permute(*d))((x @ wqkv).reshape(B, S, 3, H, Dh), 2, 0, 3, 1, 4)
        q, k, v = qkv[0], qkv[1], qkv[2]
        pq = torch.einsum("bhsd,hdf->bhsf", q, w_phi)
        pk = torch.einsum("bhsd,hdf->bhsf", k, w_phi)
        phi_q = torch.concatenate([_softmax(pq, axis=-1), _softmax(-pq, axis=-1)], axis=-1)
        phi_k = torch.concatenate([_softmax(pk, axis=-1), _softmax(-pk, axis=-1)], axis=-1)
        kv = torch.einsum("bhsf,bhsd->bhfd", phi_k, v)
        z  = torch.einsum("bhsf->bhf", phi_k)
        num = torch.einsum("bhqf,bhfd->bhqd", phi_q, kv)
        den = torch.einsum("bhqf,bhf->bhq", phi_q, z)[..., None] + 1e-6
        o = num / den
        return (lambda x, *d: x.permute(*d))(o, 0, 2, 1, 3).reshape(B, S, D) @ wo

    def _B_ref(x, w1, w2):
        h = torch.einsum("bsd,df->bsf", x, w1)
        h = _silu(h)
        out = torch.einsum("bsf,fd->bsd", h, w2)
        return out

    x = A_x
    xn = _layernorm(x, axis=-1)
    s = _A_ref(xn, A_wqkv, A_w_phi, A_wo)
    g = _silu(_B_ref(xn, B_w1, B_w2))
    return x + s * g
```

```asm
; @launch grid=(256,1,1) block=(512,1,1) lds=163840
.amdgcn_target "amdgcn-amd-amdhsa--gfx950"
.set SPIN_MAX, 200000
.set CODE_BYTES, L_CODE_END - recurrent_scan__linear_kernel_hedgehog__dense_activation_silu__prompt_kernel - 2048
.text
.globl recurrent_scan__linear_kernel_hedgehog__dense_activation_silu__prompt_kernel
.p2align 8
.type recurrent_scan__linear_kernel_hedgehog__dense_activation_silu__prompt_kernel,@function
recurrent_scan__linear_kernel_hedgehog__dense_activation_silu__prompt_kernel:
    s_load_dwordx4 s[8:11], s[0:1], 0
    s_load_dwordx4 s[16:19], s[0:1], 40
    v_lshrrev_b32 v2, 6, v0
    v_and_b32 v1, 63, v0
    v_lshlrev_b32 v6, 4, v1
    v_readfirstlane_b32 s99, v2
    s_cmp_ge_u32 s2, 256
    s_cbranch_scc1 L_END
    s_lshr_b32 s45, s2, 3
    s_and_b32 s100, s99, 3
    s_getpc_b64 s[68:69]
    s_lshl_b32 s50, s45, 10
    s_lshl_b32 s51, s99, 15
    s_add_u32 s50, s50, s51
    s_add_u32 s68, s68, s50
    s_addc_u32 s69, s69, 0
    s_cmp_ge_u32 s50, CODE_BYTES
    s_cbranch_scc1 L_NOPF2
    global_load_dwordx4 v[60:63], v6, s[68:69]
L_NOPF2:
    s_load_dwordx4 s[32:35], s[0:1], 16
    s_load_dwordx4 s[28:31], s[0:1], 56
    s_load_dwordx2 s[24:25], s[0:1], 72
    s_bfe_u32 s3, s2, 0x10001
    s_and_b32 s54, s45, 3
    s_and_b32 s50, s2, 6
    s_lshl1_add_u32 s47, s50, s54
    s_lshr_b32 s61, s45, 4
    s_bfe_u32 s50, s45, 0x20002
    s_and_b32 s55, s2, 1
    s_lshl2_add_u32 s101, s55, s50
    s_lshl_b32 s49, s3, 9
    s_lshl_b32 s48, s61, 9
    s_sub_u32 s4, 3584, s48
    s_mul_i32 s50, s101, 7
    s_lshr_b32 s50, s50, 1
    s_movk_i32 s43, 128
    s_mov_b32 s14, 0x1c0000
    s_cmp_lg_u32 s61, 0
    s_cselect_b32 s50, s101, s50
    s_cselect_b32 s43, 1024, s43
    s_cselect_b32 s14, 0x180000, s14
    s_lshl_b32 s5, s50, 7
    s_mul_i32 s51, s3, s4
    s_lshl_b32 s51, s51, 8
    s_mov_b32 s15, 0x20000
    v_and_b32 v20, 31, v1
    v_lshrrev_b32 v21, 5, v1
    s_lshl_b32 s40, s100, 12
    s_cmp_lt_u32 s99, 4
    s_cbranch_scc0 L_H0
    v_lshlrev_b32 v11, 4, v20
    v_lshl_add_u32 v11, v21, 10, v11
    s_lshl3_add_u32 s48, s61, s101
    s_lshl2_add_u32 s48, s48, s100
    s_lshl_b32 s48, s48, 11
    s_lshl_b32 s50, s47, 17
    s_add_u32 s46, s48, s50
    s_cmp_lg_u32 s61, 0
    s_waitcnt lgkmcnt(0)
    s_cselect_b32 s12, s10, s16
    s_cselect_b32 s13, s11, s17
    s_mov_b32 s10, 0x200000
    s_mov_b32 s11, 0x20000
    buffer_load_dwordx4 v[64:67], v11, s[8:11], s46 offen
    buffer_load_dwordx4 v[68:71], v11, s[8:11], s46 offen offset:512
    s_cbranch_scc1 L_MB
    s_branch L_MA
L_H0:
    v_lshrrev_b32 v7, 3, v1
    v_and_b32 v8, 7, v1
    v_lshrrev_b32 v9, 4, v1
    v_xor_b32 v10, v8, v9
    v_lshlrev_b32 v10, 4, v10
    v_lshl_add_u32 v2, v7, 10, v10
    v_xor_b32 v3, 0x2040, v2
    v_and_b32 v9, 1, v9
    v_lshlrev_b32 v9, 2, v9
    v_xor_b32 v10, v8, v9
    v_lshlrev_b32 v10, 4, v10
    v_mad_u32_u24 v4, v7, s4, v10
    s_lshl_b32 s48, s61, 5
    s_xor_b32 s48, s48, 32
    v_xor_b32 v16, 32, v4
    s_lshl2_add_u32 s38, s47, s100
    s_lshl_b32 s38, s38, 15
    s_sub_u32 s36, s38, s49
    s_add_u32 s38, s38, s49
    s_add_u32 s46, s38, 16384
    s_add_u32 m0, s40, 49152
    s_lshl_b32 s44, s4, 3
    s_mul_i32 s39, s100, s44
    s_lshl1_add_u32 s39, s39, s5
    s_sub_u32 s37, s39, s51
    s_add_u32 s39, s39, s51
    s_lshl_b32 s41, s100, 11
    s_add_u32 s41, s41, 0x4000
    s_mov_b32 s62, s39
    s_cmp_lg_u32 s61, 0
    s_waitcnt lgkmcnt(0)
    s_cselect_b32 s12, s10, s16
    s_cselect_b32 s13, s11, s17
    s_mov_b32 s10, 0x200000
    s_mov_b32 s11, 0x20000
    buffer_load_dwordx4 v2, s[8:11], s38 offen lds
    s_add_u32 m0, s40, 50176
    s_nop 0
    buffer_load_dwordx4 v3, s[8:11], s38 offen lds
    s_add_u32 m0, s40, 51200
    s_nop 0
    buffer_load_dwordx4 v2, s[8:11], s46 offen lds
    s_add_u32 m0, s40, 52224
    s_nop 0
    buffer_load_dwordx4 v3, s[8:11], s46 offen lds
    s_add_u32 m0, s41, 49152
    s_add_u32 s46, s62, s44
    buffer_load_dwordx4 v4, s[12:15], s62 offen lds
    s_add_u32 m0, s41, 50176
    s_add_u32 s62, s62, s43
    buffer_load_dwordx4 v16, s[12:15], s46 offen lds
    s_add_u32 m0, s41, 57344
    s_add_u32 s46, s62, s44
    buffer_load_dwordx4 v4, s[12:15], s62 offen lds
    s_add_u32 m0, s41, 58368
    s_add_u32 s62, s62, s43
    buffer_load_dwordx4 v16, s[12:15], s46 offen lds
    s_add_u32 m0, s41, 65536
    s_add_u32 s46, s62, s44
    buffer_load_dwordx4 v4, s[12:15], s62 offen lds
    s_add_u32 m0, s41, 66560
    s_add_u32 s62, s62, s43
    buffer_load_dwordx4 v16, s[12:15], s46 offen lds
    v_lshl_add_u32 v5, v7, 10, v10
    v_and_b32 v17, 32, v1
    v_xor_b32 v17, v17, v5
    s_cmp_lg_u32 s61, 0
    s_cbranch_scc1 L_HB
    s_add_u32 m0, s41, 73728
    s_add_u32 s46, s62, s44
    buffer_load_dwordx4 v4, s[12:15], s62 offen lds
    s_add_u32 m0, s41, 74752
    s_add_u32 s62, s62, s43
    buffer_load_dwordx4 v16, s[12:15], s46 offen lds
    s_lshl2_add_u32 s48, s54, s100
    s_mul_i32 s48, s48, s4
    s_lshl2_add_u32 s48, s48, s5
    s_add_u32 s0, s48, s51
    v_lshrrev_b32 v22, 4, v1
    v_bfe_u32 v23, v1, 2, 2
    v_lshl_add_u32 v22, v22, 6, v23
    v_add_u32 v22, 64, v22
    v_and_b32 v23, 3, v1
    v_lshlrev_b32 v23, 7, v23
    v_mad_u32_u24 v26, v22, s4, v23
    s_mov_b32 exec_lo, 0xffffffff
    s_mov_b32 exec_hi, 0xffff
    buffer_load_dword v27, v26, s[12:15], s0 offen
    s_mov_b64 exec, -1
    s_mov_b32 s20, s34
    s_mov_b32 s21, s35
    s_mov_b32 s34, s30
    s_mov_b32 s35, s31
    s_mov_b32 s66, 0xffff0000
    s_lshr_b32 s56, s45, 2
    s_xor_b32 s56, s56, 6
    s_bfe_u32 s48, s2, 0x10002
    s_lshl2_add_u32 s54, s48, s54
    s_mov_b32 s30, 0x200000
    s_mov_b32 s31, 0x20000
    s_mov_b32 s22, 0x80000
    s_mov_b32 s23, 0x20000
    s_mov_b32 s16, s18
    s_mov_b32 s17, s19
    s_mov_b32 s18, 0x1c0000
    s_mov_b32 s19, 0x20000
    s_add_u32 s24, s24, 0x0
    s_addc_u32 s25, s25, 0
    s_mov_b32 s26, 25165824
    s_mov_b32 s27, 0x20000
    s_and_b32 s53, s100, 1
    s_lshr_b32 s52, s100, 1
    v_bfe_u32 v22, v1, 2, 2
    v_lshl_add_u32 v22, v21, 3, v22
    v_bfe_u32 v23, v1, 4, 1
    v_lshlrev_b32 v23, 5, v23
    v_and_b32 v24, 1, v1
    v_lshl_add_u32 v23, v24, 4, v23
    v_bfe_u32 v24, v1, 1, 1
    v_lshl_add_u32 v23, v24, 3, v23
    v_bfe_u32 v24, v1, 3, 1
    v_lshl_add_u32 v23, v24, 6, v23
    v_lshl_add_u32 v7, v22, 7, v23
    s_cmp_eq_u32 s54, 0
    s_cselect_b32 s48, 49152, 0
    s_lshl_b32 s49, s100, 13
    s_add_u32 s48, s48, s49
    s_add_u32 s48, s48, 0x4000
    v_and_b32 v13, 32, v1
    v_xor_b32 v13, v13, v7
    v_add_u32 v12, s48, v13
    v_xor_b32 v13, 64, v12
    s_lshl3_add_u32 s42, s61, s101
    s_lshl2_add_u32 s42, s42, s100
    s_lshl_b32 s42, s42, 12
    s_add_u32 s42, s42, 11665408
    s_lshl1_add_u32 s98, s3, s54
    s_lshl_b32 s98, s98, 9
    s_add_u32 s98, s98, s42
    v_lshlrev_b32 v14, 3, v1
    s_lshl_b32 s48, s100, 8
    s_add_u32 s48, s48, 162816
    v_lshlrev_b32 v15, 2, v1
    v_add_u32 v15, s48, v15
    s_lshl_b32 s50, s100, 13
    s_lshl_b32 s48, s56, 7
    s_add_u32 s59, s50, s48
    s_mul_i32 s48, s55, 917504
    s_add_u32 s57, s59, s48
    s_lshl_b32 s58, s100, 10
    v_mov_b32 v80, 0
    v_mov_b32 v81, 0
    v_mov_b32 v82, 0
    v_mov_b32 v83, 0
    v_mov_b32 v22, 161792
    ds_write_b128 v22, v[80:83]
    ds_write_b128 v22, v[80:83] offset:16
    ds_write_b128 v22, v[80:83] offset:32
    s_lshl_b32 s48, s100, 9
    s_add_u32 s48, s48, 159744
    v_add_u32 v22, s48, v14
    ds_write_b64 v22, v[80:81]
    s_mov_b32 s70, 0x3e803e80
    s_bitcmp1_b32 s101, 0
    s_cselect_b32 s43, 0x0f0ff0f0, -1
    s_cselect_b32 s44, -1, 0xf0f00f0f
    s_add_u32 m0, s40, 98304
    s_add_u32 s46, s38, 128
    buffer_load_dwordx4 v2, s[8:11], s46 offen lds
    s_add_u32 m0, s40, 99328
    s_nop 0
    buffer_load_dwordx4 v3, s[8:11], s46 offen lds
    s_add_u32 m0, s40, 100352
    s_add_u32 s46, s38, 16512
    buffer_load_dwordx4 v2, s[8:11], s46 offen lds
    s_add_u32 m0, s40, 101376
    s_nop 0
    buffer_load_dwordx4 v3, s[8:11], s46 offen lds
    s_mov_b64 exec, 0
    s_mov_b64 vcc, 0
    s_cmp_eq_u32 s100, 0
    s_cbranch_scc1 SEG_S1_0
    s_cmp_eq_u32 s100, 1
    s_cbranch_scc1 SEG_S1_1
    s_cmp_eq_u32 s100, 2
    s_cbranch_scc1 SEG_S1_2
    s_branch SEG_S1_3
RET1_A:
    s_mov_b64 exec, -1
    s_waitcnt vmcnt(5) lgkmcnt(0)
    s_barrier
    s_setprio 0
    s_load_dword s60, s[34:35], 0
    s_mov_b32 exec_lo, s43
    s_mov_b32 exec_hi, s43
    s_add_u32 m0, s41, 98304
    s_add_u32 s62, s39, 229376
    buffer_load_dwordx4 v4, s[12:15], s62 offen lds
    s_add_u32 m0, s41, 99328
    s_add_u32 s62, s39, 258048
    buffer_load_dwordx4 v16, s[12:15], s62 offen lds
    s_mov_b64 exec, -1
    s_add_u32 m0, s41, 106496
    s_add_u32 s62, s39, 229504
    buffer_load_dwordx4 v4, s[12:15], s62 offen lds
    s_add_u32 m0, s41, 107520
    s_add_u32 s62, s39, 258176
    buffer_load_dwordx4 v16, s[12:15], s62 offen lds
    s_add_u32 m0, s41, 114688
    s_add_u32 s62, s39, 229632
    buffer_load_dwordx4 v4, s[12:15], s62 offen lds
    s_add_u32 m0, s41, 115712
    s_add_u32 s62, s39, 258304
    buffer_load_dwordx4 v16, s[12:15], s62 offen lds
    s_mov_b32 exec_lo, s44
    s_mov_b32 exec_hi, s44
    s_add_u32 m0, s41, 122880
    s_add_u32 s62, s39, 229760
    buffer_load_dwordx4 v4, s[12:15], s62 offen lds
    s_add_u32 m0, s41, 123904
    s_add_u32 s62, s39, 258432
    buffer_load_dwordx4 v16, s[12:15], s62 offen lds
    s_mov_b64 exec, -1
    s_add_u32 m0, s40, 0
    s_add_u32 s46, s38, 256
    buffer_load_dwordx4 v2, s[8:11], s46 offen lds
    s_add_u32 m0, s40, 1024
    s_nop 0
    buffer_load_dwordx4 v3, s[8:11], s46 offen lds
    s_add_u32 m0, s40, 2048
    s_add_u32 s46, s38, 16640
    buffer_load_dwordx4 v2, s[8:11], s46 offen lds
    s_add_u32 m0, s40, 3072
    s_nop 0
    buffer_load_dwordx4 v3, s[8:11], s46 offen lds
    s_mov_b32 exec_lo, s43
    s_mov_b32 exec_hi, s43
    s_add_u32 m0, s41, 0
    s_add_u32 s62, s39, 458752
    buffer_load_dwordx4 v4, s[12:15], s62 offen lds
    s_add_u32 m0, s41, 1024
    s_add_u32 s62, s39, 487424
    buffer_load_dwordx4 v16, s[12:15], s62 offen lds
    s_mov_b64 exec, -1
    s_add_u32 m0, s41, 8192
    s_add_u32 s62, s39, 458880
    buffer_load_dwordx4 v4, s[12:15], s62 offen lds
    s_add_u32 m0, s41, 9216
    s_add_u32 s62, s39, 487552
    buffer_load_dwordx4 v16, s[12:15], s62 offen lds
    s_cmp_lg_u32 s54, 0
    s_cbranch_scc1 NOCS_1
    s_waitcnt lgkmcnt(0)
    ds_read_b64_tr_b16 v[48:49], v12 offset:0
    ds_read_b64_tr_b16 v[50:51], v12 offset:512
    ds_read_b64_tr_b16 v[52:53], v13 offset:0
    ds_read_b64_tr_b16 v[54:55], v13 offset:512
    ds_read_b64_tr_b16 v[56:57], v12 offset:2048
    ds_read_b64_tr_b16 v[58:59], v12 offset:2560
    ds_read_b64_tr_b16 v[60:61], v13 offset:2048
    ds_read_b64_tr_b16 v[62:63], v13 offset:2560
    ds_read_b64_tr_b16 v[64:65], v12 offset:4096
    ds_read_b64_tr_b16 v[66:67], v12 offset:4608
    ds_read_b64_tr_b16 v[68:69], v13 offset:4096
    ds_read_b64_tr_b16 v[70:71], v13 offset:4608
    ds_read_b64_tr_b16 v[72:73], v12 offset:6144
    ds_read_b64_tr_b16 v[74:75], v12 offset:6656
    s_waitcnt lgkmcnt(12)
    ds_read_b64_tr_b16 v[76:77], v13 offset:6144
    ds_read_b64_tr_b16 v[78:79], v13 offset:6656
    s_waitcnt lgkmcnt(8)
    v_dot2c_f32_bf16 v80, s70, v48
    v_dot2c_f32_bf16 v81, s70, v52
    v_dot2c_f32_bf16 v80, s70, v49
    v_dot2c_f32_bf16 v81, s70, v53
    v_dot2c_f32_bf16 v80, s70, v50
    v_dot2c_f32_bf16 v81, s70, v54
    v_dot2c_f32_bf16 v80, s70, v51
    v_dot2c_f32_bf16 v81, s70, v55
    v_dot2c_f32_bf16 v80, s70, v56
    v_dot2c_f32_bf16 v81, s70, v60
    v_dot2c_f32_bf16 v80, s70, v57
    v_dot2c_f32_bf16 v81, s70, v61
    v_dot2c_f32_bf16 v80, s70, v58
    v_dot2c_f32_bf16 v81, s70, v62
    v_dot2c_f32_bf16 v80, s70, v59
    v_dot2c_f32_bf16 v81, s70, v63
    s_waitcnt lgkmcnt(0)
    v_dot2c_f32_bf16 v80, s70, v64
    v_dot2c_f32_bf16 v81, s70, v68
    v_dot2c_f32_bf16 v80, s70, v65
    v_dot2c_f32_bf16 v81, s70, v69
    v_dot2c_f32_bf16 v80, s70, v66
    v_dot2c_f32_bf16 v81, s70, v70
    v_dot2c_f32_bf16 v80, s70, v67
    v_dot2c_f32_bf16 v81, s70, v71
    v_dot2c_f32_bf16 v80, s70, v72
    v_dot2c_f32_bf16 v81, s70, v76
    v_dot2c_f32_bf16 v80, s70, v73
    v_dot2c_f32_bf16 v81, s70, v77
    v_dot2c_f32_bf16 v80, s70, v74
    v_dot2c_f32_bf16 v81, s70, v78
    v_dot2c_f32_bf16 v80, s70, v75
    v_dot2c_f32_bf16 v81, s70, v79
NOCS_1:
    s_waitcnt vmcnt(8)
    s_barrier
    s_lshl_b32 s48, s100, 5
    s_add_u32 s49, s48, 161856
    v_and_b32 v22, 16, v6
    v_add_u32 v23, s49, v22
    ds_read_b96 v[34:36], v23
    s_lshl3_add_u32 s49, s61, s101
    s_lshl4_add_u32 s49, s47, s49
    s_lshl_b32 s49, s49, 7
    s_add_u32 s48, s48, s49
    s_add_u32 s67, s48, 11599872
    s_add_u32 m0, s41, 16384
    s_add_u32 s62, s39, 459008
    buffer_load_dwordx4 v4, s[12:15], s62 offen lds
    s_add_u32 m0, s41, 17408
    s_add_u32 s62, s39, 487680
    buffer_load_dwordx4 v16, s[12:15], s62 offen lds
    s_mov_b32 exec_lo, s44
    s_mov_b32 exec_hi, s44
    s_add_u32 m0, s41, 24576
    s_add_u32 s62, s39, 459136
    buffer_load_dwordx4 v4, s[12:15], s62 offen lds
    s_add_u32 m0, s41, 25600
    s_add_u32 s62, s39, 487808
    buffer_load_dwordx4 v16, s[12:15], s62 offen lds
    s_mov_b64 exec, -1
    s_waitcnt lgkmcnt(0)
    s_cmp_eq_u32 s60, 0
    s_cselect_b64 vcc, -1, 0
    s_cbranch_vccnz SL_2
SE_3:
    v_mov_b32 v37, s60
    s_waitcnt lgkmcnt(0)
    s_mov_b64 exec, 3
    buffer_store_dwordx4 v[34:37], v22, s[24:27], s67 offen sc1
    s_mov_b64 exec, -1
    s_add_u32 m0, s40, 49152
    s_add_u32 s46, s38, 384
    buffer_load_dwordx4 v2, s[8:11], s46 offen lds
    s_add_u32 m0, s40, 50176
    s_nop 0
    buffer_load_dwordx4 v3, s[8:11], s46 offen lds
    s_add_u32 m0, s40, 51200
    s_add_u32 s46, s38, 16768
    buffer_load_dwordx4 v2, s[8:11], s46 offen lds
    s_add_u32 m0, s40, 52224
    s_nop 0
    buffer_load_dwordx4 v3, s[8:11], s46 offen lds
    s_mov_b32 exec_lo, s43
    s_mov_b32 exec_hi, s43
    s_add_u32 m0, s41, 49152
    s_add_u32 s62, s39, 688128
    buffer_load_dwordx4 v4, s[12:15], s62 offen lds
    s_add_u32 m0, s41, 50176
    s_add_u32 s62, s39, 716800
    buffer_load_dwordx4 v16, s[12:15], s62 offen lds
    s_mov_b64 exec, -1
    s_add_u32 m0, s41, 57344
    s_add_u32 s62, s39, 688256
    buffer_load_dwordx4 v4, s[12:15], s62 offen lds
    s_add_u32 m0, s41, 58368
    s_add_u32 s62, s39, 716928
    buffer_load_dwordx4 v16, s[12:15], s62 offen lds
    s_cmp_lg_u32 s54, 0
    s_cbranch_scc1 NOCS_4
    s_waitcnt lgkmcnt(0)
    ds_read_b64_tr_b16 v[48:49], v12 offset:49152
    ds_read_b64_tr_b16 v[50:51], v12 offset:49664
    ds_read_b64_tr_b16 v[52:53], v13 offset:49152
    ds_read_b64_tr_b16 v[54:55], v13 offset:49664
    ds_read_b64_tr_b16 v[56:57], v12 offset:51200
    ds_read_b64_tr_b16 v[58:59], v12 offset:51712
    ds_read_b64_tr_b16 v[60:61], v13 offset:51200
    ds_read_b64_tr_b16 v[62:63], v13 offset:51712
    ds_read_b64_tr_b16 v[64:65], v12 offset:53248
    ds_read_b64_tr_b16 v[66:67], v12 offset:53760
    ds_read_b64_tr_b16 v[68:69], v13 offset:53248
    ds_read_b64_tr_b16 v[70:71], v13 offset:53760
    ds_read_b64_tr_b16 v[72:73], v12 offset:55296
    ds_read_b64_tr_b16 v[74:75], v12 offset:55808
    s_waitcnt lgkmcnt(12)
    ds_read_b64_tr_b16 v[76:77], v13 offset:55296
    ds_read_b64_tr_b16 v[78:79], v13 offset:55808
    s_waitcnt lgkmcnt(8)
    v_dot2c_f32_bf16 v80, s70, v48
    v_dot2c_f32_bf16 v81, s70, v52
    v_dot2c_f32_bf16 v80, s70, v49
    v_dot2c_f32_bf16 v81, s70, v53
    v_dot2c_f32_bf16 v80, s70, v50
    v_dot2c_f32_bf16 v81, s70, v54
    v_dot2c_f32_bf16 v80, s70, v51
    v_dot2c_f32_bf16 v81, s70, v55
    v_dot2c_f32_bf16 v80, s70, v56
    v_dot2c_f32_bf16 v81, s70, v60
    v_dot2c_f32_bf16 v80, s70, v57
    v_dot2c_f32_bf16 v81, s70, v61
    v_dot2c_f32_bf16 v80, s70, v58
    v_dot2c_f32_bf16 v81, s70, v62
    v_dot2c_f32_bf16 v80, s70, v59
    v_dot2c_f32_bf16 v81, s70, v63
    s_waitcnt lgkmcnt(0)
    v_dot2c_f32_bf16 v80, s70, v64
    v_dot2c_f32_bf16 v81, s70, v68
    v_dot2c_f32_bf16 v80, s70, v65
    v_dot2c_f32_bf16 v81, s70, v69
    v_dot2c_f32_bf16 v80, s70, v66
    v_dot2c_f32_bf16 v81, s70, v70
    v_dot2c_f32_bf16 v80, s70, v67
    v_dot2c_f32_bf16 v81, s70, v71
    v_dot2c_f32_bf16 v80, s70, v72
    v_dot2c_f32_bf16 v81, s70, v76
    v_dot2c_f32_bf16 v80, s70, v73
    v_dot2c_f32_bf16 v81, s70, v77
    v_dot2c_f32_bf16 v80, s70, v74
    v_dot2c_f32_bf16 v81, s70, v78
    v_dot2c_f32_bf16 v80, s70, v75
    v_dot2c_f32_bf16 v81, s70, v79
NOCS_4:
    s_waitcnt vmcnt(9)
    s_barrier
    s_add_u32 m0, s41, 65536
    s_add_u32 s62, s39, 688384
    buffer_load_dwordx4 v4, s[12:15], s62 offen lds
    s_add_u32 m0, s41, 66560
    s_add_u32 s62, s39, 717056
    buffer_load_dwordx4 v16, s[12:15], s62 offen lds
    s_mov_b32 exec_lo, s44
    s_mov_b32 exec_hi, s44
    s_add_u32 m0, s41, 73728
    s_add_u32 s62, s39, 688512
    buffer_load_dwordx4 v4, s[12:15], s62 offen lds
    s_add_u32 m0, s41, 74752
    s_add_u32 s62, s39, 717184
    buffer_load_dwordx4 v16, s[12:15], s62 offen lds
    s_mov_b64 exec, -1
    s_and_b32 s48, s2, 127
    s_lshl2_add_u32 s48, s48, s100
    s_lshl_b32 s49, s48, 10
    s_mul_i32 s48, s48, 3584
    v_lshlrev_b32 v25, 7, v1
    s_mov_b64 exec, 0xfffffff
    buffer_load_dword v27, v25, s[16:19], s48 offen
    s_mov_b64 exec, 0xff
    buffer_load_dword v27, v25, s[20:23], s49 offen
    s_mov_b64 exec, -1
    s_add_u32 m0, s40, 98304
    s_add_u32 s46, s36, 512
    buffer_load_dwordx4 v2, s[8:11], s46 offen lds
    s_add_u32 m0, s40, 99328
    s_nop 0
    buffer_load_dwordx4 v3, s[8:11], s46 offen lds
    s_add_u32 m0, s40, 100352
    s_add_u32 s46, s36, 16896
    buffer_load_dwordx4 v2, s[8:11], s46 offen lds
    s_add_u32 m0, s40, 101376
    s_nop 0
    buffer_load_dwordx4 v3, s[8:11], s46 offen lds
    s_mov_b32 exec_lo, s43
    s_mov_b32 exec_hi, s43
    s_add_u32 m0, s41, 98304
    s_add_u32 s62, s37, 917504
    buffer_load_dwordx4 v4, s[12:15], s62 offen lds
    s_add_u32 m0, s41, 99328
    s_add_u32 s62, s37, 946176
    buffer_load_dwordx4 v16, s[12:15], s62 offen lds
    s_mov_b64 exec, -1
    s_add_u32 m0, s41, 106496
    s_add_u32 s62, s37, 917632
    buffer_load_dwordx4 v4, s[12:15], s62 offen lds
    s_add_u32 m0, s41, 107520
    s_add_u32 s62, s37, 946304
    buffer_load_dwordx4 v16, s[12:15], s62 offen lds
    s_cmp_lg_u32 s54, 1
    s_cbranch_scc1 NOCS_5
    s_waitcnt lgkmcnt(0)
    ds_read_b64_tr_b16 v[48:49], v12 offset:0
    ds_read_b64_tr_b16 v[50:51], v12 offset:512
    ds_read_b64_tr_b16 v[52:53], v13 offset:0
    ds_read_b64_tr_b16 v[54:55], v13 offset:512
    ds_read_b64_tr_b16 v[56:57], v12 offset:2048
    ds_read_b64_tr_b16 v[58:59], v12 offset:2560
    ds_read_b64_tr_b16 v[60:61], v13 offset:2048
    ds_read_b64_tr_b16 v[62:63], v13 offset:2560
    ds_read_b64_tr_b16 v[64:65], v12 offset:4096
    ds_read_b64_tr_b16 v[66:67], v12 offset:4608
    ds_read_b64_tr_b16 v[68:69], v13 offset:4096
    ds_read_b64_tr_b16 v[70:71], v13 offset:4608
    ds_read_b64_tr_b16 v[72:73], v12 offset:6144
    ds_read_b64_tr_b16 v[74:75], v12 offset:6656
    s_waitcnt lgkmcnt(12)
    ds_read_b64_tr_b16 v[76:77], v13 offset:6144
    ds_read_b64_tr_b16 v[78:79], v13 offset:6656
    s_waitcnt lgkmcnt(8)
    v_dot2c_f32_bf16 v80, s70, v48
    v_dot2c_f32_bf16 v81, s70, v52
    v_dot2c_f32_bf16 v80, s70, v49
    v_dot2c_f32_bf16 v81, s70, v53
    v_dot2c_f32_bf16 v80, s70, v50
    v_dot2c_f32_bf16 v81, s70, v54
    v_dot2c_f32_bf16 v80, s70, v51
    v_dot2c_f32_bf16 v81, s70, v55
    v_dot2c_f32_bf16 v80, s70, v56
    v_dot2c_f32_bf16 v81, s70, v60
    v_dot2c_f32_bf16 v80, s70, v57
    v_dot2c_f32_bf16 v81, s70, v61
    v_dot2c_f32_bf16 v80, s70, v58
    v_dot2c_f32_bf16 v81, s70, v62
    v_dot2c_f32_bf16 v80, s70, v59
    v_dot2c_f32_bf16 v81, s70, v63
    s_waitcnt lgkmcnt(0)
    v_dot2c_f32_bf16 v80, s70, v64
    v_dot2c_f32_bf16 v81, s70, v68
    v_dot2c_f32_bf16 v80, s70, v65
    v_dot2c_f32_bf16 v81, s70, v69
    v_dot2c_f32_bf16 v80, s70, v66
    v_dot2c_f32_bf16 v81, s70, v70
    v_dot2c_f32_bf16 v80, s70, v67
    v_dot2c_f32_bf16 v81, s70, v71
    v_dot2c_f32_bf16 v80, s70, v72
    v_dot2c_f32_bf16 v81, s70, v76
    v_dot2c_f32_bf16 v80, s70, v73
    v_dot2c_f32_bf16 v81, s70, v77
    v_dot2c_f32_bf16 v80, s70, v74
    v_dot2c_f32_bf16 v81, s70, v78
    v_dot2c_f32_bf16 v80, s70, v75
    v_dot2c_f32_bf16 v81, s70, v79
NOCS_5:
    s_waitcnt vmcnt(10)
    s_barrier
    s_add_u32 m0, s41, 114688
    s_add_u32 s62, s37, 917760
    buffer_load_dwordx4 v4, s[12:15], s62 offen lds
    s_add_u32 m0, s41, 115712
    s_add_u32 s62, s37, 946432
    buffer_load_dwordx4 v16, s[12:15], s62 offen lds
    s_mov_b32 exec_lo, s44
    s_mov_b32 exec_hi, s44
    s_add_u32 m0, s41, 122880
    s_add_u32 s62, s37, 917888
    buffer_load_dwordx4 v4, s[12:15], s62 offen lds
    s_add_u32 m0, s41, 123904
    s_add_u32 s62, s37, 946560
    buffer_load_dwordx4 v16, s[12:15], s62 offen lds
    s_mov_b64 exec, -1
    s_add_u32 m0, s40, 0
    s_add_u32 s46, s36, 640
    buffer_load_dwordx4 v2, s[8:11], s46 offen lds
    s_add_u32 m0, s40, 1024
    s_nop 0
    buffer_load_dwordx4 v3, s[8:11], s46 offen lds
    s_add_u32 m0, s40, 2048
    s_add_u32 s46, s36, 17024
    buffer_load_dwordx4 v2, s[8:11], s46 offen lds
    s_add_u32 m0, s40, 3072
    s_nop 0
    buffer_load_dwordx4 v3, s[8:11], s46 offen lds
    s_mov_b32 exec_lo, s43
    s_mov_b32 exec_hi, s43
    s_add_u32 m0, s41, 0
    s_add_u32 s62, s37, 1146880
    buffer_load_dwordx4 v4, s[12:15], s62 offen lds
    s_add_u32 m0, s41, 1024
    s_add_u32 s62, s37, 1175552
    buffer_load_dwordx4 v16, s[12:15], s62 offen lds
    s_mov_b64 exec, -1
    s_add_u32 m0, s41, 8192
    s_add_u32 s62, s37, 1147008
    buffer_load_dwordx4 v4, s[12:15], s62 offen lds
    s_add_u32 m0, s41, 9216
    s_add_u32 s62, s37, 1175680
    buffer_load_dwordx4 v16, s[12:15], s62 offen lds
    s_cmp_lg_u32 s54, 1
    s_cbranch_scc1 NOCS_6
    s_waitcnt lgkmcnt(0)
    ds_read_b64_tr_b16 v[48:49], v12 offset:49152
    ds_read_b64_tr_b16 v[50:51], v12 offset:49664
    ds_read_b64_tr_b16 v[52:53], v13 offset:49152
    ds_read_b64_tr_b16 v[54:55], v13 offset:49664
    ds_read_b64_tr_b16 v[56:57], v12 offset:51200
    ds_read_b64_tr_b16 v[58:59], v12 offset:51712
    ds_read_b64_tr_b16 v[60:61], v13 offset:51200
    ds_read_b64_tr_b16 v[62:63], v13 offset:51712
    ds_read_b64_tr_b16 v[64:65], v12 offset:53248
    ds_read_b64_tr_b16 v[66:67], v12 offset:53760
    ds_read_b64_tr_b16 v[68:69], v13 offset:53248
    ds_read_b64_tr_b16 v[70:71], v13 offset:53760
    ds_read_b64_tr_b16 v[72:73], v12 offset:55296
    ds_read_b64_tr_b16 v[74:75], v12 offset:55808
    s_waitcnt lgkmcnt(12)
    ds_read_b64_tr_b16 v[76:77], v13 offset:55296
    ds_read_b64_tr_b16 v[78:79], v13 offset:55808
    s_waitcnt lgkmcnt(8)
    v_dot2c_f32_bf16 v80, s70, v48
    v_dot2c_f32_bf16 v81, s70, v52
    v_dot2c_f32_bf16 v80, s70, v49
    v_dot2c_f32_bf16 v81, s70, v53
    v_dot2c_f32_bf16 v80, s70, v50
    v_dot2c_f32_bf16 v81, s70, v54
    v_dot2c_f32_bf16 v80, s70, v51
    v_dot2c_f32_bf16 v81, s70, v55
    v_dot2c_f32_bf16 v80, s70, v56
    v_dot2c_f32_bf16 v81, s70, v60
    v_dot2c_f32_bf16 v80, s70, v57
    v_dot2c_f32_bf16 v81, s70, v61
    v_dot2c_f32_bf16 v80, s70, v58
    v_dot2c_f32_bf16 v81, s70, v62
    v_dot2c_f32_bf16 v80, s70, v59
    v_dot2c_f32_bf16 v81, s70, v63
    s_waitcnt lgkmcnt(0)
    v_dot2c_f32_bf16 v80, s70, v64
    v_dot2c_f32_bf16 v81, s70, v68
    v_dot2c_f32_bf16 v80, s70, v65
    v_dot2c_f32_bf16 v81, s70, v69
    v_dot2c_f32_bf16 v80, s70, v66
    v_dot2c_f32_bf16 v81, s70, v70
    v_dot2c_f32_bf16 v80, s70, v67
    v_dot2c_f32_bf16 v81, s70, v71
    v_dot2c_f32_bf16 v80, s70, v72
    v_dot2c_f32_bf16 v81, s70, v76
    v_dot2c_f32_bf16 v80, s70, v73
    v_dot2c_f32_bf16 v81, s70, v77
    v_dot2c_f32_bf16 v80, s70, v74
    v_dot2c_f32_bf16 v81, s70, v78
    v_dot2c_f32_bf16 v80, s70, v75
    v_dot2c_f32_bf16 v81, s70, v79
NOCS_6:
    s_nop 2
    v_permlane32_swap_b32 v80, v81
    s_cmp_lt_u32 s54, 2
    s_cselect_b64 exec, -1, 0
    v_add_f32 v36, v80, v81
    buffer_store_dwordx2 v[36:37], v14, s[24:27], s98 offen sc1
    s_mov_b64 exec, -1
    s_waitcnt vmcnt(9)
    s_barrier
    s_add_u32 m0, s41, 16384
    s_add_u32 s62, s37, 1147136
    buffer_load_dwordx4 v4, s[12:15], s62 offen lds
    s_add_u32 m0, s41, 17408
    s_add_u32 s62, s37, 1175808
    buffer_load_dwordx4 v16, s[12:15], s62 offen lds
    s_mov_b32 exec_lo, s44
    s_mov_b32 exec_hi, s44
    s_add_u32 m0, s41, 24576
    s_add_u32 s62, s37, 1147264
    buffer_load_dwordx4 v4, s[12:15], s62 offen lds
    s_add_u32 m0, s41, 25600
    s_add_u32 s62, s37, 1175936
    buffer_load_dwordx4 v16, s[12:15], s62 offen lds
    s_mov_b64 exec, -1
    s_add_u32 m0, s40, 49152
    s_add_u32 s46, s36, 768
    buffer_load_dwordx4 v2, s[8:11], s46 offen lds
    s_add_u32 m0, s40, 50176
    s_nop 0
    buffer_load_dwordx4 v3, s[8:11], s46 offen lds
    s_add_u32 m0, s40, 51200
    s_add_u32 s46, s36, 17152
    buffer_load_dwordx4 v2, s[8:11], s46 offen lds
    s_add_u32 m0, s40, 52224
    s_nop 0
    buffer_load_dwordx4 v3, s[8:11], s46 offen lds
    s_mov_b32 exec_lo, s43
    s_mov_b32 exec_hi, s43
    s_add_u32 m0, s41, 49152
    s_add_u32 s62, s37, 1376256
    buffer_load_dwordx4 v4, s[12:15], s62 offen lds
    s_add_u32 m0, s41, 50176
    s_add_u32 s62, s37, 1404928
    buffer_load_dwordx4 v16, s[12:15], s62 offen lds
    s_mov_b64 exec, -1
    s_add_u32 m0, s41, 57344
    s_add_u32 s62, s37, 1376384
    buffer_load_dwordx4 v4, s[12:15], s62 offen lds
    s_add_u32 m0, s41, 58368
    s_add_u32 s62, s37, 1405056
    buffer_load_dwordx4 v16, s[12:15], s62 offen lds
    s_lshl1_add_u32 s48, s47, s52
    s_lshl1_add_u32 s48, s48, s55
    s_and_b32 s51, s56, 1
    s_lshl3_add_u32 s48, s48, s51
    s_lshl_b32 s48, s48, 7
    s_add_u32 s71, s48, 12058624
    s_lshl2_add_u32 s48, s47, s100
    s_mul_i32 s48, s48, 144
    s_mul_i32 s49, s55, 56
    s_add_u32 s48, s48, s49
    s_lshl_b32 s63, s48, 10
    s_lshl3_add_u32 s48, s47, s56
    s_lshl2_add_u32 s48, s48, s100
    s_mul_i32 s48, s48, 6144
    s_add_u32 s3, s48, 16777216
    s_sub_u32 s48, s55, s52
    s_mul_i32 s48, s48, 12288
    s_xor_b32 s64, s55, s52
    s_mul_i32 s49, s64, 3072
    s_add_u32 s48, s48, s49
    s_add_u32 s4, s3, s48
    s_lshl2_add_u32 s48, s101, s100
    s_and_b32 s49, s47, 3
    s_lshl4_add_u32 s48, s48, s49
    s_lshl_b32 s48, s48, 7
    s_add_u32 s6, s48, 12320768
    s_lshl1_add_u32 s48, s47, s55
    s_lshl1_add_u32 s48, s48, s53
    s_lshl_b32 s48, s48, 15
    s_lshl1_add_u32 s49, s56, s64
    s_lshl_b32 s49, s49, 6
    s_add_u32 s5, s48, s49
    v_lshlrev_b32 v8, 9, v21
    v_and_b32 v8, 0x200, v8
    v_sub_u32 v7, v7, v8
    v_xor_b32 v8, 64, v7
    v_add_u32 v9, 0x10000, v7
    v_add_u32 v10, 0x10000, v8
    v_mov_b32 v11, 161792
    s_lshl1_add_u32 s48, s47, s55
    s_lshl1_add_u32 s48, s48, s52
    s_lshl3_add_u32 s48, s48, s51
    s_lshl_b32 s48, s48, 7
    s_add_u32 s48, s48, 12189696
    s_lshl_b32 s49, s53, 6
    s_add_u32 s49, s49, s71
    s_buffer_load_dword s7, s[24:27], s49 glc
    s_buffer_load_dword s7, s[24:27], s6 glc
    s_buffer_load_dword s7, s[24:27], s48 glc
    s_buffer_load_dword s7, s[24:27], s4 offset:3064 glc
    s_waitcnt vmcnt(8)
    s_barrier
    s_add_u32 m0, s41, 65536
    s_add_u32 s62, s37, 1376512
    buffer_load_dwordx4 v4, s[12:15], s62 offen lds
    s_add_u32 m0, s41, 66560
    s_add_u32 s62, s37, 1405184
    buffer_load_dwordx4 v16, s[12:15], s62 offen lds
    s_mov_b32 exec_lo, s44
    s_mov_b32 exec_hi, s44
    s_add_u32 m0, s41, 73728
    s_add_u32 s62, s37, 1376640
    buffer_load_dwordx4 v4, s[12:15], s62 offen lds
    s_add_u32 m0, s41, 74752
    s_add_u32 s62, s37, 1405312
    buffer_load_dwordx4 v16, s[12:15], s62 offen lds
    s_mov_b64 exec, -1
    s_add_u32 m0, s40, 98304
    s_add_u32 s46, s36, 896
    buffer_load_dwordx4 v2, s[8:11], s46 offen lds
    s_add_u32 m0, s40, 99328
    s_nop 0
    buffer_load_dwordx4 v3, s[8:11], s46 offen lds
    s_add_u32 m0, s40, 100352
    s_add_u32 s46, s36, 17280
    buffer_load_dwordx4 v2, s[8:11], s46 offen lds
    s_add_u32 m0, s40, 101376
    s_nop 0
    buffer_load_dwordx4 v3, s[8:11], s46 offen lds
    s_mov_b32 exec_lo, s43
    s_mov_b32 exec_hi, s43
    s_add_u32 m0, s41, 98304
    s_add_u32 s62, s37, 1605632
    buffer_load_dwordx4 v4, s[12:15], s62 offen lds
    s_add_u32 m0, s41, 99328
    s_add_u32 s62, s37, 1634304
    buffer_load_dwordx4 v16, s[12:15], s62 offen lds
    s_mov_b64 exec, -1
    s_add_u32 m0, s41, 106496
    s_add_u32 s62, s37, 1605760
    buffer_load_dwordx4 v4, s[12:15], s62 offen lds
    s_add_u32 m0, s41, 107520
    s_add_u32 s62, s37, 1634432
    buffer_load_dwordx4 v16, s[12:15], s62 offen lds
    s_waitcnt vmcnt(8)
    s_barrier
    s_lshl2_add_u32 s48, s47, s100
    s_lshl_b32 s48, s48, 9
    s_add_u32 s48, s48, 11599872
    s_lshl_b32 s49, s100, 9
    s_add_u32 m0, s49, 157696
    s_mov_b32 exec_hi, 0
    buffer_load_dwordx4 v6, s[24:27], s48 offen sc1 lds
    s_mov_b32 exec_hi, -1
    buffer_load_dwordx2 v[84:85], v14, s[24:27], s42 offen offset:0 sc1
    buffer_load_dwordx2 v[86:87], v14, s[24:27], s42 offen offset:512 sc1
    buffer_load_dwordx2 v[88:89], v14, s[24:27], s42 offen offset:1024 sc1
    buffer_load_dwordx2 v[90:91], v14, s[24:27], s42 offen offset:1536 sc1
    s_add_u32 m0, s41, 114688
    s_add_u32 s62, s37, 1605888
    buffer_load_dwordx4 v4, s[12:15], s62 offen lds
    s_add_u32 m0, s41, 115712
    s_add_u32 s62, s37, 1634560
    buffer_load_dwordx4 v16, s[12:15], s62 offen lds
    s_mov_b32 exec_lo, s44
    s_mov_b32 exec_hi, s44
    s_add_u32 m0, s41, 122880
    s_add_u32 s62, s37, 1606016
    buffer_load_dwordx4 v4, s[12:15], s62 offen lds
    s_add_u32 m0, s41, 123904
    s_add_u32 s62, s37, 1634688
    buffer_load_dwordx4 v16, s[12:15], s62 offen lds
    s_mov_b64 exec, -1
    s_add_u32 m0, s58, 0
    s_add_u32 s62, s57, 0
    buffer_load_dwordx4 v5, s[16:19], s62 offen lds
    s_add_u32 m0, s58, 4096
    s_add_u32 s62, s57, 131072
    buffer_load_dwordx4 v5, s[16:19], s62 offen lds
    s_add_u32 m0, s58, 8192
    s_add_u32 s62, s57, 229376
    buffer_load_dwordx4 v5, s[16:19], s62 offen lds
    s_add_u32 m0, s58, 12288
    s_add_u32 s62, s57, 360448
    buffer_load_dwordx4 v5, s[16:19], s62 offen lds
    s_add_u32 m0, s58, 16384
    s_add_u32 s62, s57, 458752
    buffer_load_dwordx4 v5, s[16:19], s62 offen lds
    s_add_u32 m0, s58, 20480
    s_add_u32 s62, s57, 589824
    buffer_load_dwordx4 v5, s[16:19], s62 offen lds
    s_add_u32 m0, s58, 24576
    s_add_u32 s62, s57, 688128
    buffer_load_dwordx4 v5, s[16:19], s62 offen lds
    s_add_u32 m0, s58, 28672
    s_add_u32 s62, s57, 819200
    buffer_load_dwordx4 v5, s[16:19], s62 offen lds
    s_waitcnt vmcnt(8)
    s_barrier
    s_waitcnt vmcnt(12)
    v_xor_b32 v39, s60, v85
    v_xor_b32 v38, s60, v87
    v_or_b32 v39, v39, v38
    v_xor_b32 v38, s60, v89
    v_or_b32 v39, v39, v38
    v_xor_b32 v38, s60, v91
    v_or_b32 v39, v39, v38
    v_cmp_ne_u32 vcc, 0, v39
    s_cbranch_vccnz SL_7
SE_8:
    v_add_f32 v84, v84, v86
    v_add_f32 v88, v88, v90
    v_add_f32 v84, v84, v88
    v_cvt_pk_bf16_f32 v85, v84, v84
    v_lshlrev_b32 v85, 16, v85
    v_sub_f32 v85, v84, v85
    v_cvt_pk_bf16_f32 v84, v84, v85
    ds_write_b32 v15, v84
    s_add_u32 m0, s58, 32768
    s_add_u32 s62, s57, 32768
    buffer_load_dwordx4 v5, s[16:19], s62 offen lds
    s_add_u32 m0, s58, 36864
    s_add_u32 s62, s57, 163840
    buffer_load_dwordx4 v5, s[16:19], s62 offen lds
    s_add_u32 m0, s58, 40960
    s_add_u32 s62, s57, 262144
    buffer_load_dwordx4 v5, s[16:19], s62 offen lds
    s_add_u32 m0, s58, 45056
    s_add_u32 s62, s57, 393216
    buffer_load_dwordx4 v5, s[16:19], s62 offen lds
    s_add_u32 m0, s58, 49152
    s_add_u32 s62, s57, 491520
    buffer_load_dwordx4 v5, s[16:19], s62 offen lds
    s_add_u32 m0, s58, 53248
    s_add_u32 s62, s57, 622592
    buffer_load_dwordx4 v5, s[16:19], s62 offen lds
    s_add_u32 m0, s58, 57344
    s_add_u32 s62, s57, 720896
    buffer_load_dwordx4 v5, s[16:19], s62 offen lds
    s_add_u32 m0, s58, 61440
    s_add_u32 s62, s57, 851968
    buffer_load_dwordx4 v5, s[16:19], s62 offen lds
    s_add_u32 m0, s58, 65536
    s_add_u32 s62, s57, 65536
    buffer_load_dwordx4 v5, s[16:19], s62 offen lds
    s_add_u32 m0, s58, 69632
    s_add_u32 s62, s57, 196608
    buffer_load_dwordx4 v5, s[16:19], s62 offen lds
    s_waitcnt lgkmcnt(0)
    s_branch L_PH2H
RET1_S:
    s_cbranch_vccnz RET1_B
    s_branch RET1_A
L_HB:
    s_lshl2_add_u32 s48, s54, s100
    s_mul_i32 s48, s48, s4
    s_lshl2_add_u32 s48, s48, s5
    s_add_u32 s0, s48, s51
    v_lshrrev_b32 v22, 4, v1
    v_bfe_u32 v23, v1, 2, 2
    v_lshl_add_u32 v22, v22, 6, v23
    v_add_u32 v22, 64, v22
    v_and_b32 v23, 3, v1
    v_lshlrev_b32 v23, 10, v23
    v_mad_u32_u24 v26, v22, s4, v23
    s_mov_b32 exec_lo, 0x77777777
    s_mov_b32 exec_hi, 0x7777
    buffer_load_dword v27, v26, s[12:15], s0 offen
    s_mov_b64 exec, -1
    s_mov_b32 s20, s34
    s_mov_b32 s21, s35
    s_mov_b32 s34, s30
    s_mov_b32 s35, s31
    s_mov_b32 s66, 0xffff0000
    s_lshr_b32 s56, s45, 2
    s_xor_b32 s56, s56, 6
    s_bfe_u32 s48, s2, 0x10002
    s_lshl2_add_u32 s54, s48, s54
    s_mov_b32 s30, 0x200000
    s_mov_b32 s31, 0x20000
    s_mov_b32 s22, 0x80000
    s_mov_b32 s23, 0x20000
    s_mov_b32 s16, s18
    s_mov_b32 s17, s19
    s_mov_b32 s18, 0x1c0000
    s_mov_b32 s19, 0x20000
    s_add_u32 s24, s24, 0x0
    s_addc_u32 s25, s25, 0
    s_mov_b32 s26, 25165824
    s_mov_b32 s27, 0x20000
    s_and_b32 s53, s100, 1
    s_lshr_b32 s52, s100, 1
    v_bfe_u32 v22, v1, 2, 2
    v_lshl_add_u32 v22, v21, 3, v22
    v_bfe_u32 v23, v1, 4, 1
    v_lshlrev_b32 v23, 5, v23
    v_and_b32 v24, 1, v1
    v_lshl_add_u32 v23, v24, 4, v23
    v_bfe_u32 v24, v1, 1, 1
    v_lshl_add_u32 v23, v24, 3, v23
    v_bfe_u32 v24, v1, 3, 1
    v_lshl_add_u32 v23, v24, 6, v23
    v_lshl_add_u32 v7, v22, 7, v23
    s_cmp_eq_u32 s54, 0
    s_cselect_b32 s48, 49152, 0
    s_lshl_b32 s49, s100, 13
    s_add_u32 s48, s48, s49
    s_add_u32 s48, s48, 0x4000
    v_and_b32 v13, 32, v1
    v_xor_b32 v13, v13, v7
    v_add_u32 v12, s48, v13
    v_xor_b32 v13, 64, v12
    s_lshl3_add_u32 s42, s61, s101
    s_lshl2_add_u32 s42, s42, s100
    s_lshl_b32 s42, s42, 12
    s_add_u32 s42, s42, 11665408
    s_lshl1_add_u32 s98, s3, s54
    s_lshl_b32 s98, s98, 9
    s_add_u32 s98, s98, s42
    v_lshlrev_b32 v14, 3, v1
    s_lshl_b32 s48, s100, 8
    s_add_u32 s48, s48, 162816
    v_lshlrev_b32 v15, 2, v1
    v_add_u32 v15, s48, v15
    s_lshl_b32 s50, s100, 13
    s_lshl_b32 s48, s56, 7
    s_add_u32 s59, s50, s48
    s_mul_i32 s48, s55, 917504
    s_add_u32 s57, s59, s48
    s_lshl_b32 s58, s100, 10
    v_mov_b32 v80, 0
    v_mov_b32 v81, 0
    v_mov_b32 v82, 0
    v_mov_b32 v83, 0
    v_mov_b32 v22, 161792
    ds_write_b128 v22, v[80:83]
    ds_write_b128 v22, v[80:83] offset:16
    ds_write_b128 v22, v[80:83] offset:32
    s_lshl_b32 s48, s100, 9
    s_add_u32 s48, s48, 159744
    v_add_u32 v22, s48, v14
    ds_write_b64 v22, v[80:81]
    s_mov_b32 s70, 0x3e803e80
    s_bitcmp1_b32 s101, 0
    s_cselect_b32 s43, 0x0f0ff0f0, -1
    s_cselect_b32 s44, -1, 0xf0f00f0f
    s_add_u32 m0, s40, 98304
    s_add_u32 s46, s38, 128
    buffer_load_dwordx4 v2, s[8:11], s46 offen lds
    s_add_u32 m0, s40, 99328
    s_nop 0
    buffer_load_dwordx4 v3, s[8:11], s46 offen lds
    s_add_u32 m0, s40, 100352
    s_add_u32 s46, s38, 16512
    buffer_load_dwordx4 v2, s[8:11], s46 offen lds
    s_add_u32 m0, s40, 101376
    s_nop 0
    buffer_load_dwordx4 v3, s[8:11], s46 offen lds
    s_mov_b64 exec, 0
    s_mov_b64 vcc, 1
    s_cmp_eq_u32 s100, 0
    s_cbranch_scc1 SEG_S1_0
    s_cmp_eq_u32 s100, 1
    s_cbranch_scc1 SEG_S1_1
    s_cmp_eq_u32 s100, 2
    s_cbranch_scc1 SEG_S1_2
    s_branch SEG_S1_3
RET1_B:
    s_mov_b64 exec, -1
    s_waitcnt vmcnt(5) lgkmcnt(0)
    s_barrier
    s_setprio 0
    s_load_dword s60, s[34:35], 0
    s_add_u32 m0, s41, 98304
    s_add_u32 s62, s39, 196608
    buffer_load_dwordx4 v4, s[12:15], s62 offen lds
    s_add_u32 m0, s41, 99328
    s_add_u32 s62, s39, 221184
    buffer_load_dwordx4 v16, s[12:15], s62 offen lds
    s_add_u32 m0, s41, 106496
    s_add_u32 s62, s39, 197632
    buffer_load_dwordx4 v4, s[12:15], s62 offen lds
    s_add_u32 m0, s41, 107520
    s_add_u32 s62, s39, 222208
    buffer_load_dwordx4 v16, s[12:15], s62 offen lds
    s_add_u32 m0, s41, 114688
    s_add_u32 s62, s39, 198656
    buffer_load_dwordx4 v4, s[12:15], s62 offen lds
    s_add_u32 m0, s41, 115712
    s_add_u32 s62, s39, 223232
    buffer_load_dwordx4 v16, s[12:15], s62 offen lds
    s_and_b32 s50, s100, 1
    s_lshl_b32 s48, s101, 11
    s_lshl_b32 s49, s50, 10
    s_add_u32 s48, s48, s49
    s_add_u32 s68, s32, s48
    s_addc_u32 s69, s33, 0
    s_add_u32 m0, s49, 155648
    s_nop 0
    global_load_lds_dwordx4 v6, s[68:69]
    s_add_u32 m0, s40, 0
    s_add_u32 s46, s38, 256
    buffer_load_dwordx4 v2, s[8:11], s46 offen lds
    s_add_u32 m0, s40, 1024
    s_nop 0
    buffer_load_dwordx4 v3, s[8:11], s46 offen lds
    s_add_u32 m0, s40, 2048
    s_add_u32 s46, s38, 16640
    buffer_load_dwordx4 v2, s[8:11], s46 offen lds
    s_add_u32 m0, s40, 3072
    s_nop 0
    buffer_load_dwordx4 v3, s[8:11], s46 offen lds
    s_add_u32 m0, s41, 0
    s_add_u32 s62, s39, 393216
    buffer_load_dwordx4 v4, s[12:15], s62 offen lds
    s_add_u32 m0, s41, 1024
    s_add_u32 s62, s39, 417792
    buffer_load_dwordx4 v16, s[12:15], s62 offen lds
    s_add_u32 m0, s41, 8192
    s_add_u32 s62, s39, 394240
    buffer_load_dwordx4 v4, s[12:15], s62 offen lds
    s_add_u32 m0, s41, 9216
    s_add_u32 s62, s39, 418816
    buffer_load_dwordx4 v16, s[12:15], s62 offen lds
    s_cmp_lg_u32 s54, 0
    s_cbranch_scc1 NOCS_9
    s_waitcnt lgkmcnt(0)
    ds_read_b64_tr_b16 v[48:49], v12 offset:0
    ds_read_b64_tr_b16 v[50:51], v12 offset:512
    ds_read_b64_tr_b16 v[52:53], v13 offset:0
    ds_read_b64_tr_b16 v[54:55], v13 offset:512
    ds_read_b64_tr_b16 v[56:57], v12 offset:2048
    ds_read_b64_tr_b16 v[58:59], v12 offset:2560
    ds_read_b64_tr_b16 v[60:61], v13 offset:2048
    ds_read_b64_tr_b16 v[62:63], v13 offset:2560
    ds_read_b64_tr_b16 v[64:65], v12 offset:4096
    ds_read_b64_tr_b16 v[66:67], v12 offset:4608
    ds_read_b64_tr_b16 v[68:69], v13 offset:4096
    ds_read_b64_tr_b16 v[70:71], v13 offset:4608
    ds_read_b64_tr_b16 v[72:73], v12 offset:6144
    ds_read_b64_tr_b16 v[74:75], v12 offset:6656
    s_waitcnt lgkmcnt(12)
    ds_read_b64_tr_b16 v[76:77], v13 offset:6144
    ds_read_b64_tr_b16 v[78:79], v13 offset:6656
    s_waitcnt lgkmcnt(8)
    v_dot2c_f32_bf16 v80, s70, v48
    v_dot2c_f32_bf16 v81, s70, v52
    v_dot2c_f32_bf16 v80, s70, v49
    v_dot2c_f32_bf16 v81, s70, v53
    v_dot2c_f32_bf16 v80, s70, v50
    v_dot2c_f32_bf16 v81, s70, v54
    v_dot2c_f32_bf16 v80, s70, v51
    v_dot2c_f32_bf16 v81, s70, v55
    v_dot2c_f32_bf16 v80, s70, v56
    v_dot2c_f32_bf16 v81, s70, v60
    v_dot2c_f32_bf16 v80, s70, v57
    v_dot2c_f32_bf16 v81, s70, v61
    v_dot2c_f32_bf16 v80, s70, v58
    v_dot2c_f32_bf16 v81, s70, v62
    v_dot2c_f32_bf16 v80, s70, v59
    v_dot2c_f32_bf16 v81, s70, v63
    s_waitcnt lgkmcnt(0)
    v_dot2c_f32_bf16 v80, s70, v64
    v_dot2c_f32_bf16 v81, s70, v68
    v_dot2c_f32_bf16 v80, s70, v65
    v_dot2c_f32_bf16 v81, s70, v69
    v_dot2c_f32_bf16 v80, s70, v66
    v_dot2c_f32_bf16 v81, s70, v70
    v_dot2c_f32_bf16 v80, s70, v67
    v_dot2c_f32_bf16 v81, s70, v71
    v_dot2c_f32_bf16 v80, s70, v72
    v_dot2c_f32_bf16 v81, s70, v76
    v_dot2c_f32_bf16 v80, s70, v73
    v_dot2c_f32_bf16 v81, s70, v77
    v_dot2c_f32_bf16 v80, s70, v74
    v_dot2c_f32_bf16 v81, s70, v78
    v_dot2c_f32_bf16 v80, s70, v75
    v_dot2c_f32_bf16 v81, s70, v79
NOCS_9:
    s_waitcnt vmcnt(9)
    s_barrier
    s_add_u32 m0, s41, 16384
    s_add_u32 s62, s39, 395264
    buffer_load_dwordx4 v4, s[12:15], s62 offen lds
    s_add_u32 m0, s41, 17408
    s_add_u32 s62, s39, 419840
    buffer_load_dwordx4 v16, s[12:15], s62 offen lds
    s_add_u32 m0, s40, 49152
    s_add_u32 s46, s38, 384
    buffer_load_dwordx4 v2, s[8:11], s46 offen lds
    s_add_u32 m0, s40, 50176
    s_nop 0
    buffer_load_dwordx4 v3, s[8:11], s46 offen lds
    s_add_u32 m0, s40, 51200
    s_add_u32 s46, s38, 16768
    buffer_load_dwordx4 v2, s[8:11], s46 offen lds
    s_add_u32 m0, s40, 52224
    s_nop 0
    buffer_load_dwordx4 v3, s[8:11], s46 offen lds
    s_add_u32 m0, s41, 49152
    s_add_u32 s62, s39, 589824
    buffer_load_dwordx4 v4, s[12:15], s62 offen lds
    s_add_u32 m0, s41, 50176
    s_add_u32 s62, s39, 614400
    buffer_load_dwordx4 v16, s[12:15], s62 offen lds
    s_add_u32 m0, s41, 57344
    s_add_u32 s62, s39, 590848
    buffer_load_dwordx4 v4, s[12:15], s62 offen lds
    s_add_u32 m0, s41, 58368
    s_add_u32 s62, s39, 615424
    buffer_load_dwordx4 v16, s[12:15], s62 offen lds
    s_cmp_lg_u32 s54, 0
    s_cbranch_scc1 NOCS_10
    s_waitcnt lgkmcnt(0)
    ds_read_b64_tr_b16 v[48:49], v12 offset:49152
    ds_read_b64_tr_b16 v[50:51], v12 offset:49664
    ds_read_b64_tr_b16 v[52:53], v13 offset:49152
    ds_read_b64_tr_b16 v[54:55], v13 offset:49664
    ds_read_b64_tr_b16 v[56:57], v12 offset:51200
    ds_read_b64_tr_b16 v[58:59], v12 offset:51712
    ds_read_b64_tr_b16 v[60:61], v13 offset:51200
    ds_read_b64_tr_b16 v[62:63], v13 offset:51712
    ds_read_b64_tr_b16 v[64:65], v12 offset:53248
    ds_read_b64_tr_b16 v[66:67], v12 offset:53760
    ds_read_b64_tr_b16 v[68:69], v13 offset:53248
    ds_read_b64_tr_b16 v[70:71], v13 offset:53760
    ds_read_b64_tr_b16 v[72:73], v12 offset:55296
    ds_read_b64_tr_b16 v[74:75], v12 offset:55808
    s_waitcnt lgkmcnt(12)
    ds_read_b64_tr_b16 v[76:77], v13 offset:55296
    ds_read_b64_tr_b16 v[78:79], v13 offset:55808
    s_waitcnt lgkmcnt(8)
    v_dot2c_f32_bf16 v80, s70, v48
    v_dot2c_f32_bf16 v81, s70, v52
    v_dot2c_f32_bf16 v80, s70, v49
    v_dot2c_f32_bf16 v81, s70, v53
    v_dot2c_f32_bf16 v80, s70, v50
    v_dot2c_f32_bf16 v81, s70, v54
    v_dot2c_f32_bf16 v80, s70, v51
    v_dot2c_f32_bf16 v81, s70, v55
    v_dot2c_f32_bf16 v80, s70, v56
    v_dot2c_f32_bf16 v81, s70, v60
    v_dot2c_f32_bf16 v80, s70, v57
    v_dot2c_f32_bf16 v81, s70, v61
    v_dot2c_f32_bf16 v80, s70, v58
    v_dot2c_f32_bf16 v81, s70, v62
    v_dot2c_f32_bf16 v80, s70, v59
    v_dot2c_f32_bf16 v81, s70, v63
    s_waitcnt lgkmcnt(0)
    v_dot2c_f32_bf16 v80, s70, v64
    v_dot2c_f32_bf16 v81, s70, v68
    v_dot2c_f32_bf16 v80, s70, v65
    v_dot2c_f32_bf16 v81, s70, v69
    v_dot2c_f32_bf16 v80, s70, v66
    v_dot2c_f32_bf16 v81, s70, v70
    v_dot2c_f32_bf16 v80, s70, v67
    v_dot2c_f32_bf16 v81, s70, v71
    v_dot2c_f32_bf16 v80, s70, v72
    v_dot2c_f32_bf16 v81, s70, v76
    v_dot2c_f32_bf16 v80, s70, v73
    v_dot2c_f32_bf16 v81, s70, v77
    v_dot2c_f32_bf16 v80, s70, v74
    v_dot2c_f32_bf16 v81, s70, v78
    v_dot2c_f32_bf16 v80, s70, v75
    v_dot2c_f32_bf16 v81, s70, v79
NOCS_10:
    s_waitcnt vmcnt(8)
    s_barrier
    s_lshl_b32 s48, s100, 5
    s_add_u32 s49, s48, 161856
    v_and_b32 v22, 16, v6
    v_add_u32 v23, s49, v22
    ds_read_b96 v[34:36], v23
    s_lshl3_add_u32 s49, s61, s101
    s_lshl4_add_u32 s49, s47, s49
    s_lshl_b32 s49, s49, 7
    s_add_u32 s48, s48, s49
    s_add_u32 s67, s48, 11599872
    s_add_u32 m0, s41, 65536
    s_add_u32 s62, s39, 591872
    buffer_load_dwordx4 v4, s[12:15], s62 offen lds
    s_add_u32 m0, s41, 66560
    s_add_u32 s62, s39, 616448
    buffer_load_dwordx4 v16, s[12:15], s62 offen lds
    s_and_b32 s48, s45, 15
    s_lshl4_add_u32 s48, s100, s48
    s_lshl_b32 s48, s48, 10
    v_lshlrev_b32 v24, 16, v1
    s_mul_i32 s49, s55, 917504
    s_add_u32 s49, s49, s48
    s_mov_b64 exec, 0x3fff
    buffer_load_dword v27, v24, s[16:19], s49 offen offset:384
    s_mov_b64 exec, 0xff
    buffer_load_dword v27, v24, s[20:23], s48 offen offset:384
    s_mov_b64 exec, -1
    s_waitcnt lgkmcnt(0)
    s_cmp_eq_u32 s60, 0
    s_cselect_b64 vcc, -1, 0
    s_cbranch_vccnz SL_11
SE_12:
    v_mov_b32 v37, s60
    s_waitcnt lgkmcnt(0)
    s_mov_b64 exec, 3
    buffer_store_dwordx4 v[34:37], v22, s[24:27], s67 offen sc1
    s_mov_b64 exec, -1
    s_add_u32 m0, s40, 98304
    s_add_u32 s46, s36, 512
    buffer_load_dwordx4 v2, s[8:11], s46 offen lds
    s_add_u32 m0, s40, 99328
    s_nop 0
    buffer_load_dwordx4 v3, s[8:11], s46 offen lds
    s_add_u32 m0, s40, 100352
    s_add_u32 s46, s36, 16896
    buffer_load_dwordx4 v2, s[8:11], s46 offen lds
    s_add_u32 m0, s40, 101376
    s_nop 0
    buffer_load_dwordx4 v3, s[8:11], s46 offen lds
    s_add_u32 m0, s41, 98304
    s_add_u32 s62, s37, 786432
    buffer_load_dwordx4 v4, s[12:15], s62 offen lds
    s_add_u32 m0, s41, 99328
    s_add_u32 s62, s37, 811008
    buffer_load_dwordx4 v16, s[12:15], s62 offen lds
    s_add_u32 m0, s41, 106496
    s_add_u32 s62, s37, 787456
    buffer_load_dwordx4 v4, s[12:15], s62 offen lds
    s_add_u32 m0, s41, 107520
    s_add_u32 s62, s37, 812032
    buffer_load_dwordx4 v16, s[12:15], s62 offen lds
    s_cmp_lg_u32 s54, 1
    s_cbranch_scc1 NOCS_13
    s_waitcnt lgkmcnt(0)
    ds_read_b64_tr_b16 v[48:49], v12 offset:0
    ds_read_b64_tr_b16 v[50:51], v12 offset:512
    ds_read_b64_tr_b16 v[52:53], v13 offset:0
    ds_read_b64_tr_b16 v[54:55], v13 offset:512
    ds_read_b64_tr_b16 v[56:57], v12 offset:2048
    ds_read_b64_tr_b16 v[58:59], v12 offset:2560
    ds_read_b64_tr_b16 v[60:61], v13 offset:2048
    ds_read_b64_tr_b16 v[62:63], v13 offset:2560
    ds_read_b64_tr_b16 v[64:65], v12 offset:4096
    ds_read_b64_tr_b16 v[66:67], v12 offset:4608
    ds_read_b64_tr_b16 v[68:69], v13 offset:4096
    ds_read_b64_tr_b16 v[70:71], v13 offset:4608
    ds_read_b64_tr_b16 v[72:73], v12 offset:6144
    ds_read_b64_tr_b16 v[74:75], v12 offset:6656
    s_waitcnt lgkmcnt(12)
    ds_read_b64_tr_b16 v[76:77], v13 offset:6144
    ds_read_b64_tr_b16 v[78:79], v13 offset:6656
    s_waitcnt lgkmcnt(8)
    v_dot2c_f32_bf16 v80, s70, v48
    v_dot2c_f32_bf16 v81, s70, v52
    v_dot2c_f32_bf16 v80, s70, v49
    v_dot2c_f32_bf16 v81, s70, v53
    v_dot2c_f32_bf16 v80, s70, v50
    v_dot2c_f32_bf16 v81, s70, v54
    v_dot2c_f32_bf16 v80, s70, v51
    v_dot2c_f32_bf16 v81, s70, v55
    v_dot2c_f32_bf16 v80, s70, v56
    v_dot2c_f32_bf16 v81, s70, v60
    v_dot2c_f32_bf16 v80, s70, v57
    v_dot2c_f32_bf16 v81, s70, v61
    v_dot2c_f32_bf16 v80, s70, v58
    v_dot2c_f32_bf16 v81, s70, v62
    v_dot2c_f32_bf16 v80, s70, v59
    v_dot2c_f32_bf16 v81, s70, v63
    s_waitcnt lgkmcnt(0)
    v_dot2c_f32_bf16 v80, s70, v64
    v_dot2c_f32_bf16 v81, s70, v68
    v_dot2c_f32_bf16 v80, s70, v65
    v_dot2c_f32_bf16 v81, s70, v69
    v_dot2c_f32_bf16 v80, s70, v66
    v_dot2c_f32_bf16 v81, s70, v70
    v_dot2c_f32_bf16 v80, s70, v67
    v_dot2c_f32_bf16 v81, s70, v71
    v_dot2c_f32_bf16 v80, s70, v72
    v_dot2c_f32_bf16 v81, s70, v76
    v_dot2c_f32_bf16 v80, s70, v73
    v_dot2c_f32_bf16 v81, s70, v77
    v_dot2c_f32_bf16 v80, s70, v74
    v_dot2c_f32_bf16 v81, s70, v78
    v_dot2c_f32_bf16 v80, s70, v75
    v_dot2c_f32_bf16 v81, s70, v79
NOCS_13:
    s_waitcnt vmcnt(11)
    s_barrier
    s_add_u32 m0, s41, 114688
    s_add_u32 s62, s37, 788480
    buffer_load_dwordx4 v4, s[12:15], s62 offen lds
    s_add_u32 m0, s41, 115712
    s_add_u32 s62, s37, 813056
    buffer_load_dwordx4 v16, s[12:15], s62 offen lds
    s_add_u32 m0, s40, 0
    s_add_u32 s46, s36, 640
    buffer_load_dwordx4 v2, s[8:11], s46 offen lds
    s_add_u32 m0, s40, 1024
    s_nop 0
    buffer_load_dwordx4 v3, s[8:11], s46 offen lds
    s_add_u32 m0, s40, 2048
    s_add_u32 s46, s36, 17024
    buffer_load_dwordx4 v2, s[8:11], s46 offen lds
    s_add_u32 m0, s40, 3072
    s_nop 0
    buffer_load_dwordx4 v3, s[8:11], s46 offen lds
    s_add_u32 m0, s41, 0
    s_add_u32 s62, s37, 983040
    buffer_load_dwordx4 v4, s[12:15], s62 offen lds
    s_add_u32 m0, s41, 1024
    s_add_u32 s62, s37, 1007616
    buffer_load_dwordx4 v16, s[12:15], s62 offen lds
    s_add_u32 m0, s41, 8192
    s_add_u32 s62, s37, 984064
    buffer_load_dwordx4 v4, s[12:15], s62 offen lds
    s_add_u32 m0, s41, 9216
    s_add_u32 s62, s37, 1008640
    buffer_load_dwordx4 v16, s[12:15], s62 offen lds
    s_cmp_lg_u32 s54, 1
    s_cbranch_scc1 NOCS_14
    s_waitcnt lgkmcnt(0)
    ds_read_b64_tr_b16 v[48:49], v12 offset:49152
    ds_read_b64_tr_b16 v[50:51], v12 offset:49664
    ds_read_b64_tr_b16 v[52:53], v13 offset:49152
    ds_read_b64_tr_b16 v[54:55], v13 offset:49664
    ds_read_b64_tr_b16 v[56:57], v12 offset:51200
    ds_read_b64_tr_b16 v[58:59], v12 offset:51712
    ds_read_b64_tr_b16 v[60:61], v13 offset:51200
    ds_read_b64_tr_b16 v[62:63], v13 offset:51712
    ds_read_b64_tr_b16 v[64:65], v12 offset:53248
    ds_read_b64_tr_b16 v[66:67], v12 offset:53760
    ds_read_b64_tr_b16 v[68:69], v13 offset:53248
    ds_read_b64_tr_b16 v[70:71], v13 offset:53760
    ds_read_b64_tr_b16 v[72:73], v12 offset:55296
    ds_read_b64_tr_b16 v[74:75], v12 offset:55808
    s_waitcnt lgkmcnt(12)
    ds_read_b64_tr_b16 v[76:77], v13 offset:55296
    ds_read_b64_tr_b16 v[78:79], v13 offset:55808
    s_waitcnt lgkmcnt(8)
    v_dot2c_f32_bf16 v80, s70, v48
    v_dot2c_f32_bf16 v81, s70, v52
    v_dot2c_f32_bf16 v80, s70, v49
    v_dot2c_f32_bf16 v81, s70, v53
    v_dot2c_f32_bf16 v80, s70, v50
    v_dot2c_f32_bf16 v81, s70, v54
    v_dot2c_f32_bf16 v80, s70, v51
    v_dot2c_f32_bf16 v81, s70, v55
    v_dot2c_f32_bf16 v80, s70, v56
    v_dot2c_f32_bf16 v81, s70, v60
    v_dot2c_f32_bf16 v80, s70, v57
    v_dot2c_f32_bf16 v81, s70, v61
    v_dot2c_f32_bf16 v80, s70, v58
    v_dot2c_f32_bf16 v81, s70, v62
    v_dot2c_f32_bf16 v80, s70, v59
    v_dot2c_f32_bf16 v81, s70, v63
    s_waitcnt lgkmcnt(0)
    v_dot2c_f32_bf16 v80, s70, v64
    v_dot2c_f32_bf16 v81, s70, v68
    v_dot2c_f32_bf16 v80, s70, v65
    v_dot2c_f32_bf16 v81, s70, v69
    v_dot2c_f32_bf16 v80, s70, v66
    v_dot2c_f32_bf16 v81, s70, v70
    v_dot2c_f32_bf16 v80, s70, v67
    v_dot2c_f32_bf16 v81, s70, v71
    v_dot2c_f32_bf16 v80, s70, v72
    v_dot2c_f32_bf16 v81, s70, v76
    v_dot2c_f32_bf16 v80, s70, v73
    v_dot2c_f32_bf16 v81, s70, v77
    v_dot2c_f32_bf16 v80, s70, v74
    v_dot2c_f32_bf16 v81, s70, v78
    v_dot2c_f32_bf16 v80, s70, v75
    v_dot2c_f32_bf16 v81, s70, v79
NOCS_14:
    s_nop 2
    v_permlane32_swap_b32 v80, v81
    s_cmp_lt_u32 s54, 2
    s_cselect_b64 exec, -1, 0
    v_add_f32 v36, v80, v81
    buffer_store_dwordx2 v[36:37], v14, s[24:27], s98 offen sc1
    s_mov_b64 exec, -1
    s_waitcnt vmcnt(9)
    s_barrier
    s_add_u32 m0, s41, 16384
    s_add_u32 s62, s37, 985088
    buffer_load_dwordx4 v4, s[12:15], s62 offen lds
    s_add_u32 m0, s41, 17408
    s_add_u32 s62, s37, 1009664
    buffer_load_dwordx4 v16, s[12:15], s62 offen lds
    s_add_u32 m0, s40, 49152
    s_add_u32 s46, s36, 768
    buffer_load_dwordx4 v2, s[8:11], s46 offen lds
    s_add_u32 m0, s40, 50176
    s_nop 0
    buffer_load_dwordx4 v3, s[8:11], s46 offen lds
    s_add_u32 m0, s40, 51200
    s_add_u32 s46, s36, 17152
    buffer_load_dwordx4 v2, s[8:11], s46 offen lds
    s_add_u32 m0, s40, 52224
    s_nop 0
    buffer_load_dwordx4 v3, s[8:11], s46 offen lds
    s_add_u32 m0, s41, 49152
    s_add_u32 s62, s37, 1179648
    buffer_load_dwordx4 v4, s[12:15], s62 offen lds
    s_add_u32 m0, s41, 50176
    s_add_u32 s62, s37, 1204224
    buffer_load_dwordx4 v16, s[12:15], s62 offen lds
    s_add_u32 m0, s41, 57344
    s_add_u32 s62, s37, 1180672
    buffer_load_dwordx4 v4, s[12:15], s62 offen lds
    s_add_u32 m0, s41, 58368
    s_add_u32 s62, s37, 1205248
    buffer_load_dwordx4 v16, s[12:15], s62 offen lds
    s_lshl1_add_u32 s48, s47, s52
    s_lshl1_add_u32 s48, s48, s55
    s_and_b32 s51, s56, 1
    s_lshl3_add_u32 s48, s48, s51
    s_lshl_b32 s48, s48, 7
    s_add_u32 s71, s48, 12058624
    s_lshl2_add_u32 s48, s47, s100
    s_mul_i32 s48, s48, 144
    s_mul_i32 s49, s55, 56
    s_add_u32 s48, s48, s49
    s_lshl_b32 s63, s48, 10
    s_lshl3_add_u32 s48, s47, s56
    s_lshl2_add_u32 s48, s48, s100
    s_mul_i32 s48, s48, 6144
    s_add_u32 s3, s48, 16777216
    s_sub_u32 s48, s55, s52
    s_mul_i32 s48, s48, 12288
    s_xor_b32 s64, s55, s52
    s_mul_i32 s49, s64, 3072
    s_add_u32 s48, s48, s49
    s_add_u32 s4, s3, s48
    s_lshl2_add_u32 s48, s101, s100
    s_and_b32 s49, s47, 3
    s_lshl4_add_u32 s48, s48, s49
    s_lshl_b32 s48, s48, 7
    s_add_u32 s6, s48, 12320768
    s_lshl1_add_u32 s48, s47, s55
    s_lshl1_add_u32 s48, s48, s53
    s_lshl_b32 s48, s48, 15
    s_lshl1_add_u32 s49, s56, s64
    s_lshl_b32 s49, s49, 6
    s_add_u32 s5, s48, s49
    v_lshlrev_b32 v8, 9, v21
    v_and_b32 v8, 0x200, v8
    v_sub_u32 v7, v7, v8
    v_xor_b32 v8, 64, v7
    v_add_u32 v9, 0x10000, v7
    v_add_u32 v10, 0x10000, v8
    v_mov_b32 v11, 161792
    s_lshl1_add_u32 s48, s47, s55
    s_lshl1_add_u32 s48, s48, s52
    s_lshl3_add_u32 s48, s48, s51
    s_lshl_b32 s48, s48, 7
    s_add_u32 s48, s48, 12189696
    s_lshl_b32 s49, s53, 6
    s_add_u32 s49, s49, s71
    s_buffer_load_dword s7, s[24:27], s49 glc
    s_buffer_load_dword s7, s[24:27], s6 glc
    s_buffer_load_dword s7, s[24:27], s48 glc
    s_buffer_load_dword s7, s[24:27], s4 offset:3064 glc
    s_waitcnt vmcnt(8)
    s_barrier
    s_add_u32 m0, s41, 65536
    s_add_u32 s62, s37, 1181696
    buffer_load_dwordx4 v4, s[12:15], s62 offen lds
    s_add_u32 m0, s41, 66560
    s_add_u32 s62, s37, 1206272
    buffer_load_dwordx4 v16, s[12:15], s62 offen lds
    s_add_u32 m0, s40, 98304
    s_add_u32 s46, s36, 896
    buffer_load_dwordx4 v2, s[8:11], s46 offen lds
    s_add_u32 m0, s40, 99328
    s_nop 0
    buffer_load_dwordx4 v3, s[8:11], s46 offen lds
    s_add_u32 m0, s40, 100352
    s_add_u32 s46, s36, 17280
    buffer_load_dwordx4 v2, s[8:11], s46 offen lds
    s_add_u32 m0, s40, 101376
    s_nop 0
    buffer_load_dwordx4 v3, s[8:11], s46 offen lds
    s_add_u32 m0, s41, 98304
    s_add_u32 s62, s37, 1376256
    buffer_load_dwordx4 v4, s[12:15], s62 offen lds
    s_add_u32 m0, s41, 99328
    s_add_u32 s62, s37, 1400832
    buffer_load_dwordx4 v16, s[12:15], s62 offen lds
    s_add_u32 m0, s41, 106496
    s_add_u32 s62, s37, 1377280
    buffer_load_dwordx4 v4, s[12:15], s62 offen lds
    s_add_u32 m0, s41, 107520
    s_add_u32 s62, s37, 1401856
    buffer_load_dwordx4 v16, s[12:15], s62 offen lds
    s_waitcnt vmcnt(8)
    s_barrier
    s_lshl2_add_u32 s48, s47, s100
    s_lshl_b32 s48, s48, 9
    s_add_u32 s48, s48, 11599872
    s_lshl_b32 s49, s100, 9
    s_add_u32 m0, s49, 157696
    s_mov_b32 exec_hi, 0
    buffer_load_dwordx4 v6, s[24:27], s48 offen sc1 lds
    s_mov_b32 exec_hi, -1
    buffer_load_dwordx2 v[84:85], v14, s[24:27], s42 offen offset:0 sc1
    buffer_load_dwordx2 v[86:87], v14, s[24:27], s42 offen offset:512 sc1
    buffer_load_dwordx2 v[88:89], v14, s[24:27], s42 offen offset:1024 sc1
    buffer_load_dwordx2 v[90:91], v14, s[24:27], s42 offen offset:1536 sc1
    s_add_u32 m0, s41, 114688
    s_add_u32 s62, s37, 1378304
    buffer_load_dwordx4 v4, s[12:15], s62 offen lds
    s_add_u32 m0, s41, 115712
    s_add_u32 s62, s37, 1402880
    buffer_load_dwordx4 v16, s[12:15], s62 offen lds
    s_add_u32 m0, s58, 0
    s_add_u32 s62, s57, 0
    buffer_load_dwordx4 v5, s[16:19], s62 offen lds
    s_add_u32 m0, s58, 4096
    s_add_u32 s62, s57, 131072
    buffer_load_dwordx4 v5, s[16:19], s62 offen lds
    s_add_u32 m0, s58, 8192
    s_add_u32 s62, s57, 229376
    buffer_load_dwordx4 v5, s[16:19], s62 offen lds
    s_add_u32 m0, s58, 12288
    s_add_u32 s62, s57, 360448
    buffer_load_dwordx4 v5, s[16:19], s62 offen lds
    s_add_u32 m0, s58, 16384
    s_add_u32 s62, s57, 458752
    buffer_load_dwordx4 v5, s[16:19], s62 offen lds
    s_add_u32 m0, s58, 20480
    s_add_u32 s62, s57, 589824
    buffer_load_dwordx4 v5, s[16:19], s62 offen lds
    s_add_u32 m0, s58, 24576
    s_add_u32 s62, s57, 688128
    buffer_load_dwordx4 v5, s[16:19], s62 offen lds
    s_add_u32 m0, s58, 28672
    s_add_u32 s62, s57, 819200
    buffer_load_dwordx4 v5, s[16:19], s62 offen lds
    s_waitcnt vmcnt(8)
    s_barrier
    s_waitcnt vmcnt(10)
    v_xor_b32 v39, s60, v85
    v_xor_b32 v38, s60, v87
    v_or_b32 v39, v39, v38
    v_xor_b32 v38, s60, v89
    v_or_b32 v39, v39, v38
    v_xor_b32 v38, s60, v91
    v_or_b32 v39, v39, v38
    v_cmp_ne_u32 vcc, 0, v39
    s_cbranch_vccnz SL_15
SE_16:
    v_add_f32 v84, v84, v86
    v_add_f32 v88, v88, v90
    v_add_f32 v84, v84, v88
    v_cvt_pk_bf16_f32 v85, v84, v84
    v_lshlrev_b32 v85, 16, v85
    v_sub_f32 v85, v84, v85
    v_cvt_pk_bf16_f32 v84, v84, v85
    ds_write_b32 v15, v84
    s_add_u32 m0, s58, 32768
    s_add_u32 s62, s57, 32768
    buffer_load_dwordx4 v5, s[16:19], s62 offen lds
    s_add_u32 m0, s58, 36864
    s_add_u32 s62, s57, 163840
    buffer_load_dwordx4 v5, s[16:19], s62 offen lds
    s_add_u32 m0, s58, 40960
    s_add_u32 s62, s57, 262144
    buffer_load_dwordx4 v5, s[16:19], s62 offen lds
    s_add_u32 m0, s58, 45056
    s_add_u32 s62, s57, 393216
    buffer_load_dwordx4 v5, s[16:19], s62 offen lds
    s_add_u32 m0, s58, 49152
    s_add_u32 s62, s57, 491520
    buffer_load_dwordx4 v5, s[16:19], s62 offen lds
    s_add_u32 m0, s58, 53248
    s_add_u32 s62, s57, 622592
    buffer_load_dwordx4 v5, s[16:19], s62 offen lds
    s_add_u32 m0, s58, 57344
    s_add_u32 s62, s57, 720896
    buffer_load_dwordx4 v5, s[16:19], s62 offen lds
    s_add_u32 m0, s58, 61440
    s_add_u32 s62, s57, 851968
    buffer_load_dwordx4 v5, s[16:19], s62 offen lds
    s_add_u32 m0, s58, 65536
    s_add_u32 s62, s57, 65536
    buffer_load_dwordx4 v5, s[16:19], s62 offen lds
    s_add_u32 m0, s58, 69632
    s_add_u32 s62, s57, 196608
    buffer_load_dwordx4 v5, s[16:19], s62 offen lds
    s_waitcnt lgkmcnt(0)
L_PH2H:
    s_barrier
    s_setprio 3
    s_waitcnt vmcnt(15)
    s_add_u32 m0, s58, 73728
    s_add_u32 s62, s57, 294912
    buffer_load_dwordx4 v5, s[16:19], s62 offen lds
    s_waitcnt vmcnt(15)
    s_add_u32 m0, s58, 77824
    s_add_u32 s62, s57, 425984
    buffer_load_dwordx4 v5, s[16:19], s62 offen lds
    s_waitcnt vmcnt(15)
    s_add_u32 m0, s58, 81920
    s_add_u32 s62, s57, 524288
    buffer_load_dwordx4 v5, s[16:19], s62 offen lds
    s_waitcnt vmcnt(15)
    s_add_u32 m0, s58, 86016
    s_add_u32 s62, s57, 655360
    buffer_load_dwordx4 v5, s[16:19], s62 offen lds
    s_waitcnt vmcnt(10)
    v_mov_b32 v38, 161792
    v_mov_b32 v39, 1
    s_mov_b64 exec, 1
    ds_add_u32 v38, v39
    s_mov_b32 s65, 0
LS_17:
    ds_read_b32 v39, v38
    s_add_u32 s65, s65, 1
    s_waitcnt lgkmcnt(0)
    v_readfirstlane_b32 s48, v39
    s_cmp_gt_u32 s65, SPIN_MAX
    s_cbranch_scc1 LSE_18
    s_cmp_lt_u32 s48, 4
    s_cbranch_scc1 LS_17
LSE_18:
    s_mov_b64 exec, -1
    ds_read_b64_tr_b16 v[128:129], v7 offset:0
    ds_read_b64_tr_b16 v[130:131], v7 offset:2048
    ds_read_b64_tr_b16 v[132:133], v8 offset:0
    ds_read_b64_tr_b16 v[134:135], v8 offset:2048
    ds_read_b64_tr_b16 v[136:137], v7 offset:1024
    ds_read_b64_tr_b16 v[138:139], v7 offset:3072
    ds_read_b64_tr_b16 v[140:141], v8 offset:1024
    ds_read_b64_tr_b16 v[142:143], v8 offset:3072
    ds_read_b64_tr_b16 v[144:145], v7 offset:4096
    ds_read_b64_tr_b16 v[146:147], v7 offset:6144
    ds_read_b64_tr_b16 v[148:149], v8 offset:4096
    ds_read_b64_tr_b16 v[150:151], v8 offset:6144
    s_waitcnt lgkmcnt(8)
    ds_read_b64_tr_b16 v[152:153], v7 offset:5120
    ds_read_b64_tr_b16 v[154:155], v7 offset:7168
    ds_read_b64_tr_b16 v[156:157], v8 offset:5120
    ds_read_b64_tr_b16 v[158:159], v8 offset:7168
    s_waitcnt vmcnt(15)
    s_add_u32 m0, s58, 90112
    s_add_u32 s62, s57, 753664
    buffer_load_dwordx4 v5, s[16:19], s62 offen lds
    s_waitcnt vmcnt(15)
    s_add_u32 m0, s58, 94208
    s_add_u32 s62, s57, 884736
    buffer_load_dwordx4 v5, s[16:19], s62 offen lds
    s_waitcnt vmcnt(15)
    s_add_u32 m0, s58, 98304
    s_add_u32 s62, s57, 98304
    buffer_load_dwordx4 v5, s[16:19], s62 offen lds
    s_waitcnt vmcnt(15)
    s_add_u32 m0, s58, 102400
    s_add_u32 s62, s57, 327680
    buffer_load_dwordx4 v5, s[16:19], s62 offen lds
    s_waitcnt lgkmcnt(0)
    ds_read_b64_tr_b16 v[160:161], v7 offset:8192
    ds_read_b64_tr_b16 v[162:163], v7 offset:10240
    ds_read_b64_tr_b16 v[164:165], v8 offset:8192
    ds_read_b64_tr_b16 v[166:167], v8 offset:10240
    ds_read_b64_tr_b16 v[168:169], v7 offset:9216
    ds_read_b64_tr_b16 v[170:171], v7 offset:11264
    ds_read_b64_tr_b16 v[172:173], v8 offset:9216
    ds_read_b64_tr_b16 v[174:175], v8 offset:11264
    ds_read_b64_tr_b16 v[176:177], v7 offset:12288
    ds_read_b64_tr_b16 v[178:179], v7 offset:14336
    ds_read_b64_tr_b16 v[180:181], v8 offset:12288
    ds_read_b64_tr_b16 v[182:183], v8 offset:14336
    s_waitcnt lgkmcnt(8)
    ds_read_b64_tr_b16 v[184:185], v7 offset:13312
    ds_read_b64_tr_b16 v[186:187], v7 offset:15360
    ds_read_b64_tr_b16 v[188:189], v8 offset:13312
    ds_read_b64_tr_b16 v[190:191], v8 offset:15360
    s_waitcnt vmcnt(15)
    s_add_u32 m0, s58, 106496
    s_add_u32 s62, s57, 557056
    buffer_load_dwordx4 v5, s[16:19], s62 offen lds
    s_waitcnt vmcnt(15)
    s_add_u32 m0, s58, 110592
    s_add_u32 s62, s57, 786432
    buffer_load_dwordx4 v5, s[16:19], s62 offen lds
    s_waitcnt vmcnt(15)
    s_add_u32 m0, s58, 114688
    s_add_u32 s62, s59, 0
    buffer_load_dwordx4 v5, s[20:23], s62 offen lds
    s_waitcnt vmcnt(15)
    s_add_u32 m0, s58, 118784
    s_add_u32 s62, s59, 32768
    buffer_load_dwordx4 v5, s[20:23], s62 offen lds
    s_waitcnt lgkmcnt(0)
    ds_read_b64_tr_b16 v[192:193], v7 offset:16384
    ds_read_b64_tr_b16 v[194:195], v7 offset:18432
    ds_read_b64_tr_b16 v[196:197], v8 offset:16384
    ds_read_b64_tr_b16 v[198:199], v8 offset:18432
    ds_read_b64_tr_b16 v[200:201], v7 offset:17408
    ds_read_b64_tr_b16 v[202:203], v7 offset:19456
    ds_read_b64_tr_b16 v[204:205], v8 offset:17408
    ds_read_b64_tr_b16 v[206:207], v8 offset:19456
    ds_read_b64_tr_b16 v[208:209], v7 offset:20480
    ds_read_b64_tr_b16 v[210:211], v7 offset:22528
    ds_read_b64_tr_b16 v[212:213], v8 offset:20480
    ds_read_b64_tr_b16 v[214:215], v8 offset:22528
    s_waitcnt lgkmcnt(8)
    ds_read_b64_tr_b16 v[216:217], v7 offset:21504
    ds_read_b64_tr_b16 v[218:219], v7 offset:23552
    ds_read_b64_tr_b16 v[220:221], v8 offset:21504
    ds_read_b64_tr_b16 v[222:223], v8 offset:23552
    s_waitcnt vmcnt(15)
    s_add_u32 m0, s58, 122880
    s_add_u32 s62, s59, 65536
    buffer_load_dwordx4 v5, s[20:23], s62 offen lds
    s_waitcnt vmcnt(15)
    s_add_u32 m0, s58, 126976
    s_add_u32 s62, s59, 98304
    buffer_load_dwordx4 v5, s[20:23], s62 offen lds
    s_waitcnt vmcnt(15)
    s_add_u32 m0, s58, 131072
    s_add_u32 s62, s59, 131072
    buffer_load_dwordx4 v5, s[20:23], s62 offen lds
    s_waitcnt vmcnt(15)
    s_add_u32 m0, s58, 135168
    s_add_u32 s62, s59, 163840
    buffer_load_dwordx4 v5, s[20:23], s62 offen lds
    s_waitcnt lgkmcnt(0)
    ds_read_b64_tr_b16 v[224:225], v7 offset:24576
    ds_read_b64_tr_b16 v[226:227], v7 offset:26624
    ds_read_b64_tr_b16 v[228:229], v8 offset:24576
    ds_read_b64_tr_b16 v[230:231], v8 offset:26624
    ds_read_b64_tr_b16 v[232:233], v7 offset:25600
    ds_read_b64_tr_b16 v[234:235], v7 offset:27648
    ds_read_b64_tr_b16 v[236:237], v8 offset:25600
    ds_read_b64_tr_b16 v[238:239], v8 offset:27648
    ds_read_b64_tr_b16 v[240:241], v7 offset:28672
    ds_read_b64_tr_b16 v[242:243], v7 offset:30720
    ds_read_b64_tr_b16 v[244:245], v8 offset:28672
    ds_read_b64_tr_b16 v[246:247], v8 offset:30720
    s_waitcnt lgkmcnt(8)
    ds_read_b64_tr_b16 v[248:249], v7 offset:29696
    ds_read_b64_tr_b16 v[250:251], v7 offset:31744
    ds_read_b64_tr_b16 v[252:253], v8 offset:29696
    ds_read_b64_tr_b16 v[254:255], v8 offset:31744
    s_waitcnt vmcnt(15)
    s_add_u32 m0, s58, 139264
    s_add_u32 s62, s59, 196608
    buffer_load_dwordx4 v5, s[20:23], s62 offen lds
    s_waitcnt vmcnt(15)
    s_add_u32 m0, s58, 143360
    s_add_u32 s62, s59, 229376
    buffer_load_dwordx4 v5, s[20:23], s62 offen lds
    s_waitcnt lgkmcnt(0)
    v_mov_b32 v38, 161792
    v_mov_b32 v39, 1
    s_mov_b64 exec, 1
    ds_add_u32 v38, v39
    s_mov_b32 s65, 0
LS_19:
    ds_read_b32 v39, v38
    s_add_u32 s65, s65, 1
    s_waitcnt lgkmcnt(0)
    v_readfirstlane_b32 s48, v39
    s_cmp_gt_u32 s65, SPIN_MAX
    s_cbranch_scc1 LSE_20
    s_cmp_lt_u32 s48, 8
    s_cbranch_scc1 LS_19
LSE_20:
    s_mov_b64 exec, -1
    s_waitcnt vmcnt(15)
    s_add_u32 m0, s58, 0
    s_add_u32 s62, s59, 262144
    buffer_load_dwordx4 v5, s[20:23], s62 offen lds
    s_waitcnt vmcnt(15)
    s_add_u32 m0, s58, 4096
    s_add_u32 s62, s59, 294912
    buffer_load_dwordx4 v5, s[20:23], s62 offen lds
    s_waitcnt vmcnt(15)
    s_add_u32 m0, s58, 8192
    s_add_u32 s62, s59, 327680
    buffer_load_dwordx4 v5, s[20:23], s62 offen lds
    s_waitcnt vmcnt(15)
    s_add_u32 m0, s58, 12288
    s_add_u32 s62, s59, 360448
    buffer_load_dwordx4 v5, s[20:23], s62 offen lds
    s_waitcnt vmcnt(15)
    s_add_u32 m0, s58, 16384
    s_add_u32 s62, s59, 393216
    buffer_load_dwordx4 v5, s[20:23], s62 offen lds
    s_waitcnt vmcnt(15)
    s_add_u32 m0, s58, 20480
    s_add_u32 s62, s59, 425984
    buffer_load_dwordx4 v5, s[20:23], s62 offen lds
    s_waitcnt vmcnt(15)
    s_add_u32 m0, s58, 24576
    s_add_u32 s62, s59, 458752
    buffer_load_dwordx4 v5, s[20:23], s62 offen lds
    s_waitcnt vmcnt(15)
    s_add_u32 m0, s58, 28672
    s_add_u32 s62, s59, 491520
    buffer_load_dwordx4 v5, s[20:23], s62 offen lds
WMS_21:
SEG_S1_0:
    s_cbranch_execz PAD_S0_1
    s_mov_b32 s20, s60
    s_mov_b32 s21, s60
    s_buffer_load_dwordx8 s[12:19], s[24:27], s71 offset:0 glc
    s_waitcnt vmcnt(0)
    v_mov_b32 v12, 1
    s_mov_b64 exec, 1
    ds_add_u32 v11, v12 offset:4
    s_mov_b64 exec, -1
    s_waitcnt lgkmcnt(0)
    s_xor_b64 vcc, s[12:13], s[20:21]
    s_xor_b64 s[22:23], s[14:15], s[20:21]
    s_or_b64 vcc, vcc, s[22:23]
    s_xor_b64 s[22:23], s[16:17], s[20:21]
    s_or_b64 vcc, vcc, s[22:23]
    s_xor_b64 s[22:23], s[18:19], s[20:21]
    s_or_b64 vcc, vcc, s[22:23]
    s_cbranch_vccnz SL_22
SE_23:
    s_setprio 2
    buffer_load_dwordx4 v[64:67], v6, s[24:27], s63 offen offset:0 sc1
    buffer_load_dwordx4 v[68:71], v6, s[24:27], s63 offen offset:1024 sc1
    buffer_load_dwordx4 v[72:75], v6, s[24:27], s63 offen offset:2048 sc1
    buffer_load_dwordx4 v[76:79], v6, s[24:27], s63 offen offset:3072 sc1
    s_mov_b64 s[12:13], 0
    s_mov_b64 s[14:15], 0
    s_mov_b64 s[16:17], 0
    s_mov_b64 s[18:19], 0
    s_buffer_load_dwordx8 s[12:19], s[24:27], s71 offset:32 glc
    s_add_u32 s63, s63, 4096
    buffer_load_dwordx4 v[80:83], v6, s[24:27], s63 offen offset:0 sc1
    buffer_load_dwordx4 v[84:87], v6, s[24:27], s63 offen offset:1024 sc1
    buffer_load_dwordx4 v[88:91], v6, s[24:27], s63 offen offset:2048 sc1
    buffer_load_dwordx4 v[92:95], v6, s[24:27], s63 offen offset:3072 sc1
    s_add_u32 s63, s63, 4096
    buffer_load_dwordx4 v[96:99], v6, s[24:27], s63 offen offset:0 sc1
    buffer_load_dwordx4 v[100:103], v6, s[24:27], s63 offen offset:1024 sc1
    buffer_load_dwordx4 v[104:107], v6, s[24:27], s63 offen offset:2048 sc1
PAD_S0_1:
    s_cbranch_execz RET1_S
    buffer_load_dwordx4 v[108:111], v6, s[24:27], s63 offen offset:3072 sc1
    s_waitcnt vmcnt(11)
    v_mfma_f32_32x32x16_bf16 v[16:31], v[128:131], v[64:67], 0
    v_mfma_f32_32x32x16_bf16 v[32:47], v[132:135], v[64:67], 0
    s_add_u32 s63, s63, 4096
    buffer_load_dwordx4 v[112:115], v6, s[24:27], s63 offen offset:0 sc1
    s_waitcnt vmcnt(11)
    v_mfma_f32_32x32x16_bf16 v[16:31], v[136:139], v[68:71], v[16:31]
    v_mfma_f32_32x32x16_bf16 v[32:47], v[140:143], v[68:71], v[32:47]
    buffer_load_dwordx4 v[116:119], v6, s[24:27], s63 offen offset:1024 sc1
    s_waitcnt vmcnt(11)
    v_mfma_f32_32x32x16_bf16 v[16:31], v[144:147], v[72:75], v[16:31]
    v_mfma_f32_32x32x16_bf16 v[32:47], v[148:151], v[72:75], v[32:47]
    buffer_load_dwordx4 v[120:123], v6, s[24:27], s63 offen offset:2048 sc1
    s_waitcnt vmcnt(11)
    v_mfma_f32_32x32x16_bf16 v[16:31], v[152:155], v[76:79], v[16:31]
    v_mfma_f32_32x32x16_bf16 v[32:47], v[156:159], v[76:79], v[32:47]
    buffer_load_dwordx4 v[124:127], v6, s[24:27], s63 offen offset:3072 sc1
    s_waitcnt vmcnt(11)
    v_mfma_f32_32x32x16_bf16 v[16:31], v[160:163], v[80:83], v[16:31]
    v_mfma_f32_32x32x16_bf16 v[32:47], v[164:167], v[80:83], v[32:47]
    s_xor_b64 vcc, s[12:13], s[20:21]
    s_xor_b64 s[22:23], s[14:15], s[20:21]
    s_or_b64 vcc, vcc, s[22:23]
    s_xor_b64 s[22:23], s[16:17], s[20:21]
    s_or_b64 vcc, vcc, s[22:23]
    s_xor_b64 s[22:23], s[18:19], s[20:21]
    s_or_b64 vcc, vcc, s[22:23]
    s_cbranch_vccnz SL_24
SE_25:
    s_add_u32 s63, s63, 4096
    buffer_load_dwordx4 v[64:67], v6, s[24:27], s63 offen offset:0 sc1
    s_waitcnt vmcnt(11)
    v_mfma_f32_32x32x16_bf16 v[16:31], v[168:171], v[84:87], v[16:31]
    v_mfma_f32_32x32x16_bf16 v[32:47], v[172:175], v[84:87], v[32:47]
    buffer_load_dwordx4 v[68:71], v6, s[24:27], s63 offen offset:1024 sc1
    s_waitcnt vmcnt(11)
    v_mfma_f32_32x32x16_bf16 v[16:31], v[176:179], v[88:91], v[16:31]
    v_mfma_f32_32x32x16_bf16 v[32:47], v[180:183], v[88:91], v[32:47]
    buffer_load_dwordx4 v[72:75], v6, s[24:27], s63 offen offset:2048 sc1
SEG_S1_1:
    s_cbranch_execz PAD_S1_1
    s_waitcnt vmcnt(11)
    v_mfma_f32_32x32x16_bf16 v[16:31], v[184:187], v[92:95], v[16:31]
    v_mfma_f32_32x32x16_bf16 v[32:47], v[188:191], v[92:95], v[32:47]
    buffer_load_dwordx4 v[76:79], v6, s[24:27], s63 offen offset:3072 sc1
    s_waitcnt vmcnt(11)
WMN_26:
    v_mfma_f32_32x32x16_bf16 v[16:31], v[192:195], v[96:99], v[16:31]
    v_mfma_f32_32x32x16_bf16 v[32:47], v[196:199], v[96:99], v[32:47]
    s_add_u32 s63, s63, 4096
    buffer_load_dwordx4 v[80:83], v6, s[24:27], s63 offen offset:0 sc1
    s_waitcnt vmcnt(11)
    v_mfma_f32_32x32x16_bf16 v[16:31], v[200:203], v[100:103], v[16:31]
    v_mfma_f32_32x32x16_bf16 v[32:47], v[204:207], v[100:103], v[32:47]
    buffer_load_dwordx4 v[84:87], v6, s[24:27], s63 offen offset:1024 sc1
    s_waitcnt vmcnt(11)
    v_mfma_f32_32x32x16_bf16 v[16:31], v[208:211], v[104:107], v[16:31]
    v_mfma_f32_32x32x16_bf16 v[32:47], v[212:215], v[104:107], v[32:47]
    buffer_load_dwordx4 v[88:91], v6, s[24:27], s63 offen offset:2048 sc1
    s_waitcnt vmcnt(11)
    v_mfma_f32_32x32x16_bf16 v[16:31], v[216:219], v[108:111], v[16:31]
    s_mov_b64 s[12:13], 0
    s_mov_b64 s[14:15], 0
    s_mov_b64 s[16:17], 0
    s_mov_b64 s[18:19], 0
    s_buffer_load_dwordx8 s[12:19], s[24:27], s71 offset:64 glc
    v_mfma_f32_32x32x16_bf16 v[32:47], v[220:223], v[108:111], v[32:47]
    buffer_load_dwordx4 v[92:95], v6, s[24:27], s63 offen offset:3072 sc1
    s_waitcnt vmcnt(11)
    v_mfma_f32_32x32x16_bf16 v[16:31], v[224:227], v[112:115], v[16:31]
    v_mfma_f32_32x32x16_bf16 v[32:47], v[228:231], v[112:115], v[32:47]
    s_add_u32 s63, s63, 4096
    buffer_load_dwordx4 v[96:99], v6, s[24:27], s63 offen offset:0 sc1
    s_waitcnt vmcnt(11)
    v_mfma_f32_32x32x16_bf16 v[16:31], v[232:235], v[116:119], v[16:31]
    v_mfma_f32_32x32x16_bf16 v[32:47], v[236:239], v[116:119], v[32:47]
    buffer_load_dwordx4 v[100:103], v6, s[24:27], s63 offen offset:1024 sc1
    s_waitcnt vmcnt(11)
    v_mfma_f32_32x32x16_bf16 v[16:31], v[240:243], v[120:123], v[16:31]
    ds_read_b64_tr_b16 v[128:129], v7 offset:32768
    ds_read_b64_tr_b16 v[130:131], v7 offset:34816
    v_mfma_f32_32x32x16_bf16 v[32:47], v[244:247], v[120:123], v[32:47]
    ds_read_b64_tr_b16 v[132:133], v8 offset:32768
    ds_read_b64_tr_b16 v[134:135], v8 offset:34816
    buffer_load_dwordx4 v[104:107], v6, s[24:27], s63 offen offset:2048 sc1
    s_waitcnt vmcnt(11)
    v_mfma_f32_32x32x16_bf16 v[16:31], v[248:251], v[124:127], v[16:31]
    ds_read_b64_tr_b16 v[136:137], v7 offset:33792
    ds_read_b64_tr_b16 v[138:139], v7 offset:35840
    v_mfma_f32_32x32x16_bf16 v[32:47], v[252:255], v[124:127], v[32:47]
    ds_read_b64_tr_b16 v[140:141], v8 offset:33792
    ds_read_b64_tr_b16 v[142:143], v8 offset:35840
    buffer_load_dwordx4 v[108:111], v6, s[24:27], s63 offen offset:3072 sc1
    s_waitcnt vmcnt(11)
    s_waitcnt lgkmcnt(4)
    v_mfma_f32_32x32x16_bf16 v[16:31], v[128:131], v[64:67], v[16:31]
    ds_read_b64_tr_b16 v[144:145], v7 offset:36864
    ds_read_b64_tr_b16 v[146:147], v7 offset:38912
    v_mfma_f32_32x32x16_bf16 v[32:47], v[132:135], v[64:67], v[32:47]
    ds_read_b64_tr_b16 v[148:149], v8 offset:36864
    ds_read_b64_tr_b16 v[150:151], v8 offset:38912
    s_add_u32 s63, s63, 4096
    buffer_load_dwordx4 v[112:115], v6, s[24:27], s63 offen offset:0 sc1
    s_waitcnt vmcnt(11)
    s_waitcnt lgkmcnt(4)
    v_mfma_f32_32x32x16_bf16 v[16:31], v[136:139], v[68:71], v[16:31]
    ds_read_b64_tr_b16 v[152:153], v7 offset:37888
    ds_read_b64_tr_b16 v[154:155], v7 offset:39936
    v_mfma_f32_32x32x16_bf16 v[32:47], v[140:143], v[68:71], v[32:47]
    ds_read_b64_tr_b16 v[156:157], v8 offset:37888
    ds_read_b64_tr_b16 v[158:159], v8 offset:39936
    buffer_load_dwordx4 v[116:119], v6, s[24:27], s63 offen offset:1024 sc1
    s_waitcnt vmcnt(11)
    s_waitcnt lgkmcnt(4)
    v_mfma_f32_32x32x16_bf16 v[16:31], v[144:147], v[72:75], v[16:31]
    ds_read_b64_tr_b16 v[128:129], v7 offset:40960
    ds_read_b64_tr_b16 v[130:131], v7 offset:43008
    ds_read_b32 v13, v11 offset:4
    v_mfma_f32_32x32x16_bf16 v[32:47], v[148:151], v[72:75], v[32:47]
    ds_read_b64_tr_b16 v[132:133], v8 offset:40960
    ds_read_b64_tr_b16 v[134:135], v8 offset:43008
    buffer_load_dwordx4 v[120:123], v6, s[24:27], s63 offen offset:2048 sc1
    s_waitcnt vmcnt(11)
    s_waitcnt lgkmcnt(5)
    v_mfma_f32_32x32x16_bf16 v[16:31], v[152:155], v[76:79], v[16:31]
    ds_read_b64_tr_b16 v[136:137], v7 offset:41984
    ds_read_b64_tr_b16 v[138:139], v7 offset:44032
    v_mfma_f32_32x32x16_bf16 v[32:47], v[156:159], v[76:79], v[32:47]
    ds_read_b64_tr_b16 v[140:141], v8 offset:41984
    ds_read_b64_tr_b16 v[142:143], v8 offset:44032
    buffer_load_dwordx4 v[124:127], v6, s[24:27], s63 offen offset:3072 sc1
    s_waitcnt vmcnt(11)
    s_waitcnt lgkmcnt(4)
    v_mfma_f32_32x32x16_bf16 v[16:31], v[128:131], v[80:83], v[16:31]
    ds_read_b64_tr_b16 v[144:145], v7 offset:45056
    ds_read_b64_tr_b16 v[146:147], v7 offset:47104
    v_mfma_f32_32x32x16_bf16 v[32:47], v[132:135], v[80:83], v[32:47]
    ds_read_b64_tr_b16 v[148:149], v8 offset:45056
    ds_read_b64_tr_b16 v[150:151], v8 offset:47104
    s_xor_b64 vcc, s[12:13], s[20:21]
    s_xor_b64 s[22:23], s[14:15], s[20:21]
    s_or_b64 vcc, vcc, s[22:23]
    s_xor_b64 s[22:23], s[16:17], s[20:21]
    s_or_b64 vcc, vcc, s[22:23]
    s_xor_b64 s[22:23], s[18:19], s[20:21]
    s_or_b64 vcc, vcc, s[22:23]
    s_cbranch_vccnz SL_27
SE_28:
    s_add_u32 s63, s63, 4096
    buffer_load_dwordx4 v[64:67], v6, s[24:27], s63 offen offset:0 sc1
    s_waitcnt vmcnt(11)
    s_waitcnt lgkmcnt(4)
    v_mfma_f32_32x32x16_bf16 v[16:31], v[136:139], v[84:87], v[16:31]
    ds_read_b64_tr_b16 v[152:153], v7 offset:46080
    ds_read_b64_tr_b16 v[154:155], v7 offset:48128
    v_mfma_f32_32x32x16_bf16 v[32:47], v[140:143], v[84:87], v[32:47]
    ds_read_b64_tr_b16 v[156:157], v8 offset:46080
    ds_read_b64_tr_b16 v[158:159], v8 offset:48128
    v_cmp_gt_u32 vcc, 4, v13
    s_cbranch_vccnz SL_29
SE_30:
    buffer_load_dwordx4 v[68:71], v6, s[24:27], s63 offen offset:1024 sc1
    s_waitcnt vmcnt(11)
    s_waitcnt lgkmcnt(4)
    v_mfma_f32_32x32x16_bf16 v[16:31], v[144:147], v[88:91], v[16:31]
    ds_read_b64_tr_b16 v[128:129], v7 offset:49152
    ds_read_b64_tr_b16 v[130:131], v7 offset:51200
    v_mfma_f32_32x32x16_bf16 v[32:47], v[148:151], v[88:91], v[32:47]
    ds_read_b64_tr_b16 v[132:133], v8 offset:49152
    ds_read_b64_tr_b16 v[134:135], v8 offset:51200
    buffer_load_dwordx4 v[72:75], v6, s[24:27], s63 offen offset:2048 sc1
    s_waitcnt vmcnt(11)
    s_waitcnt lgkmcnt(4)
    v_mfma_f32_32x32x16_bf16 v[16:31], v[152:155], v[92:95], v[16:31]
    ds_read_b64_tr_b16 v[136:137], v7 offset:50176
    ds_read_b64_tr_b16 v[138:139], v7 offset:52224
    v_mfma_f32_32x32x16_bf16 v[32:47], v[156:159], v[92:95], v[32:47]
    ds_read_b64_tr_b16 v[140:141], v8 offset:50176
    ds_read_b64_tr_b16 v[142:143], v8 offset:52224
    buffer_load_dwordx4 v[76:79], v6, s[24:27], s63 offen offset:3072 sc1
    s_waitcnt vmcnt(11)
    s_waitcnt lgkmcnt(4)
    v_mfma_f32_32x32x16_bf16 v[16:31], v[128:131], v[96:99], v[16:31]
    ds_read_b64_tr_b16 v[144:145], v7 offset:53248
    ds_read_b64_tr_b16 v[146:147], v7 offset:55296
    v_mov_b32 v195, s60
    v_mfma_f32_32x32x16_bf16 v[32:47], v[132:135], v[96:99], v[32:47]
    ds_read_b64_tr_b16 v[148:149], v8 offset:53248
    ds_read_b64_tr_b16 v[150:151], v8 offset:55296
    s_add_u32 s63, s63, 4096
    buffer_load_dwordx4 v[80:83], v6, s[24:27], s63 offen offset:0 sc1
    s_waitcnt vmcnt(11)
    s_waitcnt lgkmcnt(4)
    v_mfma_f32_32x32x16_bf16 v[16:31], v[136:139], v[100:103], v[16:31]
    ds_read_b64_tr_b16 v[152:153], v7 offset:54272
    ds_read_b64_tr_b16 v[154:155], v7 offset:56320
    v_mov_b32 v199, s60
    v_mfma_f32_32x32x16_bf16 v[32:47], v[140:143], v[100:103], v[32:47]
    ds_read_b64_tr_b16 v[156:157], v8 offset:54272
    ds_read_b64_tr_b16 v[158:159], v8 offset:56320
    buffer_load_dwordx4 v[84:87], v6, s[24:27], s63 offen offset:1024 sc1
    s_waitcnt vmcnt(11)
    s_waitcnt lgkmcnt(4)
    v_mfma_f32_32x32x16_bf16 v[16:31], v[144:147], v[104:107], v[16:31]
    ds_read_b64_tr_b16 v[128:129], v7 offset:57344
    ds_read_b64_tr_b16 v[130:131], v7 offset:59392
    v_mov_b32 v203, s60
    v_mfma_f32_32x32x16_bf16 v[32:47], v[148:151], v[104:107], v[32:47]
    ds_read_b64_tr_b16 v[132:133], v8 offset:57344
    ds_read_b64_tr_b16 v[134:135], v8 offset:59392
    buffer_load_dwordx4 v[88:91], v6, s[24:27], s63 offen offset:2048 sc1
    s_waitcnt vmcnt(11)
    s_waitcnt lgkmcnt(4)
    v_mfma_f32_32x32x16_bf16 v[16:31], v[152:155], v[108:111], v[16:31]
    ds_read_b64_tr_b16 v[136:137], v7 offset:58368
    ds_read_b64_tr_b16 v[138:139], v7 offset:60416
    s_mov_b64 s[12:13], 0
    s_mov_b64 s[14:15], 0
    s_mov_b64 s[16:17], 0
    s_mov_b64 s[18:19], 0
    s_buffer_load_dwordx8 s[12:19], s[24:27], s71 offset:96 glc
    v_mov_b32 v207, s60
    v_mfma_f32_32x32x16_bf16 v[32:47], v[156:159], v[108:111], v[32:47]
    ds_read_b64_tr_b16 v[140:141], v8 offset:58368
    ds_read_b64_tr_b16 v[142:143], v8 offset:60416
    buffer_load_dwordx4 v[92:95], v6, s[24:27], s63 offen offset:3072 sc1
    s_waitcnt vmcnt(11)
    s_waitcnt lgkmcnt(4)
    v_mfma_f32_32x32x16_bf16 v[16:31], v[128:131], v[112:115], v[16:31]
    ds_read_b64_tr_b16 v[144:145], v7 offset:61440
    ds_read_b64_tr_b16 v[146:147], v7 offset:63488
    v_mov_b32 v211, s60
    v_mfma_f32_32x32x16_bf16 v[32:47], v[132:135], v[112:115], v[32:47]
    ds_read_b64_tr_b16 v[148:149], v8 offset:61440
    ds_read_b64_tr_b16 v[150:151], v8 offset:63488
    s_add_u32 s63, s63, 4096
    buffer_load_dwordx4 v[96:99], v6, s[24:27], s63 offen offset:0 sc1
    s_waitcnt vmcnt(11)
    s_waitcnt lgkmcnt(4)
    v_mfma_f32_32x32x16_bf16 v[16:31], v[136:139], v[116:119], v[16:31]
    ds_read_b64_tr_b16 v[152:153], v7 offset:62464
    ds_read_b64_tr_b16 v[154:155], v7 offset:64512
    v_mov_b32 v215, s60
    v_mfma_f32_32x32x16_bf16 v[32:47], v[140:143], v[116:119], v[32:47]
    ds_read_b64_tr_b16 v[156:157], v8 offset:62464
    ds_read_b64_tr_b16 v[158:159], v8 offset:64512
    buffer_load_dwordx4 v[100:103], v6, s[24:27], s63 offen offset:1024 sc1
    s_waitcnt vmcnt(11)
    s_waitcnt lgkmcnt(4)
    v_mfma_f32_32x32x16_bf16 v[16:31], v[144:147], v[120:123], v[16:31]
    ds_read_b64_tr_b16 v[128:129], v9 offset:0
    ds_read_b64_tr_b16 v[130:131], v9 offset:2048
    v_mov_b32 v202, s60
    v_mfma_f32_32x32x16_bf16 v[32:47], v[148:151], v[120:123], v[32:47]
    ds_read_b64_tr_b16 v[132:133], v10 offset:0
    ds_read_b64_tr_b16 v[134:135], v10 offset:2048
    buffer_load_dwordx4 v[104:107], v6, s[24:27], s63 offen offset:2048 sc1
    s_waitcnt vmcnt(11)
    s_waitcnt lgkmcnt(4)
    v_mfma_f32_32x32x16_bf16 v[16:31], v[152:155], v[124:127], v[16:31]
    ds_read_b64_tr_b16 v[136:137], v9 offset:1024
    ds_read_b64_tr_b16 v[138:139], v9 offset:3072
    v_mov_b32 v214, s60
    v_mfma_f32_32x32x16_bf16 v[32:47], v[156:159], v[124:127], v[32:47]
    ds_read_b64_tr_b16 v[140:141], v10 offset:1024
    ds_read_b64_tr_b16 v[142:143], v10 offset:3072
    buffer_load_dwordx4 v[108:111], v6, s[24:27], s63 offen offset:3072 sc1
    s_waitcnt vmcnt(11)
    s_waitcnt lgkmcnt(4)
    v_mfma_f32_32x32x16_bf16 v[16:31], v[128:131], v[64:67], v[16:31]
    ds_read_b64_tr_b16 v[144:145], v9 offset:4096
    ds_read_b64_tr_b16 v[146:147], v9 offset:6144
    v_mfma_f32_32x32x16_bf16 v[32:47], v[132:135], v[64:67], v[32:47]
    ds_read_b64_tr_b16 v[148:149], v10 offset:4096
    ds_read_b64_tr_b16 v[150:151], v10 offset:6144
    s_add_u32 s63, s63, 4096
    buffer_load_dwordx4 v[112:115], v6, s[24:27], s63 offen offset:0 sc1
    s_waitcnt vmcnt(11)
    s_waitcnt lgkmcnt(4)
    v_mfma_f32_32x32x16_bf16 v[16:31], v[136:139], v[68:71], v[16:31]
    ds_read_b64_tr_b16 v[152:153], v9 offset:5120
    ds_read_b64_tr_b16 v[154:155], v9 offset:7168
    v_and_b32 v2, 31, v1
    v_lshrrev_b32 v3, 5, v1
    v_lshlrev_b32 v2, 10, v2
    v_lshl_add_u32 v2, v3, 4, v2
    v_mfma_f32_32x32x16_bf16 v[32:47], v[140:143], v[68:71], v[32:47]
    ds_read_b64_tr_b16 v[156:157], v10 offset:5120
    ds_read_b64_tr_b16 v[158:159], v10 offset:7168
    buffer_load_dwordx4 v[116:119], v6, s[24:27], s63 offen offset:1024 sc1
    s_waitcnt vmcnt(11)
    s_waitcnt lgkmcnt(4)
    v_mfma_f32_32x32x16_bf16 v[16:31], v[144:147], v[72:75], v[16:31]
    ds_read_b64_tr_b16 v[128:129], v9 offset:8192
    ds_read_b64_tr_b16 v[130:131], v9 offset:10240
    v_and_b32 v3, 0x3c10, v2
    v_bfe_u32 v4, v1, 4, 1
    v_lshl_add_u32 v3, v4, 5, v3
    v_mul_u32_u24 v4, 3072, v1
    v_mfma_f32_32x32x16_bf16 v[32:47], v[148:151], v[72:75], v[32:47]
    ds_read_b64_tr_b16 v[132:133], v10 offset:8192
    ds_read_b64_tr_b16 v[134:135], v10 offset:10240
    buffer_load_dwordx4 v[120:123], v6, s[24:27], s63 offen offset:2048 sc1
    s_waitcnt vmcnt(11)
    s_waitcnt lgkmcnt(4)
    v_mfma_f32_32x32x16_bf16 v[16:31], v[152:155], v[76:79], v[16:31]
    ds_read_b64_tr_b16 v[136:137], v9 offset:9216
    ds_read_b64_tr_b16 v[138:139], v9 offset:11264
    v_mov_b32 v15, 1
    s_mov_b64 exec, 1
    ds_add_u32 v11, v15 offset:12
    s_mov_b64 exec, -1
    v_mfma_f32_32x32x16_bf16 v[32:47], v[156:159], v[76:79], v[32:47]
    ds_read_b64_tr_b16 v[140:141], v10 offset:9216
    ds_read_b64_tr_b16 v[142:143], v10 offset:11264
    buffer_load_dwordx4 v[124:127], v6, s[24:27], s63 offen offset:3072 sc1
    s_waitcnt vmcnt(11)
    s_waitcnt lgkmcnt(5)
    v_mfma_f32_32x32x16_bf16 v[16:31], v[128:131], v[80:83], v[16:31]
    ds_read_b64_tr_b16 v[144:145], v9 offset:12288
    ds_read_b64_tr_b16 v[146:147], v9 offset:14336
    v_mfma_f32_32x32x16_bf16 v[32:47], v[132:135], v[80:83], v[32:47]
    ds_read_b64_tr_b16 v[148:149], v10 offset:12288
    ds_read_b64_tr_b16 v[150:151], v10 offset:14336
    s_xor_b64 vcc, s[12:13], s[20:21]
    s_xor_b64 s[22:23], s[14:15], s[20:21]
    s_or_b64 vcc, vcc, s[22:23]
    s_xor_b64 s[22:23], s[16:17], s[20:21]
    s_or_b64 vcc, vcc, s[22:23]
    s_xor_b64 s[22:23], s[18:19], s[20:21]
    s_or_b64 vcc, vcc, s[22:23]
    s_cbranch_vccnz SL_31
SE_32:
    s_add_u32 s63, s63, 4096
    buffer_load_dwordx4 v[64:67], v6, s[24:27], s63 offen offset:0 sc1
    s_waitcnt vmcnt(11)
    s_waitcnt lgkmcnt(4)
    v_mfma_f32_32x32x16_bf16 v[16:31], v[136:139], v[84:87], v[16:31]
    ds_read_b64_tr_b16 v[152:153], v9 offset:13312
    ds_read_b64_tr_b16 v[154:155], v9 offset:15360
    s_lshl1_add_u32 s48, s53, s64
    s_lshl_b32 s48, s48, 12
    v_add_u32 v5, s48, v6
    v_mfma_f32_32x32x16_bf16 v[32:47], v[140:143], v[84:87], v[32:47]
    ds_read_b64_tr_b16 v[156:157], v10 offset:13312
    ds_read_b64_tr_b16 v[158:159], v10 offset:15360
    buffer_load_dwordx4 v[68:71], v6, s[24:27], s63 offen offset:1024 sc1
    s_waitcnt vmcnt(11)
    s_waitcnt lgkmcnt(4)
    v_mfma_f32_32x32x16_bf16 v[16:31], v[144:147], v[88:91], v[16:31]
    ds_read_b64_tr_b16 v[128:129], v9 offset:16384
    ds_read_b64_tr_b16 v[130:131], v9 offset:18432
    v_mfma_f32_32x32x16_bf16 v[32:47], v[148:151], v[88:91], v[32:47]
    ds_read_b64_tr_b16 v[132:133], v10 offset:16384
    ds_read_b64_tr_b16 v[134:135], v10 offset:18432
    buffer_load_dwordx4 v[72:75], v6, s[24:27], s63 offen offset:2048 sc1
    s_waitcnt vmcnt(11)
    s_waitcnt lgkmcnt(4)
    v_mfma_f32_32x32x16_bf16 v[16:31], v[152:155], v[92:95], v[16:31]
    ds_read_b64_tr_b16 v[136:137], v9 offset:17408
    ds_read_b64_tr_b16 v[138:139], v9 offset:19456
    v_mfma_f32_32x32x16_bf16 v[32:47], v[156:159], v[92:95], v[32:47]
    ds_read_b64_tr_b16 v[140:141], v10 offset:17408
    ds_read_b64_tr_b16 v[142:143], v10 offset:19456
    buffer_load_dwordx4 v[76:79], v6, s[24:27], s63 offen offset:3072 sc1
    s_waitcnt vmcnt(11)
    s_waitcnt lgkmcnt(4)
    v_mfma_f32_32x32x16_bf16 v[16:31], v[128:131], v[96:99], v[16:31]
    ds_read_b64_tr_b16 v[144:145], v9 offset:20480
    ds_read_b64_tr_b16 v[146:147], v9 offset:22528
    v_mfma_f32_32x32x16_bf16 v[32:47], v[132:135], v[96:99], v[32:47]
    ds_read_b64_tr_b16 v[148:149], v10 offset:20480
    ds_read_b64_tr_b16 v[150:151], v10 offset:22528
    s_add_u32 s63, s63, 4096
    buffer_load_dwordx4 v[80:83], v6, s[24:27], s63 offen offset:0 sc1
    s_waitcnt vmcnt(11)
    s_waitcnt lgkmcnt(4)
    v_mfma_f32_32x32x16_bf16 v[16:31], v[136:139], v[100:103], v[16:31]
    ds_read_b64_tr_b16 v[152:153], v9 offset:21504
    ds_read_b64_tr_b16 v[154:155], v9 offset:23552
    v_mfma_f32_32x32x16_bf16 v[32:47], v[140:143], v[100:103], v[32:47]
    ds_read_b64_tr_b16 v[156:157], v10 offset:21504
    ds_read_b64_tr_b16 v[158:159], v10 offset:23552
    buffer_load_dwordx4 v[84:87], v6, s[24:27], s63 offen offset:1024 sc1
    s_waitcnt vmcnt(11)
    s_waitcnt lgkmcnt(4)
    v_mfma_f32_32x32x16_bf16 v[16:31], v[144:147], v[104:107], v[16:31]
    ds_read_b64_tr_b16 v[128:129], v9 offset:24576
    ds_read_b64_tr_b16 v[130:131], v9 offset:26624
    v_mfma_f32_32x32x16_bf16 v[32:47], v[148:151], v[104:107], v[32:47]
    ds_read_b64_tr_b16 v[132:133], v10 offset:24576
    ds_read_b64_tr_b16 v[134:135], v10 offset:26624
    buffer_load_dwordx4 v[88:91], v6, s[24:27], s63 offen offset:2048 sc1
    s_waitcnt vmcnt(11)
    s_waitcnt lgkmcnt(4)
    v_mfma_f32_32x32x16_bf16 v[16:31], v[152:155], v[108:111], v[16:31]
    ds_read_b64_tr_b16 v[136:137], v9 offset:25600
    ds_read_b64_tr_b16 v[138:139], v9 offset:27648
    v_mfma_f32_32x32x16_bf16 v[32:47], v[156:159], v[108:111], v[32:47]
    ds_read_b64_tr_b16 v[140:141], v10 offset:25600
    ds_read_b64_tr_b16 v[142:143], v10 offset:27648
    buffer_load_dwordx4 v[92:95], v6, s[24:27], s63 offen offset:3072 sc1
    s_waitcnt vmcnt(11)
    s_waitcnt lgkmcnt(4)
    v_mfma_f32_32x32x16_bf16 v[16:31], v[128:131], v[112:115], v[16:31]
    ds_read_b64_tr_b16 v[144:145], v9 offset:28672
    ds_read_b64_tr_b16 v[146:147], v9 offset:30720
    v_mfma_f32_32x32x16_bf16 v[32:47], v[132:135], v[112:115], v[32:47]
    ds_read_b64_tr_b16 v[148:149], v10 offset:28672
    ds_read_b64_tr_b16 v[150:151], v10 offset:30720
    s_waitcnt vmcnt(10)
    s_waitcnt lgkmcnt(4)
    v_mfma_f32_32x32x16_bf16 v[16:31], v[136:139], v[116:119], v[16:31]
    ds_read_b64_tr_b16 v[152:153], v9 offset:29696
    ds_read_b64_tr_b16 v[154:155], v9 offset:31744
    buffer_load_dwordx4 v[160:163], v2, s[8:11], s5 offen offset:0
    v_mfma_f32_32x32x16_bf16 v[32:47], v[140:143], v[116:119], v[32:47]
    ds_read_b64_tr_b16 v[156:157], v10 offset:29696
    ds_read_b64_tr_b16 v[158:159], v10 offset:31744
    buffer_load_dwordx4 v[164:167], v2, s[8:11], s5 offen offset:32
    s_waitcnt vmcnt(11)
    s_waitcnt lgkmcnt(4)
    v_mfma_f32_32x32x16_bf16 v[16:31], v[144:147], v[120:123], v[16:31]
    ds_read_b64_tr_b16 v[128:129], v9 offset:32768
    ds_read_b64_tr_b16 v[130:131], v9 offset:34816
    v_mfma_f32_32x32x16_bf16 v[32:47], v[148:151], v[120:123], v[32:47]
    ds_read_b64_tr_b16 v[132:133], v10 offset:32768
    ds_read_b64_tr_b16 v[134:135], v10 offset:34816
    s_waitcnt vmcnt(10)
    s_waitcnt lgkmcnt(4)
    v_mfma_f32_32x32x16_bf16 v[16:31], v[152:155], v[124:127], v[16:31]
    ds_read_b64_tr_b16 v[136:137], v9 offset:33792
    ds_read_b64_tr_b16 v[138:139], v9 offset:35840
    v_mfma_f32_32x32x16_bf16 v[32:47], v[156:159], v[124:127], v[32:47]
    ds_read_b64_tr_b16 v[140:141], v10 offset:33792
    ds_read_b64_tr_b16 v[142:143], v10 offset:35840
    s_waitcnt vmcnt(9)
    s_waitcnt lgkmcnt(4)
    v_mfma_f32_32x32x16_bf16 v[16:31], v[128:131], v[64:67], v[16:31]
    ds_read_b64_tr_b16 v[144:145], v9 offset:36864
    ds_read_b64_tr_b16 v[146:147], v9 offset:38912
    v_mfma_f32_32x32x16_bf16 v[32:47], v[132:135], v[64:67], v[32:47]
    ds_read_b64_tr_b16 v[148:149], v10 offset:36864
    ds_read_b64_tr_b16 v[150:151], v10 offset:38912
    s_waitcnt vmcnt(8)
    s_waitcnt lgkmcnt(4)
    v_mfma_f32_32x32x16_bf16 v[16:31], v[136:139], v[68:71], v[16:31]
    ds_read_b64_tr_b16 v[152:153], v9 offset:37888
    ds_read_b64_tr_b16 v[154:155], v9 offset:39936
    v_mfma_f32_32x32x16_bf16 v[32:47], v[140:143], v[68:71], v[32:47]
    ds_read_b64_tr_b16 v[156:157], v10 offset:37888
    ds_read_b64_tr_b16 v[158:159], v10 offset:39936
    s_waitcnt vmcnt(7)
    s_waitcnt lgkmcnt(4)
    v_mfma_f32_32x32x16_bf16 v[16:31], v[144:147], v[72:75], v[16:31]
    ds_read_b64_tr_b16 v[128:129], v9 offset:40960
    ds_read_b64_tr_b16 v[130:131], v9 offset:43008
    s_mul_i32 exec_lo, s64, 3
    s_mov_b32 exec_hi, 0
    buffer_store_dword v195, v4, s[24:27], s3 offen offset:3064 sc1
    s_mov_b64 exec, -1
    v_mfma_f32_32x32x16_bf16 v[32:47], v[148:151], v[72:75], v[32:47]
    ds_read_b64_tr_b16 v[132:133], v10 offset:40960
    ds_read_b64_tr_b16 v[134:135], v10 offset:43008
    s_waitcnt vmcnt(7)
    s_waitcnt lgkmcnt(4)
    v_mfma_f32_32x32x16_bf16 v[16:31], v[152:155], v[76:79], v[16:31]
    ds_read_b64_tr_b16 v[136:137], v9 offset:41984
    ds_read_b64_tr_b16 v[138:139], v9 offset:44032
    v_mfma_f32_32x32x16_bf16 v[32:47], v[156:159], v[76:79], v[32:47]
    ds_read_b64_tr_b16 v[140:141], v10 offset:41984
    ds_read_b64_tr_b16 v[142:143], v10 offset:44032
    s_waitcnt vmcnt(6)
    s_waitcnt lgkmcnt(4)
    v_mfma_f32_32x32x16_bf16 v[16:31], v[128:131], v[80:83], v[16:31]
    ds_read_b64_tr_b16 v[144:145], v9 offset:45056
    ds_read_b64_tr_b16 v[146:147], v9 offset:47104
    s_lshl_b32 s48, s53, 13
    s_add_u32 s48, s48, 32768
    v_add_u32 v12, s48, v6
    s_lshl_b32 s48, s53, 2
    v_add_u32 v14, s48, v11
    v_mfma_f32_32x32x16_bf16 v[32:47], v[132:135], v[80:83], v[32:47]
    ds_read_b64_tr_b16 v[148:149], v10 offset:45056
    ds_read_b64_tr_b16 v[150:151], v10 offset:47104
    s_waitcnt vmcnt(5)
    s_waitcnt lgkmcnt(4)
    v_mfma_f32_32x32x16_bf16 v[16:31], v[136:139], v[84:87], v[16:31]
    ds_read_b64_tr_b16 v[152:153], v9 offset:46080
    ds_read_b64_tr_b16 v[154:155], v9 offset:48128
    v_mfma_f32_32x32x16_bf16 v[32:47], v[140:143], v[84:87], v[32:47]
    ds_read_b64_tr_b16 v[156:157], v10 offset:46080
    ds_read_b64_tr_b16 v[158:159], v10 offset:48128
    s_waitcnt vmcnt(4)
    s_waitcnt lgkmcnt(4)
    v_mfma_f32_32x32x16_bf16 v[16:31], v[144:147], v[88:91], v[16:31]
    ds_read_b32 v13, v11 offset:12
    v_mfma_f32_32x32x16_bf16 v[32:47], v[148:151], v[88:91], v[32:47]
    s_waitcnt vmcnt(3)
    s_waitcnt lgkmcnt(1)
    v_mfma_f32_32x32x16_bf16 v[16:31], v[152:155], v[92:95], v[16:31]
    v_mfma_f32_32x32x16_bf16 v[32:47], v[156:159], v[92:95], v[32:47]
    s_cmp_eq_u32 s64, 0
    s_cbranch_scc1 L_OWN
    s_nop 8
    v_cvt_pk_bf16_f32 v192, v16, v17
    v_cvt_pk_bf16_f32 v193, v18, v19
    v_cvt_pk_bf16_f32 v194, v20, v21
    buffer_store_dwordx4 v[192:195], v6, s[24:27], s3 offen offset:0 sc1
    v_cvt_pk_bf16_f32 v196, v22, v23
    v_cvt_pk_bf16_f32 v197, v24, v25
    v_cvt_pk_bf16_f32 v198, v26, v27
    buffer_store_dwordx4 v[196:199], v6, s[24:27], s3 offen offset:1024 sc1
    v_cvt_pk_bf16_f32 v200, v28, v29
    v_cvt_pk_bf16_f32 v201, v30, v31
    buffer_store_dwordx4 v[200:203], v6, s[24:27], s3 offen offset:2048 sc1
    v_cvt_pk_bf16_f32 v204, v32, v33
    v_cvt_pk_bf16_f32 v205, v34, v35
    v_cvt_pk_bf16_f32 v206, v36, v37
    s_add_u32 s3, s3, 3072
    buffer_store_dwordx4 v[204:207], v6, s[24:27], s3 offen offset:0 sc1
    v_cvt_pk_bf16_f32 v208, v38, v39
    v_cvt_pk_bf16_f32 v209, v40, v41
    v_cvt_pk_bf16_f32 v210, v42, v43
    buffer_store_dwordx4 v[208:211], v6, s[24:27], s3 offen offset:1024 sc1
    v_cvt_pk_bf16_f32 v212, v44, v45
    v_cvt_pk_bf16_f32 v213, v46, v47
    buffer_store_dwordx4 v[212:215], v6, s[24:27], s3 offen offset:2048 sc1
    v_mov_b32 v15, 1
    s_mov_b64 exec, 1
    ds_add_u32 v11, v15 offset:8
    s_mov_b64 exec, -1
    v_add_u32 v12, 0x1000, v12
    ds_read_b32 v13, v14 offset:32
    ds_read_b128 v[16:19], v12 offset:0
    ds_read_b128 v[20:23], v12 offset:1024
    ds_read_b128 v[24:27], v12 offset:2048
    ds_read_b128 v[28:31], v12 offset:3072
    s_buffer_load_dword s12, s[24:27], s4 offset:3064 glc
    s_waitcnt lgkmcnt(0)
    v_cmp_eq_u32 vcc, 0, v13
    s_cbranch_vccnz SL_33
SE_34:
    s_branch L_GFIN
L_OWN:
    s_waitcnt lgkmcnt(0)
    v_cmp_gt_u32 vcc, 8, v13
    s_cbranch_vccnz SL_35
SE_36:
    s_nop 6
    ds_write_b128 v12, v[32:35] offset:4096
    ds_write_b128 v12, v[36:39] offset:5120
    ds_write_b128 v12, v[40:43] offset:6144
    ds_write_b128 v12, v[44:47] offset:7168
    ds_write_b32 v14, v14 offset:32
    s_buffer_load_dword s12, s[24:27], s4 offset:3064 glc
    s_waitcnt lgkmcnt(0)
L_GFIN:
    s_cmp_lg_u32 s12, s60
    s_cselect_b64 vcc, -1, 0
    s_cbranch_vccnz SL_37
SE_38:
    buffer_load_dwordx4 v[216:219], v6, s[24:27], s4 offen offset:0 sc1
    buffer_load_dwordx4 v[220:223], v6, s[24:27], s4 offen offset:1024 sc1
    buffer_load_dwordx4 v[224:227], v6, s[24:27], s4 offen offset:2048 sc1
    v_mov_b32 v48, 0xbfb8aa3b
    s_add_u32 s51, s5, 0x4000
    v_mul_f32 v16, v48, v16
    v_mul_f32 v17, v48, v17
    v_mul_f32 v18, v48, v18
    v_mul_f32 v19, v48, v19
    v_mul_f32 v20, v48, v20
    v_mul_f32 v21, v48, v21
    v_mul_f32 v22, v48, v22
    v_mul_f32 v23, v48, v23
    v_mul_f32 v24, v48, v24
    v_mul_f32 v25, v48, v25
    v_mul_f32 v26, v48, v26
    v_mul_f32 v27, v48, v27
    v_mul_f32 v28, v48, v28
    v_mul_f32 v29, v48, v29
    v_mul_f32 v30, v48, v30
    v_mul_f32 v31, v48, v31
    s_waitcnt vmcnt(3)
    v_lshlrev_b32 v168, 16, v160
    v_and_b32 v169, s66, v160
    v_lshlrev_b32 v170, 16, v161
    v_and_b32 v171, s66, v161
    v_lshlrev_b32 v172, 16, v162
    v_and_b32 v173, s66, v162
    v_lshlrev_b32 v174, 16, v163
    v_and_b32 v175, s66, v163
    v_lshlrev_b32 v176, 16, v164
    v_and_b32 v177, s66, v164
    v_lshlrev_b32 v178, 16, v165
    v_and_b32 v179, s66, v165
    v_lshlrev_b32 v180, 16, v166
    v_and_b32 v181, s66, v166
    v_lshlrev_b32 v182, 16, v167
    v_and_b32 v183, s66, v167
    s_waitcnt vmcnt(0)
    v_xor_b32 v13, s60, v219
    v_xor_b32 v14, s60, v223
    v_xor_b32 v15, s60, v227
    v_or3_b32 v13, v13, v14, v15
    v_cmp_ne_u32 vcc, 0, v13
    s_cbranch_vccnz SL_39
SE_40:
    v_lshlrev_b32 v64, 16, v216
    v_and_b32 v65, s66, v216
    v_lshlrev_b32 v66, 16, v217
    v_and_b32 v67, s66, v217
    v_lshlrev_b32 v68, 16, v218
    v_and_b32 v69, s66, v218
    v_lshlrev_b32 v70, 16, v220
    v_and_b32 v71, s66, v220
    v_lshlrev_b32 v72, 16, v221
    v_and_b32 v73, s66, v221
    v_lshlrev_b32 v74, 16, v222
    v_and_b32 v75, s66, v222
    v_lshlrev_b32 v76, 16, v224
    v_and_b32 v77, s66, v224
    v_lshlrev_b32 v78, 16, v225
    v_and_b32 v79, s66, v225
    v_fmac_f32 v16, v48, v64
    v_fmac_f32 v17, v48, v65
    v_fmac_f32 v18, v48, v66
    v_fmac_f32 v19, v48, v67
    v_fmac_f32 v20, v48, v68
    v_fmac_f32 v21, v48, v69
    v_fmac_f32 v22, v48, v70
    v_fmac_f32 v23, v48, v71
    v_fmac_f32 v24, v48, v72
    v_fmac_f32 v25, v48, v73
    v_fmac_f32 v26, v48, v74
    v_fmac_f32 v27, v48, v75
    v_fmac_f32 v28, v48, v76
    v_fmac_f32 v29, v48, v77
    v_fmac_f32 v30, v48, v78
    v_fmac_f32 v31, v48, v79
    v_exp_f32 v64, v16
    v_exp_f32 v65, v17
    v_exp_f32 v66, v18
    v_exp_f32 v67, v19
    v_exp_f32 v68, v20
    v_exp_f32 v69, v21
    v_exp_f32 v70, v22
    v_exp_f32 v71, v23
    v_exp_f32 v72, v24
    v_exp_f32 v73, v25
    v_exp_f32 v74, v26
    v_exp_f32 v75, v27
    v_exp_f32 v76, v28
    v_exp_f32 v77, v29
    v_exp_f32 v78, v30
    v_exp_f32 v79, v31
    v_fma_f32 v64, v64, v48, v48
    v_fma_f32 v65, v65, v48, v48
    v_fma_f32 v66, v66, v48, v48
    v_fma_f32 v67, v67, v48, v48
    v_fma_f32 v68, v68, v48, v48
    v_fma_f32 v69, v69, v48, v48
    v_fma_f32 v70, v70, v48, v48
    v_fma_f32 v71, v71, v48, v48
    v_fma_f32 v72, v72, v48, v48
    v_fma_f32 v73, v73, v48, v48
    v_fma_f32 v74, v74, v48, v48
    v_fma_f32 v75, v75, v48, v48
    v_fma_f32 v76, v76, v48, v48
    v_fma_f32 v77, v77, v48, v48
    v_fma_f32 v78, v78, v48, v48
    v_fma_f32 v79, v79, v48, v48
    s_barrier
    ds_read_b128 v[96:99], v5 offset:0
    ds_read_b128 v[112:115], v5 offset:16384
    ds_read_b128 v[100:103], v5 offset:1024
    ds_read_b128 v[116:119], v5 offset:17408
    ds_read_b128 v[104:107], v5 offset:2048
    ds_read_b128 v[120:123], v5 offset:18432
    ds_read_b128 v[108:111], v5 offset:3072
    ds_read_b128 v[124:127], v5 offset:19456
    v_rcp_f32 v64, v64
    v_rcp_f32 v65, v65
    v_rcp_f32 v66, v66
    v_rcp_f32 v67, v67
    v_rcp_f32 v68, v68
    v_rcp_f32 v69, v69
    v_rcp_f32 v70, v70
    v_rcp_f32 v71, v71
    v_rcp_f32 v72, v72
    v_rcp_f32 v73, v73
    v_rcp_f32 v74, v74
    v_rcp_f32 v75, v75
    v_rcp_f32 v76, v76
    v_rcp_f32 v77, v77
    v_rcp_f32 v78, v78
    v_rcp_f32 v79, v79
    v_pk_mul_f32 v[16:17], v[16:17], v[64:65]
    v_pk_mul_f32 v[18:19], v[18:19], v[66:67]
    v_pk_mul_f32 v[20:21], v[20:21], v[68:69]
    v_pk_mul_f32 v[22:23], v[22:23], v[70:71]
    s_waitcnt lgkmcnt(4)
    v_pk_add_f32 v[96:97], v[96:97], v[112:113]
    v_pk_add_f32 v[98:99], v[98:99], v[114:115]
    v_pk_add_f32 v[100:101], v[100:101], v[116:117]
    v_pk_add_f32 v[102:103], v[102:103], v[118:119]
    v_pk_fma_f32 v[16:17], v[16:17], v[96:97], v[168:169]
    v_pk_fma_f32 v[18:19], v[18:19], v[98:99], v[170:171]
    v_pk_fma_f32 v[20:21], v[20:21], v[100:101], v[172:173]
    v_pk_fma_f32 v[22:23], v[22:23], v[102:103], v[174:175]
    v_cvt_pk_bf16_f32 v160, v16, v17
    v_cvt_pk_bf16_f32 v161, v18, v19
    v_cvt_pk_bf16_f32 v162, v20, v21
    v_cvt_pk_bf16_f32 v163, v22, v23
    v_pk_mul_f32 v[24:25], v[24:25], v[72:73]
    v_pk_mul_f32 v[26:27], v[26:27], v[74:75]
    v_pk_mul_f32 v[28:29], v[28:29], v[76:77]
    v_pk_mul_f32 v[30:31], v[30:31], v[78:79]
    s_waitcnt lgkmcnt(0)
    v_pk_add_f32 v[104:105], v[104:105], v[120:121]
    v_pk_add_f32 v[106:107], v[106:107], v[122:123]
    v_pk_add_f32 v[108:109], v[108:109], v[124:125]
    v_pk_add_f32 v[110:111], v[110:111], v[126:127]
    v_pk_fma_f32 v[24:25], v[24:25], v[104:105], v[176:177]
    v_pk_fma_f32 v[26:27], v[26:27], v[106:107], v[178:179]
    v_pk_fma_f32 v[28:29], v[28:29], v[108:109], v[180:181]
    v_pk_fma_f32 v[30:31], v[30:31], v[110:111], v[182:183]
    v_cvt_pk_bf16_f32 v164, v24, v25
    v_cvt_pk_bf16_f32 v165, v26, v27
    v_cvt_pk_bf16_f32 v166, v28, v29
    v_cvt_pk_bf16_f32 v167, v30, v31
    v_permlane16_swap_b32 v160, v164
    v_permlane16_swap_b32 v161, v165
    v_permlane16_swap_b32 v162, v166
    v_permlane16_swap_b32 v163, v167
    buffer_store_dwordx4 v[160:163], v3, s[28:31], s5 offen sc1
    buffer_store_dwordx4 v[164:167], v3, s[28:31], s51 offen sc1
    s_branch L_FIN
L_MA:
    s_or_b32 s48, s2, s99
    s_cmp_lg_u32 s48, 0
    s_cbranch_scc1 L_NOLEAD
    s_memrealtime s[68:69]
    v_mov_b32 v12, 0
    s_waitcnt lgkmcnt(0)
    s_or_b32 s48, s68, 1
    v_mov_b32 v13, s48
    s_mov_b64 exec, 1
    global_store_dword v12, v13, s[30:31] sc1
    s_mov_b64 exec, -1
L_NOLEAD:
    s_mov_b32 s20, s34
    s_mov_b32 s21, s35
    s_mov_b32 s34, s30
    s_mov_b32 s35, s31
    s_mov_b32 s66, 0xffff0000
    s_lshr_b32 s56, s45, 2
    s_xor_b32 s56, s56, 6
    s_bfe_u32 s48, s2, 0x10002
    s_lshl2_add_u32 s54, s48, s54
    s_mov_b32 s30, 0x200000
    s_mov_b32 s31, 0x20000
    s_mov_b32 s22, 0x80000
    s_mov_b32 s23, 0x20000
    s_mov_b32 s16, s18
    s_mov_b32 s17, s19
    s_mov_b32 s18, 0x1c0000
    s_mov_b32 s19, 0x20000
    s_add_u32 s24, s24, 0x0
    s_addc_u32 s25, s25, 0
    s_mov_b32 s26, 25165824
    s_mov_b32 s27, 0x20000
    s_and_b32 s53, s100, 1
    s_lshr_b32 s52, s100, 1
    v_bfe_u32 v22, v1, 2, 2
    v_lshl_add_u32 v22, v21, 3, v22
    v_bfe_u32 v23, v1, 4, 1
    v_lshlrev_b32 v23, 5, v23
    v_and_b32 v24, 1, v1
    v_lshl_add_u32 v23, v24, 4, v23
    v_bfe_u32 v24, v1, 1, 1
    v_lshl_add_u32 v23, v24, 3, v23
    v_bfe_u32 v24, v1, 3, 1
    v_lshl_add_u32 v23, v24, 6, v23
    v_lshl_add_u32 v7, v22, 7, v23
    s_mov_b32 s97, s52
    s_mov_b32 s96, s53
    v_bfe_u32 v23, v1, 1, 3
    v_xor_b32 v23, v23, v21
    v_lshlrev_b32 v23, 4, v23
    v_lshl_add_u32 v23, v20, 7, v23
    s_add_u32 s48, s40, 49152
    v_add_u32 v192, s48, v23
    v_xor_b32 v193, 32, v192
    v_xor_b32 v194, 64, v192
    v_xor_b32 v195, 0x60, v192
    s_lshl1_add_u32 s48, s47, s97
    s_lshr_b32 s49, s101, 2
    s_lshl1_add_u32 s48, s48, s49
    s_lshl_b32 s48, s48, 10
    s_and_b32 s49, s101, 3
    s_lshl1_add_u32 s49, s49, s96
    s_lshl2_add_u32 s48, s49, s48
    s_add_u32 s70, s48, 12058624
    v_and_b32 v2, 15, v1
    v_lshrrev_b32 v3, 4, v1
    v_bfe_u32 v23, v1, 1, 3
    v_xor_b32 v23, v23, v3
    v_lshlrev_b32 v23, 4, v23
    v_lshl_add_u32 v23, v2, 7, v23
    s_add_u32 s48, s40, 49152
    v_add_u32 v192, s48, v23
    v_xor_b32 v193, 64, v192
    v_xor_b32 v194, 0x1000, v192
    v_xor_b32 v195, 0x1000, v193
    v_bfe_u32 v22, v1, 2, 2
    v_lshl_add_u32 v22, v3, 3, v22
    v_and_b32 v23, 3, v1
    v_lshlrev_b32 v23, 3, v23
    v_bfe_u32 v24, v1, 4, 1
    v_lshl_add_u32 v23, v24, 5, v23
    v_bfe_u32 v24, v1, 3, 1
    v_lshl_add_u32 v23, v24, 6, v23
    v_lshl_add_u32 v15, v22, 7, v23
    v_and_b32 v4, 3, v1
    v_lshl_add_u32 v4, v24, 2, v4
    v_bfe_u32 v24, v1, 2, 1
    v_lshl_add_u32 v4, v24, 3, v4
    v_lshlrev_b32 v2, 4, v2
    v_lshl_add_u32 v3, v3, 9, v2
    s_and_b32 s51, s101, 1
    s_lshl_b32 s49, s96, 2
    s_add_u32 s49, s49, s51
    s_lshl_b32 s50, s49, 7
    s_add_u32 s50, s50, 162816
    v_lshlrev_b32 v13, 2, v4
    v_add_u32 v14, s50, v13
    s_and_b32 s48, s49, 1
    s_lshl_b32 s48, s48, 6
    v_xor_b32 v200, s48, v15
    s_lshr_b32 s48, s49, 1
    s_lshl_b32 s48, s48, 13
    s_add_u32 s48, s48, 65536
    v_add_u32 v200, s48, v200
    s_add_u32 s49, s49, 1
    s_and_b32 s48, s49, 1
    s_lshl_b32 s48, s48, 6
    v_xor_b32 v201, s48, v15
    s_lshr_b32 s48, s49, 1
    s_lshl_b32 s48, s48, 13
    s_add_u32 s48, s48, 65536
    v_add_u32 v201, s48, v201
    s_add_u32 s49, s51, 3
    s_and_b32 s48, s49, 1
    s_lshl_b32 s48, s48, 6
    v_xor_b32 v202, s48, v15
    s_lshr_b32 s48, s49, 1
    s_lshl_b32 s48, s48, 13
    s_add_u32 s48, s48, 65536
    v_add_u32 v202, s48, v202
    v_xor_b32 v203, 32, v200
    v_xor_b32 v204, 32, v201
    v_xor_b32 v205, 32, v202
    s_lshl_b32 s50, s49, 7
    s_add_u32 s50, s50, 162816
    v_add_u32 v13, s50, v13
    s_lshl_b32 s48, s47, 2
    s_add_u32 s48, s48, s100
    s_xor_b32 s50, s48, 1
    s_mul_i32 s48, s48, 144
    s_mul_i32 s50, s50, 144
    s_lshr_b32 s49, s101, 2
    s_mul_i32 s49, s49, 56
    s_add_u32 s48, s48, s49
    s_add_u32 s50, s50, s49
    s_and_b32 s49, s101, 3
    s_lshl_b32 s49, s49, 1
    s_add_u32 s62, s48, s49
    s_add_u32 s62, s62, 48
    s_lshl_b32 s62, s62, 10
    s_add_u32 s49, s49, s96
    s_lshl_b32 s49, s49, 1
    s_add_u32 s48, s48, s49
    s_add_u32 s50, s50, s49
    s_lshl_b32 s63, s48, 10
    s_lshl_b32 s46, s50, 10
    s_lshl_b32 s48, s47, 11
    s_lshl_b32 s49, s100, 9
    s_add_u32 s67, s48, s49
    s_add_u32 s67, s67, 11599872
    s_xor_b32 s5, s67, 512
    s_add_u32 s49, s49, 157696
    v_add_u32 v26, s49, v2
    v_xor_b32 v27, 0x200, v26
    v_mov_b32 v72, 0
    v_mov_b32 v73, 0
    s_lshl1_add_u32 s48, s47, s55
    s_lshl1_add_u32 s49, s48, s52
    s_and_b32 s50, s56, 1
    s_lshl3_add_u32 s49, s49, s50
    s_lshl_b32 s49, s49, 7
    s_add_u32 s71, s49, 12189696
    s_lshl1_add_u32 s48, s48, s53
    s_mul_i32 s49, s48, 144
    s_lshl4_add_u32 s49, s52, s49
    s_add_u32 s49, s49, 112
    s_lshl_b32 s4, s49, 10
    s_lshl_b32 s48, s100, 5
    s_add_u32 s48, s48, 161856
    v_lshlrev_b32 v39, 4, v21
    v_add_u32 v39, s48, v39
    s_waitcnt vmcnt(0)
    v_lshlrev_b32 v80, 16, v64
    v_and_b32 v81, s66, v64
    v_lshlrev_b32 v82, 16, v65
    v_and_b32 v83, s66, v65
    v_lshlrev_b32 v84, 16, v66
    v_and_b32 v85, s66, v66
    v_lshlrev_b32 v86, 16, v67
    v_and_b32 v87, s66, v67
    v_lshlrev_b32 v88, 16, v68
    v_and_b32 v89, s66, v68
    v_lshlrev_b32 v90, 16, v69
    v_and_b32 v91, s66, v69
    v_lshlrev_b32 v92, 16, v70
    v_and_b32 v93, s66, v70
    v_lshlrev_b32 v94, 16, v71
    v_and_b32 v95, s66, v71
    v_pk_add_f32 v[64:65], v[80:81], v[82:83]
    v_pk_add_f32 v[66:67], v[84:85], v[86:87]
    v_pk_add_f32 v[64:65], v[64:65], v[88:89]
    v_pk_add_f32 v[66:67], v[66:67], v[90:91]
    v_pk_add_f32 v[64:65], v[64:65], v[92:93]
    v_pk_add_f32 v[66:67], v[66:67], v[94:95]
    v_pk_add_f32 v[64:65], v[64:65], v[66:67]
    v_add_f32 v34, v64, v65
    s_nop 1
    v_add_f32_dpp v34, v34, v34 quad_perm:[1,0,3,2] row_mask:0xf bank_mask:0xf
    s_nop 1
    v_add_f32_dpp v34, v34, v34 quad_perm:[2,3,0,1] row_mask:0xf bank_mask:0xf
    s_nop 1
    v_add_f32_dpp v34, v34, v34 row_half_mirror row_mask:0xf bank_mask:0xf
    s_nop 1
    v_add_f32_dpp v34, v34, v34 row_mirror row_mask:0xf bank_mask:0xf
    v_mov_b32 v64, v34
    s_nop 1
    v_permlane16_swap_b32 v34, v64
    v_add_f32 v34, v34, v64
    v_mul_f32 v34, 0x3b000000, v34
    v_pk_add_f32 v[80:81], v[80:81], v[34:35] op_sel_hi:[1,0] neg_lo:[0,1] neg_hi:[0,1]
    v_pk_add_f32 v[82:83], v[82:83], v[34:35] op_sel_hi:[1,0] neg_lo:[0,1] neg_hi:[0,1]
    v_pk_add_f32 v[84:85], v[84:85], v[34:35] op_sel_hi:[1,0] neg_lo:[0,1] neg_hi:[0,1]
    v_pk_add_f32 v[86:87], v[86:87], v[34:35] op_sel_hi:[1,0] neg_lo:[0,1] neg_hi:[0,1]
    v_pk_add_f32 v[88:89], v[88:89], v[34:35] op_sel_hi:[1,0] neg_lo:[0,1] neg_hi:[0,1]
    v_pk_add_f32 v[90:91], v[90:91], v[34:35] op_sel_hi:[1,0] neg_lo:[0,1] neg_hi:[0,1]
    v_pk_add_f32 v[92:93], v[92:93], v[34:35] op_sel_hi:[1,0] neg_lo:[0,1] neg_hi:[0,1]
    v_pk_add_f32 v[94:95], v[94:95], v[34:35] op_sel_hi:[1,0] neg_lo:[0,1] neg_hi:[0,1]
    v_pk_mul_f32 v[64:65], v[80:81], v[80:81]
    v_pk_mul_f32 v[66:67], v[82:83], v[82:83]
    v_pk_fma_f32 v[64:65], v[84:85], v[84:85], v[64:65]
    v_pk_fma_f32 v[66:67], v[86:87], v[86:87], v[66:67]
    v_pk_fma_f32 v[64:65], v[88:89], v[88:89], v[64:65]
    v_pk_fma_f32 v[66:67], v[90:91], v[90:91], v[66:67]
    v_pk_fma_f32 v[64:65], v[92:93], v[92:93], v[64:65]
    v_pk_fma_f32 v[66:67], v[94:95], v[94:95], v[66:67]
    v_pk_add_f32 v[64:65], v[64:65], v[66:67]
    v_add_f32 v36, v64, v65
    s_nop 1
    v_add_f32_dpp v36, v36, v36 quad_perm:[1,0,3,2] row_mask:0xf bank_mask:0xf
    s_nop 1
    v_add_f32_dpp v36, v36, v36 quad_perm:[2,3,0,1] row_mask:0xf bank_mask:0xf
    s_nop 1
    v_add_f32_dpp v36, v36, v36 row_half_mirror row_mask:0xf bank_mask:0xf
    s_nop 1
    v_add_f32_dpp v36, v36, v36 row_mirror row_mask:0xf bank_mask:0xf
    v_mov_b32 v64, v36
    s_nop 1
    v_permlane16_swap_b32 v36, v64
    v_add_f32 v36, v36, v64
    v_mov_b32 v64, 0x3727c5ac
    v_fmac_f32 v64, 0x3b000000, v36
    v_rsq_f32 v35, v64
    v_sqrt_f32 v36, v64
    s_mov_b64 exec, 0
    s_mov_b64 vcc, 0
    s_cmp_eq_u32 s100, 0
    s_cbranch_scc1 SEG_A0_0
    s_cmp_eq_u32 s100, 1
    s_cbranch_scc1 SEG_A0_1
    s_cmp_eq_u32 s100, 2
    s_cbranch_scc1 SEG_A0_2
    s_branch SEG_A0_3
RET0_A:
    s_mov_b64 exec, -1
    ds_write_b96 v39, v[34:36]
    s_waitcnt lgkmcnt(0)
    s_setprio 2
    s_barrier
    ds_read_b128 v[240:243], v192 offset:0
    ds_read_b64_tr_b16 v[208:209], v200 offset:0
    ds_read_b64_tr_b16 v[210:211], v200 offset:512
    ds_read_b128 v[244:247], v192 offset:2048
    ds_read_b128 v[248:251], v194 offset:0
    ds_read_b128 v[252:255], v194 offset:2048
    ds_read_b64_tr_b16 v[212:213], v201 offset:0
    ds_read_b64_tr_b16 v[214:215], v201 offset:512
    ds_read_b64_tr_b16 v[216:217], v200 offset:8192
    ds_read_b64_tr_b16 v[218:219], v200 offset:8704
    ds_read_b64_tr_b16 v[220:221], v202 offset:0
    ds_read_b64_tr_b16 v[222:223], v202 offset:512
    s_waitcnt lgkmcnt(8)
    v_mfma_f32_16x16x32_bf16 v[80:83], v[208:211], v[240:243], 0
    ds_read_b64_tr_b16 v[224:225], v203 offset:0
    v_mfma_f32_16x16x32_bf16 v[88:91], v[208:211], v[244:247], 0
    ds_read_b64_tr_b16 v[226:227], v203 offset:512
    s_waitcnt lgkmcnt(8)
    v_mfma_f32_16x16x32_bf16 v[96:99], v[208:211], v[248:251], 0
    ds_read_b64_tr_b16 v[228:229], v204 offset:0
    v_mfma_f32_16x16x32_bf16 v[104:107], v[208:211], v[252:255], 0
    ds_read_b64_tr_b16 v[230:231], v204 offset:512
    s_waitcnt lgkmcnt(8)
    v_mfma_f32_16x16x32_bf16 v[112:115], v[212:215], v[240:243], 0
    ds_read_b64_tr_b16 v[232:233], v203 offset:8192
    v_mfma_f32_16x16x32_bf16 v[120:123], v[212:215], v[244:247], 0
    ds_read_b64_tr_b16 v[234:235], v203 offset:8704
    v_mfma_f32_16x16x32_bf16 v[128:131], v[212:215], v[248:251], 0
    ds_read_b64_tr_b16 v[236:237], v205 offset:0
    v_mfma_f32_16x16x32_bf16 v[136:139], v[212:215], v[252:255], 0
    ds_read_b64_tr_b16 v[238:239], v205 offset:512
    s_waitcnt lgkmcnt(8)
    v_mfma_f32_16x16x32_bf16 v[144:147], v[216:219], v[240:243], 0
    ds_read_b128 v[40:43], v193 offset:0
    v_mfma_f32_16x16x32_bf16 v[152:155], v[216:219], v[244:247], 0
    ds_read_b128 v[44:47], v193 offset:2048
    v_mfma_f32_16x16x32_bf16 v[160:163], v[216:219], v[248:251], 0
    v_add_u32 v192, 0xc000, v192
    v_mfma_f32_16x16x32_bf16 v[168:171], v[216:219], v[252:255], 0
    v_add_u32 v194, 0xc000, v194
    v_mfma_f32_16x16x32_bf16 v[176:179], v[220:223], v[240:243], 0
    v_mfma_f32_16x16x32_bf16 v[184:187], v[220:223], v[244:247], 0
    s_waitcnt lgkmcnt(8)
    v_mfma_f32_16x16x32_bf16 v[84:87], v[224:227], v[240:243], 0
    ds_read_b128 v[48:51], v195 offset:0
    v_mfma_f32_16x16x32_bf16 v[92:95], v[224:227], v[244:247], 0
    ds_read_b128 v[52:55], v195 offset:2048
    v_mfma_f32_16x16x32_bf16 v[100:103], v[224:227], v[248:251], 0
    ds_read_b64_tr_b16 v[208:209], v200 offset:4096
    v_mfma_f32_16x16x32_bf16 v[108:111], v[224:227], v[252:255], 0
    ds_read_b64_tr_b16 v[210:211], v200 offset:4608
    s_waitcnt lgkmcnt(10)
    v_mfma_f32_16x16x32_bf16 v[116:119], v[228:231], v[240:243], 0
    ds_read_b64_tr_b16 v[212:213], v201 offset:4096
    v_mfma_f32_16x16x32_bf16 v[124:127], v[228:231], v[244:247], 0
    ds_read_b64_tr_b16 v[214:215], v201 offset:4608
    v_mfma_f32_16x16x32_bf16 v[132:135], v[228:231], v[248:251], 0
    ds_read_b64_tr_b16 v[216:217], v200 offset:12288
    v_mfma_f32_16x16x32_bf16 v[140:143], v[228:231], v[252:255], 0
    ds_read_b64_tr_b16 v[218:219], v200 offset:12800
    s_waitcnt lgkmcnt(10)
    v_mfma_f32_16x16x32_bf16 v[148:151], v[232:235], v[240:243], 0
    ds_read_b64_tr_b16 v[220:221], v202 offset:4096
    v_mfma_f32_16x16x32_bf16 v[156:159], v[232:235], v[244:247], 0
    ds_read_b64_tr_b16 v[222:223], v202 offset:4608
    v_mfma_f32_16x16x32_bf16 v[164:167], v[232:235], v[248:251], 0
    v_add_u32 v193, 0xc000, v193
    v_mfma_f32_16x16x32_bf16 v[172:175], v[232:235], v[252:255], 0
    v_add_u32 v200, 0xc000, v200
    v_mfma_f32_16x16x32_bf16 v[180:183], v[236:239], v[240:243], 0
    v_add_u32 v201, 0xc000, v201
    v_mfma_f32_16x16x32_bf16 v[188:191], v[236:239], v[244:247], 0
    v_add_u32 v202, 0xc000, v202
    s_waitcnt lgkmcnt(6)
    v_mfma_f32_16x16x32_bf16 v[80:83], v[208:211], v[40:43], v[80:83]
    ds_read_b64_tr_b16 v[224:225], v203 offset:4096
    v_mfma_f32_16x16x32_bf16 v[88:91], v[208:211], v[44:47], v[88:91]
    ds_read_b64_tr_b16 v[226:227], v203 offset:4608
    v_mfma_f32_16x16x32_bf16 v[96:99], v[208:211], v[48:51], v[96:99]
    ds_read_b64_tr_b16 v[228:229], v204 offset:4096
    v_mfma_f32_16x16x32_bf16 v[104:107], v[208:211], v[52:55], v[104:107]
    ds_read_b64_tr_b16 v[230:231], v204 offset:4608
    s_waitcnt lgkmcnt(8)
    v_mfma_f32_16x16x32_bf16 v[112:115], v[212:215], v[40:43], v[112:115]
    ds_read_b64_tr_b16 v[232:233], v203 offset:12288
    v_mfma_f32_16x16x32_bf16 v[120:123], v[212:215], v[44:47], v[120:123]
    ds_read_b64_tr_b16 v[234:235], v203 offset:12800
    v_mfma_f32_16x16x32_bf16 v[128:131], v[212:215], v[48:51], v[128:131]
    ds_read_b64_tr_b16 v[236:237], v205 offset:4096
    v_mfma_f32_16x16x32_bf16 v[136:139], v[212:215], v[52:55], v[136:139]
    ds_read_b64_tr_b16 v[238:239], v205 offset:4608
    s_waitcnt lgkmcnt(8)
    v_mfma_f32_16x16x32_bf16 v[144:147], v[216:219], v[40:43], v[144:147]
    v_mfma_f32_16x16x32_bf16 v[152:155], v[216:219], v[44:47], v[152:155]
    v_add_u32 v195, 0xc000, v195
    v_mfma_f32_16x16x32_bf16 v[160:163], v[216:219], v[48:51], v[160:163]
    v_add_u32 v203, 0xc000, v203
    v_mfma_f32_16x16x32_bf16 v[168:171], v[216:219], v[52:55], v[168:171]
    v_add_u32 v204, 0xc000, v204
    v_mfma_f32_16x16x32_bf16 v[176:179], v[220:223], v[40:43], v[176:179]
    v_add_u32 v205, 0xc000, v205
    v_mfma_f32_16x16x32_bf16 v[184:187], v[220:223], v[44:47], v[184:187]
    s_waitcnt lgkmcnt(6)
    v_mfma_f32_16x16x32_bf16 v[84:87], v[224:227], v[40:43], v[84:87]
    v_mfma_f32_16x16x32_bf16 v[92:95], v[224:227], v[44:47], v[92:95]
    s_waitcnt lgkmcnt(0)
    s_barrier
    ds_read_b128 v[240:243], v192 offset:0
    v_mfma_f32_16x16x32_bf16 v[100:103], v[224:227], v[48:51], v[100:103]
    ds_read_b64_tr_b16 v[208:209], v200 offset:0
    v_mfma_f32_16x16x32_bf16 v[108:111], v[224:227], v[52:55], v[108:111]
    ds_read_b64_tr_b16 v[210:211], v200 offset:512
    v_mfma_f32_16x16x32_bf16 v[116:119], v[228:231], v[40:43], v[116:119]
    ds_read_b128 v[244:247], v192 offset:2048
    v_mfma_f32_16x16x32_bf16 v[124:127], v[228:231], v[44:47], v[124:127]
    ds_read_b128 v[248:251], v194 offset:0
    v_mfma_f32_16x16x32_bf16 v[132:135], v[228:231], v[48:51], v[132:135]
    ds_read_b128 v[252:255], v194 offset:2048
    v_mfma_f32_16x16x32_bf16 v[140:143], v[228:231], v[52:55], v[140:143]
    ds_read_b64_tr_b16 v[212:213], v201 offset:0
    v_mfma_f32_16x16x32_bf16 v[148:151], v[232:235], v[40:43], v[148:151]
    ds_read_b64_tr_b16 v[214:215], v201 offset:512
    v_mfma_f32_16x16x32_bf16 v[156:159], v[232:235], v[44:47], v[156:159]
    ds_read_b64_tr_b16 v[216:217], v200 offset:8192
    v_mfma_f32_16x16x32_bf16 v[164:167], v[232:235], v[48:51], v[164:167]
    ds_read_b64_tr_b16 v[218:219], v200 offset:8704
    v_mfma_f32_16x16x32_bf16 v[172:175], v[232:235], v[52:55], v[172:175]
    ds_read_b64_tr_b16 v[220:221], v202 offset:0
    v_mfma_f32_16x16x32_bf16 v[180:183], v[236:239], v[40:43], v[180:183]
    ds_read_b64_tr_b16 v[222:223], v202 offset:512
    v_mfma_f32_16x16x32_bf16 v[188:191], v[236:239], v[44:47], v[188:191]
    s_waitcnt lgkmcnt(8)
    v_mfma_f32_16x16x32_bf16 v[80:83], v[208:211], v[240:243], v[80:83]
    ds_read_b64_tr_b16 v[224:225], v203 offset:0
    v_mfma_f32_16x16x32_bf16 v[88:91], v[208:211], v[244:247], v[88:91]
    ds_read_b64_tr_b16 v[226:227], v203 offset:512
    s_waitcnt lgkmcnt(8)
    v_mfma_f32_16x16x32_bf16 v[96:99], v[208:211], v[248:251], v[96:99]
    ds_read_b64_tr_b16 v[228:229], v204 offset:0
    v_mfma_f32_16x16x32_bf16 v[104:107], v[208:211], v[252:255], v[104:107]
    ds_read_b64_tr_b16 v[230:231], v204 offset:512
    s_waitcnt lgkmcnt(8)
    v_mfma_f32_16x16x32_bf16 v[112:115], v[212:215], v[240:243], v[112:115]
    ds_read_b64_tr_b16 v[232:233], v203 offset:8192
    v_mfma_f32_16x16x32_bf16 v[120:123], v[212:215], v[244:247], v[120:123]
    ds_read_b64_tr_b16 v[234:235], v203 offset:8704
    v_mfma_f32_16x16x32_bf16 v[128:131], v[212:215], v[248:251], v[128:131]
    ds_read_b64_tr_b16 v[236:237], v205 offset:0
    v_mfma_f32_16x16x32_bf16 v[136:139], v[212:215], v[252:255], v[136:139]
    ds_read_b64_tr_b16 v[238:239], v205 offset:512
    s_waitcnt lgkmcnt(8)
    v_mfma_f32_16x16x32_bf16 v[144:147], v[216:219], v[240:243], v[144:147]
    ds_read_b128 v[40:43], v193 offset:0
    v_mfma_f32_16x16x32_bf16 v[152:155], v[216:219], v[244:247], v[152:155]
    ds_read_b128 v[44:47], v193 offset:2048
    v_mfma_f32_16x16x32_bf16 v[160:163], v[216:219], v[248:251], v[160:163]
    v_add_u32 v192, 0xfffe8000, v192
    v_mfma_f32_16x16x32_bf16 v[168:171], v[216:219], v[252:255], v[168:171]
    v_add_u32 v194, 0xfffe8000, v194
    v_mfma_f32_16x16x32_bf16 v[176:179], v[220:223], v[240:243], v[176:179]
    v_mfma_f32_16x16x32_bf16 v[184:187], v[220:223], v[244:247], v[184:187]
    s_waitcnt lgkmcnt(8)
    v_mfma_f32_16x16x32_bf16 v[84:87], v[224:227], v[240:243], v[84:87]
    ds_read_b128 v[48:51], v195 offset:0
    v_mfma_f32_16x16x32_bf16 v[92:95], v[224:227], v[244:247], v[92:95]
    ds_read_b128 v[52:55], v195 offset:2048
    v_mfma_f32_16x16x32_bf16 v[100:103], v[224:227], v[248:251], v[100:103]
    ds_read_b64_tr_b16 v[208:209], v200 offset:4096
    v_mfma_f32_16x16x32_bf16 v[108:111], v[224:227], v[252:255], v[108:111]
    ds_read_b64_tr_b16 v[210:211], v200 offset:4608
    s_waitcnt lgkmcnt(10)
    v_mfma_f32_16x16x32_bf16 v[116:119], v[228:231], v[240:243], v[116:119]
    ds_read_b64_tr_b16 v[212:213], v201 offset:4096
    v_mfma_f32_16x16x32_bf16 v[124:127], v[228:231], v[244:247], v[124:127]
    ds_read_b64_tr_b16 v[214:215], v201 offset:4608
    v_mfma_f32_16x16x32_bf16 v[132:135], v[228:231], v[248:251], v[132:135]
    ds_read_b64_tr_b16 v[216:217], v200 offset:12288
    v_mfma_f32_16x16x32_bf16 v[140:143], v[228:231], v[252:255], v[140:143]
    ds_read_b64_tr_b16 v[218:219], v200 offset:12800
    s_waitcnt lgkmcnt(10)
    v_mfma_f32_16x16x32_bf16 v[148:151], v[232:235], v[240:243], v[148:151]
    ds_read_b64_tr_b16 v[220:221], v202 offset:4096
    v_mfma_f32_16x16x32_bf16 v[156:159], v[232:235], v[244:247], v[156:159]
    ds_read_b64_tr_b16 v[222:223], v202 offset:4608
    v_mfma_f32_16x16x32_bf16 v[164:167], v[232:235], v[248:251], v[164:167]
    v_add_u32 v193, 0xfffe8000, v193
    v_mfma_f32_16x16x32_bf16 v[172:175], v[232:235], v[252:255], v[172:175]
    v_add_u32 v200, 0xfffe8000, v200
    v_mfma_f32_16x16x32_bf16 v[180:183], v[236:239], v[240:243], v[180:183]
    v_add_u32 v201, 0xfffe8000, v201
    v_mfma_f32_16x16x32_bf16 v[188:191], v[236:239], v[244:247], v[188:191]
    v_add_u32 v202, 0xfffe8000, v202
    s_waitcnt lgkmcnt(6)
    v_mfma_f32_16x16x32_bf16 v[80:83], v[208:211], v[40:43], v[80:83]
    ds_read_b64_tr_b16 v[224:225], v203 offset:4096
    v_mfma_f32_16x16x32_bf16 v[88:91], v[208:211], v[44:47], v[88:91]
    ds_read_b64_tr_b16 v[226:227], v203 offset:4608
    v_mfma_f32_16x16x32_bf16 v[96:99], v[208:211], v[48:51], v[96:99]
    ds_read_b64_tr_b16 v[228:229], v204 offset:4096
    v_mfma_f32_16x16x32_bf16 v[104:107], v[208:211], v[52:55], v[104:107]
    ds_read_b64_tr_b16 v[230:231], v204 offset:4608
    s_waitcnt lgkmcnt(8)
    v_mfma_f32_16x16x32_bf16 v[112:115], v[212:215], v[40:43], v[112:115]
    ds_read_b64_tr_b16 v[232:233], v203 offset:12288
    v_mfma_f32_16x16x32_bf16 v[120:123], v[212:215], v[44:47], v[120:123]
    ds_read_b64_tr_b16 v[234:235], v203 offset:12800
    v_mfma_f32_16x16x32_bf16 v[128:131], v[212:215], v[48:51], v[128:131]
    ds_read_b64_tr_b16 v[236:237], v205 offset:4096
    v_mfma_f32_16x16x32_bf16 v[136:139], v[212:215], v[52:55], v[136:139]
    ds_read_b64_tr_b16 v[238:239], v205 offset:4608
    s_waitcnt lgkmcnt(8)
    v_mfma_f32_16x16x32_bf16 v[144:147], v[216:219], v[40:43], v[144:147]
    v_mfma_f32_16x16x32_bf16 v[152:155], v[216:219], v[44:47], v[152:155]
    v_add_u32 v195, 0xfffe8000, v195
    v_mfma_f32_16x16x32_bf16 v[160:163], v[216:219], v[48:51], v[160:163]
    v_add_u32 v203, 0xfffe8000, v203
    v_mfma_f32_16x16x32_bf16 v[168:171], v[216:219], v[52:55], v[168:171]
    v_add_u32 v204, 0xfffe8000, v204
    v_mfma_f32_16x16x32_bf16 v[176:179], v[220:223], v[40:43], v[176:179]
    v_add_u32 v205, 0xfffe8000, v205
    v_mfma_f32_16x16x32_bf16 v[184:187], v[220:223], v[44:47], v[184:187]
    s_waitcnt lgkmcnt(6)
    v_mfma_f32_16x16x32_bf16 v[84:87], v[224:227], v[40:43], v[84:87]
    v_mfma_f32_16x16x32_bf16 v[92:95], v[224:227], v[44:47], v[92:95]
    s_waitcnt lgkmcnt(0)
    s_barrier
    ds_read_b128 v[240:243], v192 offset:0
    v_mfma_f32_16x16x32_bf16 v[100:103], v[224:227], v[48:51], v[100:103]
    ds_read_b64_tr_b16 v[208:209], v200 offset:0
    v_mfma_f32_16x16x32_bf16 v[108:111], v[224:227], v[52:55], v[108:111]
    ds_read_b64_tr_b16 v[210:211], v200 offset:512
    v_mfma_f32_16x16x32_bf16 v[116:119], v[228:231], v[40:43], v[116:119]
    ds_read_b128 v[244:247], v192 offset:2048
    v_mfma_f32_16x16x32_bf16 v[124:127], v[228:231], v[44:47], v[124:127]
    ds_read_b128 v[248:251], v194 offset:0
    v_mfma_f32_16x16x32_bf16 v[132:135], v[228:231], v[48:51], v[132:135]
    ds_read_b128 v[252:255], v194 offset:2048
    v_mfma_f32_16x16x32_bf16 v[140:143], v[228:231], v[52:55], v[140:143]
    ds_read_b64_tr_b16 v[212:213], v201 offset:0
    v_mfma_f32_16x16x32_bf16 v[148:151], v[232:235], v[40:43], v[148:151]
    ds_read_b64_tr_b16 v[214:215], v201 offset:512
    v_mfma_f32_16x16x32_bf16 v[156:159], v[232:235], v[44:47], v[156:159]
    ds_read_b64_tr_b16 v[216:217], v200 offset:8192
    v_mfma_f32_16x16x32_bf16 v[164:167], v[232:235], v[48:51], v[164:167]
    ds_read_b64_tr_b16 v[218:219], v200 offset:8704
    v_mfma_f32_16x16x32_bf16 v[172:175], v[232:235], v[52:55], v[172:175]
    ds_read_b64_tr_b16 v[220:221], v202 offset:0
    v_mfma_f32_16x16x32_bf16 v[180:183], v[236:239], v[40:43], v[180:183]
    ds_read_b64_tr_b16 v[222:223], v202 offset:512
    v_mfma_f32_16x16x32_bf16 v[188:191], v[236:239], v[44:47], v[188:191]
    s_waitcnt lgkmcnt(8)
    v_mfma_f32_16x16x32_bf16 v[80:83], v[208:211], v[240:243], v[80:83]
    ds_read_b64_tr_b16 v[224:225], v203 offset:0
    v_mfma_f32_16x16x32_bf16 v[88:91], v[208:211], v[244:247], v[88:91]
    ds_read_b64_tr_b16 v[226:227], v203 offset:512
    s_waitcnt lgkmcnt(8)
    v_mfma_f32_16x16x32_bf16 v[96:99], v[208:211], v[248:251], v[96:99]
    ds_read_b64_tr_b16 v[228:229], v204 offset:0
    v_mfma_f32_16x16x32_bf16 v[104:107], v[208:211], v[252:255], v[104:107]
    ds_read_b64_tr_b16 v[230:231], v204 offset:512
    s_waitcnt lgkmcnt(8)
    v_mfma_f32_16x16x32_bf16 v[112:115], v[212:215], v[240:243], v[112:115]
    ds_read_b64_tr_b16 v[232:233], v203 offset:8192
    v_mfma_f32_16x16x32_bf16 v[120:123], v[212:215], v[244:247], v[120:123]
    ds_read_b64_tr_b16 v[234:235], v203 offset:8704
    v_mfma_f32_16x16x32_bf16 v[128:131], v[212:215], v[248:251], v[128:131]
    ds_read_b64_tr_b16 v[236:237], v205 offset:0
    v_mfma_f32_16x16x32_bf16 v[136:139], v[212:215], v[252:255], v[136:139]
    ds_read_b64_tr_b16 v[238:239], v205 offset:512
    s_waitcnt lgkmcnt(8)
    v_mfma_f32_16x16x32_bf16 v[144:147], v[216:219], v[240:243], v[144:147]
    ds_read_b128 v[40:43], v193 offset:0
    v_mfma_f32_16x16x32_bf16 v[152:155], v[216:219], v[244:247], v[152:155]
    ds_read_b128 v[44:47], v193 offset:2048
    v_mfma_f32_16x16x32_bf16 v[160:163], v[216:219], v[248:251], v[160:163]
    v_add_u32 v192, 0xc000, v192
    v_mfma_f32_16x16x32_bf16 v[168:171], v[216:219], v[252:255], v[168:171]
    v_add_u32 v194, 0xc000, v194
    v_mfma_f32_16x16x32_bf16 v[176:179], v[220:223], v[240:243], v[176:179]
    v_mfma_f32_16x16x32_bf16 v[184:187], v[220:223], v[244:247], v[184:187]
    s_waitcnt lgkmcnt(8)
    v_mfma_f32_16x16x32_bf16 v[84:87], v[224:227], v[240:243], v[84:87]
    ds_read_b128 v[48:51], v195 offset:0
    v_mfma_f32_16x16x32_bf16 v[92:95], v[224:227], v[244:247], v[92:95]
    ds_read_b128 v[52:55], v195 offset:2048
    v_mfma_f32_16x16x32_bf16 v[100:103], v[224:227], v[248:251], v[100:103]
    ds_read_b64_tr_b16 v[208:209], v200 offset:4096
    v_mfma_f32_16x16x32_bf16 v[108:111], v[224:227], v[252:255], v[108:111]
    ds_read_b64_tr_b16 v[210:211], v200 offset:4608
    s_waitcnt lgkmcnt(10)
    v_mfma_f32_16x16x32_bf16 v[116:119], v[228:231], v[240:243], v[116:119]
    ds_read_b64_tr_b16 v[212:213], v201 offset:4096
    v_mfma_f32_16x16x32_bf16 v[124:127], v[228:231], v[244:247], v[124:127]
    ds_read_b64_tr_b16 v[214:215], v201 offset:4608
    v_mfma_f32_16x16x32_bf16 v[132:135], v[228:231], v[248:251], v[132:135]
    ds_read_b64_tr_b16 v[216:217], v200 offset:12288
    v_mfma_f32_16x16x32_bf16 v[140:143], v[228:231], v[252:255], v[140:143]
    ds_read_b64_tr_b16 v[218:219], v200 offset:12800
    s_waitcnt lgkmcnt(10)
    v_mfma_f32_16x16x32_bf16 v[148:151], v[232:235], v[240:243], v[148:151]
    ds_read_b64_tr_b16 v[220:221], v202 offset:4096
    v_mfma_f32_16x16x32_bf16 v[156:159], v[232:235], v[244:247], v[156:159]
    ds_read_b64_tr_b16 v[222:223], v202 offset:4608
    v_mfma_f32_16x16x32_bf16 v[164:167], v[232:235], v[248:251], v[164:167]
    v_add_u32 v193, 0xc000, v193
    v_mfma_f32_16x16x32_bf16 v[172:175], v[232:235], v[252:255], v[172:175]
    v_add_u32 v200, 0xc000, v200
    v_mfma_f32_16x16x32_bf16 v[180:183], v[236:239], v[240:243], v[180:183]
    v_add_u32 v201, 0xc000, v201
    v_mfma_f32_16x16x32_bf16 v[188:191], v[236:239], v[244:247], v[188:191]
    v_add_u32 v202, 0xc000, v202
    s_waitcnt lgkmcnt(6)
    v_mfma_f32_16x16x32_bf16 v[80:83], v[208:211], v[40:43], v[80:83]
    ds_read_b64_tr_b16 v[224:225], v203 offset:4096
    v_mfma_f32_16x16x32_bf16 v[88:91], v[208:211], v[44:47], v[88:91]
    ds_read_b64_tr_b16 v[226:227], v203 offset:4608
    v_mfma_f32_16x16x32_bf16 v[96:99], v[208:211], v[48:51], v[96:99]
    ds_read_b64_tr_b16 v[228:229], v204 offset:4096
    v_mfma_f32_16x16x32_bf16 v[104:107], v[208:211], v[52:55], v[104:107]
    ds_read_b64_tr_b16 v[230:231], v204 offset:4608
    s_waitcnt lgkmcnt(8)
    v_mfma_f32_16x16x32_bf16 v[112:115], v[212:215], v[40:43], v[112:115]
    ds_read_b64_tr_b16 v[232:233], v203 offset:12288
    v_mfma_f32_16x16x32_bf16 v[120:123], v[212:215], v[44:47], v[120:123]
    ds_read_b64_tr_b16 v[234:235], v203 offset:12800
    v_mfma_f32_16x16x32_bf16 v[128:131], v[212:215], v[48:51], v[128:131]
    ds_read_b64_tr_b16 v[236:237], v205 offset:4096
    v_mfma_f32_16x16x32_bf16 v[136:139], v[212:215], v[52:55], v[136:139]
    ds_read_b64_tr_b16 v[238:239], v205 offset:4608
    s_waitcnt lgkmcnt(8)
    v_mfma_f32_16x16x32_bf16 v[144:147], v[216:219], v[40:43], v[144:147]
    v_mfma_f32_16x16x32_bf16 v[152:155], v[216:219], v[44:47], v[152:155]
    v_add_u32 v195, 0xc000, v195
    v_mfma_f32_16x16x32_bf16 v[160:163], v[216:219], v[48:51], v[160:163]
    v_add_u32 v203, 0xc000, v203
    v_mfma_f32_16x16x32_bf16 v[168:171], v[216:219], v[52:55], v[168:171]
    v_add_u32 v204, 0xc000, v204
    v_mfma_f32_16x16x32_bf16 v[176:179], v[220:223], v[40:43], v[176:179]
    v_add_u32 v205, 0xc000, v205
    v_mfma_f32_16x16x32_bf16 v[184:187], v[220:223], v[44:47], v[184:187]
    s_waitcnt lgkmcnt(6)
    v_mfma_f32_16x16x32_bf16 v[84:87], v[224:227], v[40:43], v[84:87]
    v_mfma_f32_16x16x32_bf16 v[92:95], v[224:227], v[44:47], v[92:95]
    s_waitcnt lgkmcnt(0)
    s_barrier
    ds_read_b128 v[240:243], v192 offset:0
    v_mfma_f32_16x16x32_bf16 v[100:103], v[224:227], v[48:51], v[100:103]
    ds_read_b64_tr_b16 v[208:209], v200 offset:0
    v_mfma_f32_16x16x32_bf16 v[108:111], v[224:227], v[52:55], v[108:111]
    ds_read_b64_tr_b16 v[210:211], v200 offset:512
    v_mfma_f32_16x16x32_bf16 v[116:119], v[228:231], v[40:43], v[116:119]
    ds_read_b128 v[244:247], v192 offset:2048
    v_mfma_f32_16x16x32_bf16 v[124:127], v[228:231], v[44:47], v[124:127]
    ds_read_b128 v[248:251], v194 offset:0
    s_load_dword s60, s[34:35], 0
    v_mfma_f32_16x16x32_bf16 v[132:135], v[228:231], v[48:51], v[132:135]
    ds_read_b128 v[252:255], v194 offset:2048
    v_mfma_f32_16x16x32_bf16 v[140:143], v[228:231], v[52:55], v[140:143]
    ds_read_b64_tr_b16 v[212:213], v201 offset:0
    v_mfma_f32_16x16x32_bf16 v[148:151], v[232:235], v[40:43], v[148:151]
    ds_read_b64_tr_b16 v[214:215], v201 offset:512
    v_mfma_f32_16x16x32_bf16 v[156:159], v[232:235], v[44:47], v[156:159]
    ds_read_b64_tr_b16 v[216:217], v200 offset:8192
    v_mfma_f32_16x16x32_bf16 v[164:167], v[232:235], v[48:51], v[164:167]
    ds_read_b64_tr_b16 v[218:219], v200 offset:8704
    v_mfma_f32_16x16x32_bf16 v[172:175], v[232:235], v[52:55], v[172:175]
    ds_read_b64_tr_b16 v[220:221], v202 offset:0
    v_mfma_f32_16x16x32_bf16 v[180:183], v[236:239], v[40:43], v[180:183]
    ds_read_b64_tr_b16 v[222:223], v202 offset:512
    v_mfma_f32_16x16x32_bf16 v[188:191], v[236:239], v[44:47], v[188:191]
    s_waitcnt lgkmcnt(8)
    v_mfma_f32_16x16x32_bf16 v[80:83], v[208:211], v[240:243], v[80:83]
    ds_read_b64_tr_b16 v[224:225], v203 offset:0
    v_mfma_f32_16x16x32_bf16 v[88:91], v[208:211], v[244:247], v[88:91]
    ds_read_b64_tr_b16 v[226:227], v203 offset:512
    s_waitcnt lgkmcnt(8)
    v_mfma_f32_16x16x32_bf16 v[96:99], v[208:211], v[248:251], v[96:99]
    ds_read_b64_tr_b16 v[228:229], v204 offset:0
    v_mfma_f32_16x16x32_bf16 v[104:107], v[208:211], v[252:255], v[104:107]
    ds_read_b64_tr_b16 v[230:231], v204 offset:512
    s_waitcnt lgkmcnt(8)
    v_mfma_f32_16x16x32_bf16 v[112:115], v[212:215], v[240:243], v[112:115]
    ds_read_b64_tr_b16 v[232:233], v203 offset:8192
    v_mfma_f32_16x16x32_bf16 v[120:123], v[212:215], v[244:247], v[120:123]
    ds_read_b64_tr_b16 v[234:235], v203 offset:8704
    v_mfma_f32_16x16x32_bf16 v[128:131], v[212:215], v[248:251], v[128:131]
    ds_read_b64_tr_b16 v[236:237], v205 offset:0
    v_mfma_f32_16x16x32_bf16 v[136:139], v[212:215], v[252:255], v[136:139]
    ds_read_b64_tr_b16 v[238:239], v205 offset:512
    s_waitcnt lgkmcnt(8)
    v_mfma_f32_16x16x32_bf16 v[144:147], v[216:219], v[240:243], v[144:147]
    ds_read_b128 v[40:43], v193 offset:0
    v_mfma_f32_16x16x32_bf16 v[152:155], v[216:219], v[244:247], v[152:155]
    ds_read_b128 v[44:47], v193 offset:2048
    v_mfma_f32_16x16x32_bf16 v[160:163], v[216:219], v[248:251], v[160:163]
    v_add_u32 v192, 0xc000, v192
    v_mfma_f32_16x16x32_bf16 v[168:171], v[216:219], v[252:255], v[168:171]
    v_add_u32 v194, 0xc000, v194
    v_mfma_f32_16x16x32_bf16 v[176:179], v[220:223], v[240:243], v[176:179]
    v_mfma_f32_16x16x32_bf16 v[184:187], v[220:223], v[244:247], v[184:187]
    s_waitcnt lgkmcnt(8)
    v_mfma_f32_16x16x32_bf16 v[84:87], v[224:227], v[240:243], v[84:87]
    ds_read_b128 v[48:51], v195 offset:0
    v_mfma_f32_16x16x32_bf16 v[92:95], v[224:227], v[244:247], v[92:95]
    ds_read_b128 v[52:55], v195 offset:2048
    v_mfma_f32_16x16x32_bf16 v[100:103], v[224:227], v[248:251], v[100:103]
    ds_read_b64_tr_b16 v[208:209], v200 offset:4096
    v_mfma_f32_16x16x32_bf16 v[108:111], v[224:227], v[252:255], v[108:111]
    ds_read_b64_tr_b16 v[210:211], v200 offset:4608
    s_waitcnt lgkmcnt(10)
    v_mfma_f32_16x16x32_bf16 v[116:119], v[228:231], v[240:243], v[116:119]
    ds_read_b64_tr_b16 v[212:213], v201 offset:4096
    v_mfma_f32_16x16x32_bf16 v[124:127], v[228:231], v[244:247], v[124:127]
    ds_read_b64_tr_b16 v[214:215], v201 offset:4608
    v_mfma_f32_16x16x32_bf16 v[132:135], v[228:231], v[248:251], v[132:135]
    ds_read_b64_tr_b16 v[216:217], v200 offset:12288
    v_mfma_f32_16x16x32_bf16 v[140:143], v[228:231], v[252:255], v[140:143]
    ds_read_b64_tr_b16 v[218:219], v200 offset:12800
    s_waitcnt lgkmcnt(10)
    v_mfma_f32_16x16x32_bf16 v[148:151], v[232:235], v[240:243], v[148:151]
    ds_read_b64_tr_b16 v[220:221], v202 offset:4096
    v_mfma_f32_16x16x32_bf16 v[156:159], v[232:235], v[244:247], v[156:159]
    ds_read_b64_tr_b16 v[222:223], v202 offset:4608
    v_mfma_f32_16x16x32_bf16 v[164:167], v[232:235], v[248:251], v[164:167]
    v_add_u32 v193, 0xc000, v193
    v_mfma_f32_16x16x32_bf16 v[172:175], v[232:235], v[252:255], v[172:175]
    v_add_u32 v200, 0xc000, v200
    v_mfma_f32_16x16x32_bf16 v[180:183], v[236:239], v[240:243], v[180:183]
    v_add_u32 v201, 0xc000, v201
    v_mfma_f32_16x16x32_bf16 v[188:191], v[236:239], v[244:247], v[188:191]
    v_add_u32 v202, 0xc000, v202
    s_waitcnt lgkmcnt(6)
    v_mfma_f32_16x16x32_bf16 v[80:83], v[208:211], v[40:43], v[80:83]
    ds_read_b64_tr_b16 v[224:225], v203 offset:4096
    v_mfma_f32_16x16x32_bf16 v[88:91], v[208:211], v[44:47], v[88:91]
    ds_read_b64_tr_b16 v[226:227], v203 offset:4608
    v_mfma_f32_16x16x32_bf16 v[96:99], v[208:211], v[48:51], v[96:99]
    ds_read_b64_tr_b16 v[228:229], v204 offset:4096
    v_mfma_f32_16x16x32_bf16 v[104:107], v[208:211], v[52:55], v[104:107]
    ds_read_b64_tr_b16 v[230:231], v204 offset:4608
    s_waitcnt lgkmcnt(8)
    v_mfma_f32_16x16x32_bf16 v[112:115], v[212:215], v[40:43], v[112:115]
    ds_read_b64_tr_b16 v[232:233], v203 offset:12288
    v_mfma_f32_16x16x32_bf16 v[120:123], v[212:215], v[44:47], v[120:123]
    ds_read_b64_tr_b16 v[234:235], v203 offset:12800
    v_mfma_f32_16x16x32_bf16 v[128:131], v[212:215], v[48:51], v[128:131]
    ds_read_b64_tr_b16 v[236:237], v205 offset:4096
    v_mfma_f32_16x16x32_bf16 v[136:139], v[212:215], v[52:55], v[136:139]
    ds_read_b64_tr_b16 v[238:239], v205 offset:4608
    s_waitcnt lgkmcnt(8)
    v_mfma_f32_16x16x32_bf16 v[144:147], v[216:219], v[40:43], v[144:147]
    v_mfma_f32_16x16x32_bf16 v[152:155], v[216:219], v[44:47], v[152:155]
    v_add_u32 v195, 0xc000, v195
    v_mfma_f32_16x16x32_bf16 v[160:163], v[216:219], v[48:51], v[160:163]
    v_add_u32 v203, 0xc000, v203
    v_mfma_f32_16x16x32_bf16 v[168:171], v[216:219], v[52:55], v[168:171]
    v_add_u32 v204, 0xc000, v204
    v_mfma_f32_16x16x32_bf16 v[176:179], v[220:223], v[40:43], v[176:179]
    v_add_u32 v205, 0xc000, v205
    v_mfma_f32_16x16x32_bf16 v[184:187], v[220:223], v[44:47], v[184:187]
    s_waitcnt lgkmcnt(6)
    v_mfma_f32_16x16x32_bf16 v[84:87], v[224:227], v[40:43], v[84:87]
    v_mfma_f32_16x16x32_bf16 v[92:95], v[224:227], v[44:47], v[92:95]
    s_waitcnt lgkmcnt(0)
    s_barrier
    ds_read_b128 v[240:243], v192 offset:0
    v_mfma_f32_16x16x32_bf16 v[100:103], v[224:227], v[48:51], v[100:103]
    ds_read_b64_tr_b16 v[208:209], v200 offset:0
    v_mfma_f32_16x16x32_bf16 v[108:111], v[224:227], v[52:55], v[108:111]
    ds_read_b64_tr_b16 v[210:211], v200 offset:512
    v_mfma_f32_16x16x32_bf16 v[116:119], v[228:231], v[40:43], v[116:119]
    ds_read_b128 v[244:247], v192 offset:2048
    v_mfma_f32_16x16x32_bf16 v[124:127], v[228:231], v[44:47], v[124:127]
    ds_read_b128 v[248:251], v194 offset:0
    v_mfma_f32_16x16x32_bf16 v[132:135], v[228:231], v[48:51], v[132:135]
    ds_read_b128 v[252:255], v194 offset:2048
    v_mfma_f32_16x16x32_bf16 v[140:143], v[228:231], v[52:55], v[140:143]
    ds_read_b64_tr_b16 v[212:213], v201 offset:0
    v_mfma_f32_16x16x32_bf16 v[148:151], v[232:235], v[40:43], v[148:151]
    ds_read_b64_tr_b16 v[214:215], v201 offset:512
    v_mfma_f32_16x16x32_bf16 v[156:159], v[232:235], v[44:47], v[156:159]
    ds_read_b64_tr_b16 v[216:217], v200 offset:8192
    v_mfma_f32_16x16x32_bf16 v[164:167], v[232:235], v[48:51], v[164:167]
    ds_read_b64_tr_b16 v[218:219], v200 offset:8704
    v_mfma_f32_16x16x32_bf16 v[172:175], v[232:235], v[52:55], v[172:175]
    ds_read_b64_tr_b16 v[220:221], v202 offset:0
    v_mfma_f32_16x16x32_bf16 v[180:183], v[236:239], v[40:43], v[180:183]
    ds_read_b64_tr_b16 v[222:223], v202 offset:512
    v_mfma_f32_16x16x32_bf16 v[188:191], v[236:239], v[44:47], v[188:191]
    s_waitcnt lgkmcnt(8)
    v_mfma_f32_16x16x32_bf16 v[80:83], v[208:211], v[240:243], v[80:83]
    ds_read_b64_tr_b16 v[224:225], v203 offset:0
    v_mfma_f32_16x16x32_bf16 v[88:91], v[208:211], v[244:247], v[88:91]
    ds_read_b64_tr_b16 v[226:227], v203 offset:512
    s_waitcnt lgkmcnt(8)
    v_mfma_f32_16x16x32_bf16 v[96:99], v[208:211], v[248:251], v[96:99]
    ds_read_b64_tr_b16 v[228:229], v204 offset:0
    v_mfma_f32_16x16x32_bf16 v[104:107], v[208:211], v[252:255], v[104:107]
    ds_read_b64_tr_b16 v[230:231], v204 offset:512
    s_waitcnt lgkmcnt(8)
    v_mfma_f32_16x16x32_bf16 v[112:115], v[212:215], v[240:243], v[112:115]
    ds_read_b64_tr_b16 v[232:233], v203 offset:8192
    v_mfma_f32_16x16x32_bf16 v[120:123], v[212:215], v[244:247], v[120:123]
    ds_read_b64_tr_b16 v[234:235], v203 offset:8704
    v_mfma_f32_16x16x32_bf16 v[128:131], v[212:215], v[248:251], v[128:131]
    ds_read_b64_tr_b16 v[236:237], v205 offset:0
    v_mfma_f32_16x16x32_bf16 v[136:139], v[212:215], v[252:255], v[136:139]
    ds_read_b64_tr_b16 v[238:239], v205 offset:512
    s_waitcnt lgkmcnt(8)
    v_mfma_f32_16x16x32_bf16 v[144:147], v[216:219], v[240:243], v[144:147]
    ds_read_b128 v[40:43], v193 offset:0
    v_mfma_f32_16x16x32_bf16 v[152:155], v[216:219], v[244:247], v[152:155]
    ds_read_b128 v[44:47], v193 offset:2048
    v_mfma_f32_16x16x32_bf16 v[160:163], v[216:219], v[248:251], v[160:163]
    v_add_u32 v192, 0xfffe8000, v192
    v_mfma_f32_16x16x32_bf16 v[168:171], v[216:219], v[252:255], v[168:171]
    s_cmp_eq_u32 s60, 0
    s_cselect_b64 vcc, -1, 0
    s_cbranch_vccnz SL_41
SE_42:
    v_add_u32 v194, 0xfffe8000, v194
    v_mfma_f32_16x16x32_bf16 v[176:179], v[220:223], v[240:243], v[176:179]
    v_mfma_f32_16x16x32_bf16 v[184:187], v[220:223], v[244:247], v[184:187]
    s_waitcnt lgkmcnt(8)
    v_mfma_f32_16x16x32_bf16 v[84:87], v[224:227], v[240:243], v[84:87]
    ds_read_b128 v[48:51], v195 offset:0
    v_mfma_f32_16x16x32_bf16 v[92:95], v[224:227], v[244:247], v[92:95]
    ds_read_b128 v[52:55], v195 offset:2048
    v_mfma_f32_16x16x32_bf16 v[100:103], v[224:227], v[248:251], v[100:103]
    ds_read_b64_tr_b16 v[208:209], v200 offset:4096
    v_mfma_f32_16x16x32_bf16 v[108:111], v[224:227], v[252:255], v[108:111]
    ds_read_b64_tr_b16 v[210:211], v200 offset:4608
    s_waitcnt lgkmcnt(10)
    v_mfma_f32_16x16x32_bf16 v[116:119], v[228:231], v[240:243], v[116:119]
    ds_read_b64_tr_b16 v[212:213], v201 offset:4096
    v_mfma_f32_16x16x32_bf16 v[124:127], v[228:231], v[244:247], v[124:127]
    ds_read_b64_tr_b16 v[214:215], v201 offset:4608
    v_mfma_f32_16x16x32_bf16 v[132:135], v[228:231], v[248:251], v[132:135]
    ds_read_b64_tr_b16 v[216:217], v200 offset:12288
    v_mfma_f32_16x16x32_bf16 v[140:143], v[228:231], v[252:255], v[140:143]
    ds_read_b64_tr_b16 v[218:219], v200 offset:12800
    s_waitcnt lgkmcnt(10)
    v_mfma_f32_16x16x32_bf16 v[148:151], v[232:235], v[240:243], v[148:151]
    ds_read_b64_tr_b16 v[220:221], v202 offset:4096
    v_mfma_f32_16x16x32_bf16 v[156:159], v[232:235], v[244:247], v[156:159]
    ds_read_b64_tr_b16 v[222:223], v202 offset:4608
    v_mfma_f32_16x16x32_bf16 v[164:167], v[232:235], v[248:251], v[164:167]
    v_add_u32 v193, 0xfffe8000, v193
    v_mfma_f32_16x16x32_bf16 v[172:175], v[232:235], v[252:255], v[172:175]
    v_add_u32 v200, 0xfffe8000, v200
    v_mfma_f32_16x16x32_bf16 v[180:183], v[236:239], v[240:243], v[180:183]
    v_add_u32 v201, 0xfffe8000, v201
    v_mfma_f32_16x16x32_bf16 v[188:191], v[236:239], v[244:247], v[188:191]
    v_add_u32 v202, 0xfffe8000, v202
    s_waitcnt lgkmcnt(6)
    v_mfma_f32_16x16x32_bf16 v[80:83], v[208:211], v[40:43], v[80:83]
    ds_read_b64_tr_b16 v[224:225], v203 offset:4096
    v_mfma_f32_16x16x32_bf16 v[88:91], v[208:211], v[44:47], v[88:91]
    ds_read_b64_tr_b16 v[226:227], v203 offset:4608
    v_mfma_f32_16x16x32_bf16 v[96:99], v[208:211], v[48:51], v[96:99]
    ds_read_b64_tr_b16 v[228:229], v204 offset:4096
    v_mfma_f32_16x16x32_bf16 v[104:107], v[208:211], v[52:55], v[104:107]
    ds_read_b64_tr_b16 v[230:231], v204 offset:4608
    s_waitcnt lgkmcnt(8)
    v_mfma_f32_16x16x32_bf16 v[112:115], v[212:215], v[40:43], v[112:115]
    ds_read_b64_tr_b16 v[232:233], v203 offset:12288
    v_mfma_f32_16x16x32_bf16 v[120:123], v[212:215], v[44:47], v[120:123]
    ds_read_b64_tr_b16 v[234:235], v203 offset:12800
    v_mfma_f32_16x16x32_bf16 v[128:131], v[212:215], v[48:51], v[128:131]
    ds_read_b64_tr_b16 v[236:237], v205 offset:4096
    v_mfma_f32_16x16x32_bf16 v[136:139], v[212:215], v[52:55], v[136:139]
    ds_read_b64_tr_b16 v[238:239], v205 offset:4608
    s_waitcnt lgkmcnt(8)
    v_mfma_f32_16x16x32_bf16 v[144:147], v[216:219], v[40:43], v[144:147]
    v_mfma_f32_16x16x32_bf16 v[152:155], v[216:219], v[44:47], v[152:155]
    v_add_u32 v195, 0xfffe8000, v195
    v_mfma_f32_16x16x32_bf16 v[160:163], v[216:219], v[48:51], v[160:163]
    v_add_u32 v203, 0xfffe8000, v203
    v_mfma_f32_16x16x32_bf16 v[168:171], v[216:219], v[52:55], v[168:171]
    v_add_u32 v204, 0xfffe8000, v204
    v_mfma_f32_16x16x32_bf16 v[176:179], v[220:223], v[40:43], v[176:179]
    v_add_u32 v205, 0xfffe8000, v205
    v_mfma_f32_16x16x32_bf16 v[184:187], v[220:223], v[44:47], v[184:187]
    s_waitcnt lgkmcnt(6)
    v_mfma_f32_16x16x32_bf16 v[84:87], v[224:227], v[40:43], v[84:87]
    v_mfma_f32_16x16x32_bf16 v[92:95], v[224:227], v[44:47], v[92:95]
    s_waitcnt lgkmcnt(0)
    s_barrier
    ds_read_b128 v[240:243], v192 offset:0
    v_mfma_f32_16x16x32_bf16 v[100:103], v[224:227], v[48:51], v[100:103]
    ds_read_b64_tr_b16 v[208:209], v200 offset:0
    v_mfma_f32_16x16x32_bf16 v[108:111], v[224:227], v[52:55], v[108:111]
    ds_read_b64_tr_b16 v[210:211], v200 offset:512
    v_mfma_f32_16x16x32_bf16 v[116:119], v[228:231], v[40:43], v[116:119]
    ds_read_b128 v[244:247], v192 offset:2048
    v_mfma_f32_16x16x32_bf16 v[124:127], v[228:231], v[44:47], v[124:127]
    ds_read_b128 v[248:251], v194 offset:0
    v_mfma_f32_16x16x32_bf16 v[132:135], v[228:231], v[48:51], v[132:135]
    ds_read_b128 v[252:255], v194 offset:2048
    v_mfma_f32_16x16x32_bf16 v[140:143], v[228:231], v[52:55], v[140:143]
    ds_read_b64_tr_b16 v[212:213], v201 offset:0
    v_mfma_f32_16x16x32_bf16 v[148:151], v[232:235], v[40:43], v[148:151]
    ds_read_b64_tr_b16 v[214:215], v201 offset:512
    v_mfma_f32_16x16x32_bf16 v[156:159], v[232:235], v[44:47], v[156:159]
    ds_read_b64_tr_b16 v[216:217], v200 offset:8192
    v_mfma_f32_16x16x32_bf16 v[164:167], v[232:235], v[48:51], v[164:167]
    ds_read_b64_tr_b16 v[218:219], v200 offset:8704
    v_mfma_f32_16x16x32_bf16 v[172:175], v[232:235], v[52:55], v[172:175]
    ds_read_b64_tr_b16 v[220:221], v202 offset:0
    v_mfma_f32_16x16x32_bf16 v[180:183], v[236:239], v[40:43], v[180:183]
    ds_read_b64_tr_b16 v[222:223], v202 offset:512
    v_mfma_f32_16x16x32_bf16 v[188:191], v[236:239], v[44:47], v[188:191]
    s_waitcnt lgkmcnt(8)
    v_mfma_f32_16x16x32_bf16 v[80:83], v[208:211], v[240:243], v[80:83]
    ds_read_b64_tr_b16 v[224:225], v203 offset:0
    v_mfma_f32_16x16x32_bf16 v[88:91], v[208:211], v[244:247], v[88:91]
    ds_read_b64_tr_b16 v[226:227], v203 offset:512
    s_waitcnt lgkmcnt(8)
    v_mfma_f32_16x16x32_bf16 v[96:99], v[208:211], v[248:251], v[96:99]
    ds_read_b64_tr_b16 v[228:229], v204 offset:0
    v_mfma_f32_16x16x32_bf16 v[104:107], v[208:211], v[252:255], v[104:107]
    ds_read_b64_tr_b16 v[230:231], v204 offset:512
    s_waitcnt lgkmcnt(8)
    v_mfma_f32_16x16x32_bf16 v[112:115], v[212:215], v[240:243], v[112:115]
    ds_read_b64_tr_b16 v[232:233], v203 offset:8192
    v_mfma_f32_16x16x32_bf16 v[120:123], v[212:215], v[244:247], v[120:123]
    ds_read_b64_tr_b16 v[234:235], v203 offset:8704
    v_mfma_f32_16x16x32_bf16 v[128:131], v[212:215], v[248:251], v[128:131]
    ds_read_b64_tr_b16 v[236:237], v205 offset:0
    v_mfma_f32_16x16x32_bf16 v[136:139], v[212:215], v[252:255], v[136:139]
    ds_read_b64_tr_b16 v[238:239], v205 offset:512
    s_waitcnt lgkmcnt(8)
    v_mfma_f32_16x16x32_bf16 v[144:147], v[216:219], v[240:243], v[144:147]
    ds_read_b128 v[40:43], v193 offset:0
    v_mfma_f32_16x16x32_bf16 v[152:155], v[216:219], v[244:247], v[152:155]
    ds_read_b128 v[44:47], v193 offset:2048
    v_mfma_f32_16x16x32_bf16 v[160:163], v[216:219], v[248:251], v[160:163]
    v_add_u32 v192, 0xc000, v192
    v_mfma_f32_16x16x32_bf16 v[168:171], v[216:219], v[252:255], v[168:171]
    v_add_u32 v194, 0xc000, v194
    v_mfma_f32_16x16x32_bf16 v[176:179], v[220:223], v[240:243], v[176:179]
    v_mfma_f32_16x16x32_bf16 v[184:187], v[220:223], v[244:247], v[184:187]
    s_waitcnt lgkmcnt(8)
    v_mfma_f32_16x16x32_bf16 v[84:87], v[224:227], v[240:243], v[84:87]
    ds_read_b128 v[48:51], v195 offset:0
    v_mfma_f32_16x16x32_bf16 v[92:95], v[224:227], v[244:247], v[92:95]
    ds_read_b128 v[52:55], v195 offset:2048
    v_mfma_f32_16x16x32_bf16 v[100:103], v[224:227], v[248:251], v[100:103]
    ds_read_b64_tr_b16 v[208:209], v200 offset:4096
    v_mfma_f32_16x16x32_bf16 v[108:111], v[224:227], v[252:255], v[108:111]
    ds_read_b64_tr_b16 v[210:211], v200 offset:4608
    s_waitcnt lgkmcnt(10)
    v_mfma_f32_16x16x32_bf16 v[116:119], v[228:231], v[240:243], v[116:119]
    ds_read_b64_tr_b16 v[212:213], v201 offset:4096
    v_mfma_f32_16x16x32_bf16 v[124:127], v[228:231], v[244:247], v[124:127]
    ds_read_b64_tr_b16 v[214:215], v201 offset:4608
    v_mfma_f32_16x16x32_bf16 v[132:135], v[228:231], v[248:251], v[132:135]
    ds_read_b64_tr_b16 v[216:217], v200 offset:12288
    v_mfma_f32_16x16x32_bf16 v[140:143], v[228:231], v[252:255], v[140:143]
    ds_read_b64_tr_b16 v[218:219], v200 offset:12800
    s_waitcnt lgkmcnt(10)
    v_mfma_f32_16x16x32_bf16 v[148:151], v[232:235], v[240:243], v[148:151]
    ds_read_b64_tr_b16 v[220:221], v202 offset:4096
    v_mfma_f32_16x16x32_bf16 v[156:159], v[232:235], v[244:247], v[156:159]
    ds_read_b64_tr_b16 v[222:223], v202 offset:4608
    v_mfma_f32_16x16x32_bf16 v[164:167], v[232:235], v[248:251], v[164:167]
    v_add_u32 v193, 0xc000, v193
    v_mfma_f32_16x16x32_bf16 v[172:175], v[232:235], v[252:255], v[172:175]
    v_add_u32 v200, 0xc000, v200
    v_mfma_f32_16x16x32_bf16 v[180:183], v[236:239], v[240:243], v[180:183]
    v_add_u32 v201, 0xc000, v201
    v_mfma_f32_16x16x32_bf16 v[188:191], v[236:239], v[244:247], v[188:191]
    v_add_u32 v202, 0xc000, v202
    s_waitcnt lgkmcnt(6)
    v_mfma_f32_16x16x32_bf16 v[80:83], v[208:211], v[40:43], v[80:83]
    ds_read_b64_tr_b16 v[224:225], v203 offset:4096
    v_mfma_f32_16x16x32_bf16 v[88:91], v[208:211], v[44:47], v[88:91]
    ds_read_b64_tr_b16 v[226:227], v203 offset:4608
    v_mfma_f32_16x16x32_bf16 v[96:99], v[208:211], v[48:51], v[96:99]
    ds_read_b64_tr_b16 v[228:229], v204 offset:4096
    v_mfma_f32_16x16x32_bf16 v[104:107], v[208:211], v[52:55], v[104:107]
    ds_read_b64_tr_b16 v[230:231], v204 offset:4608
    s_waitcnt lgkmcnt(8)
    v_mfma_f32_16x16x32_bf16 v[112:115], v[212:215], v[40:43], v[112:115]
    ds_read_b64_tr_b16 v[232:233], v203 offset:12288
    v_mfma_f32_16x16x32_bf16 v[120:123], v[212:215], v[44:47], v[120:123]
    ds_read_b64_tr_b16 v[234:235], v203 offset:12800
    v_mfma_f32_16x16x32_bf16 v[128:131], v[212:215], v[48:51], v[128:131]
    ds_read_b64_tr_b16 v[236:237], v205 offset:4096
    v_mfma_f32_16x16x32_bf16 v[136:139], v[212:215], v[52:55], v[136:139]
    ds_read_b64_tr_b16 v[238:239], v205 offset:4608
    s_waitcnt lgkmcnt(8)
    v_mfma_f32_16x16x32_bf16 v[144:147], v[216:219], v[40:43], v[144:147]
    v_mfma_f32_16x16x32_bf16 v[152:155], v[216:219], v[44:47], v[152:155]
    v_add_u32 v195, 0xc000, v195
    v_mfma_f32_16x16x32_bf16 v[160:163], v[216:219], v[48:51], v[160:163]
    v_add_u32 v203, 0xc000, v203
    v_mfma_f32_16x16x32_bf16 v[168:171], v[216:219], v[52:55], v[168:171]
    v_add_u32 v204, 0xc000, v204
    v_mfma_f32_16x16x32_bf16 v[176:179], v[220:223], v[40:43], v[176:179]
    v_add_u32 v205, 0xc000, v205
    v_mfma_f32_16x16x32_bf16 v[184:187], v[220:223], v[44:47], v[184:187]
    s_waitcnt lgkmcnt(6)
    v_mfma_f32_16x16x32_bf16 v[84:87], v[224:227], v[40:43], v[84:87]
    v_mfma_f32_16x16x32_bf16 v[92:95], v[224:227], v[44:47], v[92:95]
    s_waitcnt lgkmcnt(0)
    s_barrier
    ds_read_b128 v[240:243], v192 offset:0
    v_mfma_f32_16x16x32_bf16 v[100:103], v[224:227], v[48:51], v[100:103]
    ds_read_b64_tr_b16 v[208:209], v200 offset:0
    v_mfma_f32_16x16x32_bf16 v[108:111], v[224:227], v[52:55], v[108:111]
    ds_read_b64_tr_b16 v[210:211], v200 offset:512
    v_mfma_f32_16x16x32_bf16 v[116:119], v[228:231], v[40:43], v[116:119]
    ds_read_b128 v[244:247], v192 offset:2048
    v_mfma_f32_16x16x32_bf16 v[124:127], v[228:231], v[44:47], v[124:127]
    ds_read_b128 v[248:251], v194 offset:0
    v_mfma_f32_16x16x32_bf16 v[132:135], v[228:231], v[48:51], v[132:135]
    ds_read_b128 v[252:255], v194 offset:2048
    v_mfma_f32_16x16x32_bf16 v[140:143], v[228:231], v[52:55], v[140:143]
    ds_read_b64_tr_b16 v[212:213], v201 offset:0
    v_mfma_f32_16x16x32_bf16 v[148:151], v[232:235], v[40:43], v[148:151]
    ds_read_b64_tr_b16 v[214:215], v201 offset:512
    v_mfma_f32_16x16x32_bf16 v[156:159], v[232:235], v[44:47], v[156:159]
    ds_read_b64_tr_b16 v[216:217], v200 offset:8192
    v_mfma_f32_16x16x32_bf16 v[164:167], v[232:235], v[48:51], v[164:167]
    ds_read_b64_tr_b16 v[218:219], v200 offset:8704
    v_mfma_f32_16x16x32_bf16 v[172:175], v[232:235], v[52:55], v[172:175]
    ds_read_b64_tr_b16 v[220:221], v202 offset:0
    v_mfma_f32_16x16x32_bf16 v[180:183], v[236:239], v[40:43], v[180:183]
    ds_read_b64_tr_b16 v[222:223], v202 offset:512
    v_mfma_f32_16x16x32_bf16 v[188:191], v[236:239], v[44:47], v[188:191]
    s_waitcnt lgkmcnt(8)
    v_mfma_f32_16x16x32_bf16 v[80:83], v[208:211], v[240:243], v[80:83]
    ds_read_b64_tr_b16 v[224:225], v203 offset:0
    v_mfma_f32_16x16x32_bf16 v[88:91], v[208:211], v[244:247], v[88:91]
    ds_read_b64_tr_b16 v[226:227], v203 offset:512
    s_waitcnt lgkmcnt(8)
    v_mfma_f32_16x16x32_bf16 v[96:99], v[208:211], v[248:251], v[96:99]
    ds_read_b64_tr_b16 v[228:229], v204 offset:0
    v_mfma_f32_16x16x32_bf16 v[104:107], v[208:211], v[252:255], v[104:107]
    ds_read_b64_tr_b16 v[230:231], v204 offset:512
    s_waitcnt lgkmcnt(8)
    v_mfma_f32_16x16x32_bf16 v[112:115], v[212:215], v[240:243], v[112:115]
    ds_read_b64_tr_b16 v[232:233], v203 offset:8192
    v_mfma_f32_16x16x32_bf16 v[120:123], v[212:215], v[244:247], v[120:123]
    ds_read_b64_tr_b16 v[234:235], v203 offset:8704
    v_mfma_f32_16x16x32_bf16 v[128:131], v[212:215], v[248:251], v[128:131]
    ds_read_b64_tr_b16 v[236:237], v205 offset:0
    v_mfma_f32_16x16x32_bf16 v[136:139], v[212:215], v[252:255], v[136:139]
    ds_read_b64_tr_b16 v[238:239], v205 offset:512
    s_waitcnt lgkmcnt(8)
    v_mfma_f32_16x16x32_bf16 v[144:147], v[216:219], v[240:243], v[144:147]
    ds_read_b128 v[40:43], v193 offset:0
    v_mfma_f32_16x16x32_bf16 v[152:155], v[216:219], v[244:247], v[152:155]
    ds_read_b128 v[44:47], v193 offset:2048
    v_mfma_f32_16x16x32_bf16 v[160:163], v[216:219], v[248:251], v[160:163]
    v_add_u32 v192, 0xc000, v192
    v_mfma_f32_16x16x32_bf16 v[168:171], v[216:219], v[252:255], v[168:171]
    v_add_u32 v194, 0xc000, v194
    v_mfma_f32_16x16x32_bf16 v[176:179], v[220:223], v[240:243], v[176:179]
    s_waitcnt vmcnt(0)
    v_lshlrev_b32 v38, 7, v1
    v_mfma_f32_16x16x32_bf16 v[184:187], v[220:223], v[244:247], v[184:187]
    s_waitcnt lgkmcnt(8)
    v_mfma_f32_16x16x32_bf16 v[84:87], v[224:227], v[240:243], v[84:87]
    ds_read_b128 v[48:51], v195 offset:0
    v_mfma_f32_16x16x32_bf16 v[92:95], v[224:227], v[244:247], v[92:95]
    ds_read_b128 v[52:55], v195 offset:2048
    v_mfma_f32_16x16x32_bf16 v[100:103], v[224:227], v[248:251], v[100:103]
    ds_read_b64_tr_b16 v[208:209], v200 offset:4096
    v_mfma_f32_16x16x32_bf16 v[108:111], v[224:227], v[252:255], v[108:111]
    ds_read_b64_tr_b16 v[210:211], v200 offset:4608
    s_waitcnt lgkmcnt(10)
    v_mfma_f32_16x16x32_bf16 v[116:119], v[228:231], v[240:243], v[116:119]
    ds_read_b64_tr_b16 v[212:213], v201 offset:4096
    v_mfma_f32_16x16x32_bf16 v[124:127], v[228:231], v[244:247], v[124:127]
    ds_read_b64_tr_b16 v[214:215], v201 offset:4608
    v_mfma_f32_16x16x32_bf16 v[132:135], v[228:231], v[248:251], v[132:135]
    ds_read_b64_tr_b16 v[216:217], v200 offset:12288
    v_mfma_f32_16x16x32_bf16 v[140:143], v[228:231], v[252:255], v[140:143]
    ds_read_b64_tr_b16 v[218:219], v200 offset:12800
    s_waitcnt lgkmcnt(10)
    v_mfma_f32_16x16x32_bf16 v[148:151], v[232:235], v[240:243], v[148:151]
    ds_read_b64_tr_b16 v[220:221], v202 offset:4096
    v_mfma_f32_16x16x32_bf16 v[156:159], v[232:235], v[244:247], v[156:159]
    ds_read_b64_tr_b16 v[222:223], v202 offset:4608
    v_mfma_f32_16x16x32_bf16 v[164:167], v[232:235], v[248:251], v[164:167]
    v_add_u32 v193, 0xc000, v193
    v_mfma_f32_16x16x32_bf16 v[172:175], v[232:235], v[252:255], v[172:175]
    v_add_u32 v200, 0xc000, v200
    v_mfma_f32_16x16x32_bf16 v[180:183], v[236:239], v[240:243], v[180:183]
    v_add_u32 v201, 0xc000, v201
    v_mfma_f32_16x16x32_bf16 v[188:191], v[236:239], v[244:247], v[188:191]
    v_add_u32 v202, 0xc000, v202
    s_waitcnt lgkmcnt(6)
    v_mfma_f32_16x16x32_bf16 v[80:83], v[208:211], v[40:43], v[80:83]
    ds_read_b64_tr_b16 v[224:225], v203 offset:4096
    v_mfma_f32_16x16x32_bf16 v[88:91], v[208:211], v[44:47], v[88:91]
    ds_read_b64_tr_b16 v[226:227], v203 offset:4608
    v_mfma_f32_16x16x32_bf16 v[96:99], v[208:211], v[48:51], v[96:99]
    ds_read_b64_tr_b16 v[228:229], v204 offset:4096
    v_mfma_f32_16x16x32_bf16 v[104:107], v[208:211], v[52:55], v[104:107]
    ds_read_b64_tr_b16 v[230:231], v204 offset:4608
    s_waitcnt lgkmcnt(8)
    v_mfma_f32_16x16x32_bf16 v[112:115], v[212:215], v[40:43], v[112:115]
    ds_read_b64_tr_b16 v[232:233], v203 offset:12288
    v_mfma_f32_16x16x32_bf16 v[120:123], v[212:215], v[44:47], v[120:123]
    ds_read_b64_tr_b16 v[234:235], v203 offset:12800
    v_mfma_f32_16x16x32_bf16 v[128:131], v[212:215], v[48:51], v[128:131]
    ds_read_b64_tr_b16 v[236:237], v205 offset:4096
    v_mfma_f32_16x16x32_bf16 v[136:139], v[212:215], v[52:55], v[136:139]
    ds_read_b64_tr_b16 v[238:239], v205 offset:4608
    s_waitcnt lgkmcnt(8)
    v_mfma_f32_16x16x32_bf16 v[144:147], v[216:219], v[40:43], v[144:147]
    v_mfma_f32_16x16x32_bf16 v[152:155], v[216:219], v[44:47], v[152:155]
    v_add_u32 v195, 0xc000, v195
    v_mfma_f32_16x16x32_bf16 v[160:163], v[216:219], v[48:51], v[160:163]
    v_add_u32 v203, 0xc000, v203
    v_mfma_f32_16x16x32_bf16 v[168:171], v[216:219], v[52:55], v[168:171]
    v_add_u32 v204, 0xc000, v204
    v_mfma_f32_16x16x32_bf16 v[176:179], v[220:223], v[40:43], v[176:179]
    v_add_u32 v205, 0xc000, v205
    v_mfma_f32_16x16x32_bf16 v[184:187], v[220:223], v[44:47], v[184:187]
    s_waitcnt lgkmcnt(6)
    v_mfma_f32_16x16x32_bf16 v[84:87], v[224:227], v[40:43], v[84:87]
    v_mfma_f32_16x16x32_bf16 v[92:95], v[224:227], v[44:47], v[92:95]
    s_waitcnt lgkmcnt(0)
    s_barrier
    ds_read_b128 v[240:243], v192 offset:0
    v_mfma_f32_16x16x32_bf16 v[100:103], v[224:227], v[48:51], v[100:103]
    ds_read_b64_tr_b16 v[208:209], v200 offset:0
    v_mfma_f32_16x16x32_bf16 v[108:111], v[224:227], v[52:55], v[108:111]
    ds_read_b64_tr_b16 v[210:211], v200 offset:512
    v_mfma_f32_16x16x32_bf16 v[116:119], v[228:231], v[40:43], v[116:119]
    ds_read_b128 v[244:247], v192 offset:2048
    v_mfma_f32_16x16x32_bf16 v[124:127], v[228:231], v[44:47], v[124:127]
    ds_read_b128 v[248:251], v194 offset:0
    v_mfma_f32_16x16x32_bf16 v[132:135], v[228:231], v[48:51], v[132:135]
    ds_read_b128 v[252:255], v194 offset:2048
    v_mfma_f32_16x16x32_bf16 v[140:143], v[228:231], v[52:55], v[140:143]
    ds_read_b64_tr_b16 v[212:213], v201 offset:0
    v_mfma_f32_16x16x32_bf16 v[148:151], v[232:235], v[40:43], v[148:151]
    ds_read_b64_tr_b16 v[214:215], v201 offset:512
    v_mfma_f32_16x16x32_bf16 v[156:159], v[232:235], v[44:47], v[156:159]
    ds_read_b64_tr_b16 v[216:217], v200 offset:8192
    v_mfma_f32_16x16x32_bf16 v[164:167], v[232:235], v[48:51], v[164:167]
    ds_read_b64_tr_b16 v[218:219], v200 offset:8704
    v_mfma_f32_16x16x32_bf16 v[172:175], v[232:235], v[52:55], v[172:175]
    ds_read_b64_tr_b16 v[220:221], v202 offset:0
    v_mfma_f32_16x16x32_bf16 v[180:183], v[236:239], v[40:43], v[180:183]
    ds_read_b64_tr_b16 v[222:223], v202 offset:512
    v_mfma_f32_16x16x32_bf16 v[188:191], v[236:239], v[44:47], v[188:191]
    s_waitcnt lgkmcnt(8)
    v_mfma_f32_16x16x32_bf16 v[80:83], v[208:211], v[240:243], v[80:83]
    ds_read_b64_tr_b16 v[224:225], v203 offset:0
    v_mfma_f32_16x16x32_bf16 v[88:91], v[208:211], v[244:247], v[88:91]
    ds_read_b64_tr_b16 v[226:227], v203 offset:512
    s_waitcnt lgkmcnt(8)
    v_mfma_f32_16x16x32_bf16 v[96:99], v[208:211], v[248:251], v[96:99]
    ds_read_b64_tr_b16 v[228:229], v204 offset:0
    v_mfma_f32_16x16x32_bf16 v[104:107], v[208:211], v[252:255], v[104:107]
    ds_read_b64_tr_b16 v[230:231], v204 offset:512
    s_waitcnt lgkmcnt(8)
    v_mfma_f32_16x16x32_bf16 v[112:115], v[212:215], v[240:243], v[112:115]
    ds_read_b64_tr_b16 v[232:233], v203 offset:8192
    v_mfma_f32_16x16x32_bf16 v[120:123], v[212:215], v[244:247], v[120:123]
    ds_read_b64_tr_b16 v[234:235], v203 offset:8704
    v_mfma_f32_16x16x32_bf16 v[128:131], v[212:215], v[248:251], v[128:131]
    ds_read_b64_tr_b16 v[236:237], v205 offset:0
    v_mfma_f32_16x16x32_bf16 v[136:139], v[212:215], v[252:255], v[136:139]
    ds_read_b64_tr_b16 v[238:239], v205 offset:512
    s_waitcnt lgkmcnt(8)
    v_mfma_f32_16x16x32_bf16 v[144:147], v[216:219], v[240:243], v[144:147]
    ds_read_b128 v[40:43], v193 offset:0
    v_mfma_f32_16x16x32_bf16 v[152:155], v[216:219], v[244:247], v[152:155]
    ds_read_b128 v[44:47], v193 offset:2048
    v_mfma_f32_16x16x32_bf16 v[160:163], v[216:219], v[248:251], v[160:163]
    ds_read_b128 v[34:37], v26 offset:0
    v_mfma_f32_16x16x32_bf16 v[168:171], v[216:219], v[252:255], v[168:171]
    ds_read_b128 v[8:11], v26 offset:256
    v_mfma_f32_16x16x32_bf16 v[176:179], v[220:223], v[240:243], v[176:179]
    ds_read_b128 v[28:31], v27 offset:0
    v_mfma_f32_16x16x32_bf16 v[184:187], v[220:223], v[244:247], v[184:187]
    ds_read_b128 v[16:19], v27 offset:256
    s_waitcnt lgkmcnt(12)
    v_mfma_f32_16x16x32_bf16 v[84:87], v[224:227], v[240:243], v[84:87]
    ds_read_b128 v[48:51], v195 offset:0
    v_mfma_f32_16x16x32_bf16 v[92:95], v[224:227], v[244:247], v[92:95]
    ds_read_b128 v[52:55], v195 offset:2048
    v_mfma_f32_16x16x32_bf16 v[100:103], v[224:227], v[248:251], v[100:103]
    ds_read_b64_tr_b16 v[208:209], v200 offset:4096
    v_mfma_f32_16x16x32_bf16 v[108:111], v[224:227], v[252:255], v[108:111]
    ds_read_b64_tr_b16 v[210:211], v200 offset:4608
    s_waitcnt lgkmcnt(14)
    v_mfma_f32_16x16x32_bf16 v[116:119], v[228:231], v[240:243], v[116:119]
    ds_read_b64_tr_b16 v[212:213], v201 offset:4096
    v_mfma_f32_16x16x32_bf16 v[124:127], v[228:231], v[244:247], v[124:127]
    ds_read_b64_tr_b16 v[214:215], v201 offset:4608
    v_mfma_f32_16x16x32_bf16 v[132:135], v[228:231], v[248:251], v[132:135]
    ds_read_b64_tr_b16 v[216:217], v200 offset:12288
    v_mfma_f32_16x16x32_bf16 v[140:143], v[228:231], v[252:255], v[140:143]
    ds_read_b64_tr_b16 v[218:219], v200 offset:12800
    s_waitcnt lgkmcnt(14)
    v_mfma_f32_16x16x32_bf16 v[148:151], v[232:235], v[240:243], v[148:151]
    ds_read_b64_tr_b16 v[220:221], v202 offset:4096
    v_mfma_f32_16x16x32_bf16 v[156:159], v[232:235], v[244:247], v[156:159]
    ds_read_b64_tr_b16 v[222:223], v202 offset:4608
    v_mfma_f32_16x16x32_bf16 v[164:167], v[232:235], v[248:251], v[164:167]
    s_waitcnt lgkmcnt(10)
    v_xor_b32 v32, s60, v37
    v_xor_b32 v33, s60, v11
    v_mfma_f32_16x16x32_bf16 v[172:175], v[232:235], v[252:255], v[172:175]
    v_xor_b32 v25, s60, v31
    v_xor_b32 v5, s60, v19
    v_mfma_f32_16x16x32_bf16 v[180:183], v[236:239], v[240:243], v[180:183]
    v_or3_b32 v32, v32, v33, v25
    v_or_b32 v32, v32, v5
    v_mfma_f32_16x16x32_bf16 v[188:191], v[236:239], v[244:247], v[188:191]
    v_cmp_ne_u32 vcc, 0, v32
    s_cbranch_vccnz SL_43
SE_44:
    s_waitcnt lgkmcnt(6)
    v_mfma_f32_16x16x32_bf16 v[80:83], v[208:211], v[40:43], v[80:83]
    ds_read_b64_tr_b16 v[224:225], v203 offset:4096
    v_mfma_f32_16x16x32_bf16 v[88:91], v[208:211], v[44:47], v[88:91]
    ds_read_b64_tr_b16 v[226:227], v203 offset:4608
    v_cvt_pk_bf16_f32 v240, -v34, -v34
    v_mfma_f32_16x16x32_bf16 v[96:99], v[208:211], v[48:51], v[96:99]
    ds_read_b64_tr_b16 v[228:229], v204 offset:4096
    v_mov_b32 v242, 0
    v_mfma_f32_16x16x32_bf16 v[104:107], v[208:211], v[52:55], v[104:107]
    ds_read_b64_tr_b16 v[230:231], v204 offset:4608
    v_lshlrev_b32 v241, 16, v240
    s_waitcnt lgkmcnt(8)
    v_mfma_f32_16x16x32_bf16 v[112:115], v[212:215], v[40:43], v[112:115]
    ds_read_b64_tr_b16 v[232:233], v203 offset:12288
    v_sub_f32 v241, -v34, v241
    v_mfma_f32_16x16x32_bf16 v[120:123], v[212:215], v[44:47], v[120:123]
    ds_read_b64_tr_b16 v[234:235], v203 offset:12800
    v_mov_b32 v243, 0
    v_mfma_f32_16x16x32_bf16 v[128:131], v[212:215], v[48:51], v[128:131]
    ds_read_b64_tr_b16 v[236:237], v205 offset:4096
    v_cvt_pk_bf16_f32 v241, v241, v241
    v_mfma_f32_16x16x32_bf16 v[136:139], v[212:215], v[52:55], v[136:139]
    ds_read_b64_tr_b16 v[238:239], v205 offset:4608
    v_mul_f32 v34, 0xbfb8aa3b, v35
    s_waitcnt lgkmcnt(8)
    v_mfma_f32_16x16x32_bf16 v[144:147], v[216:219], v[40:43], v[144:147]
    v_cvt_pk_bf16_f32 v244, -v8, -v8
    v_mov_b32 v246, 0
    v_mfma_f32_16x16x32_bf16 v[152:155], v[216:219], v[44:47], v[152:155]
    v_lshlrev_b32 v245, 16, v244
    v_sub_f32 v245, -v8, v245
    v_mfma_f32_16x16x32_bf16 v[160:163], v[216:219], v[48:51], v[160:163]
    v_mov_b32 v247, 0
    v_cvt_pk_bf16_f32 v245, v245, v245
    v_mfma_f32_16x16x32_bf16 v[168:171], v[216:219], v[52:55], v[168:171]
    v_mul_f32 v8, 0xbfb8aa3b, v9
    v_cvt_pk_bf16_f32 v248, -v28, -v28
    v_mfma_f32_16x16x32_bf16 v[176:179], v[220:223], v[40:43], v[176:179]
    v_mov_b32 v250, 0
    v_lshlrev_b32 v249, 16, v248
    v_mfma_f32_16x16x32_bf16 v[184:187], v[220:223], v[44:47], v[184:187]
    v_sub_f32 v249, -v28, v249
    v_mov_b32 v251, 0
    s_waitcnt lgkmcnt(6)
    v_mfma_f32_16x16x32_bf16 v[84:87], v[224:227], v[40:43], v[84:87]
    v_mfma_f32_16x16x32_bf16 v[92:95], v[224:227], v[44:47], v[92:95]
    s_waitcnt lgkmcnt(0)
    s_barrier
    ds_read2_b32 v[56:57], v14 offset0:0 offset1:0
    ds_read2_b32 v[58:59], v14 offset0:16 offset1:16
    v_mfma_f32_16x16x32_bf16 v[100:103], v[224:227], v[48:51], v[100:103]
    ds_read2_b32 v[60:61], v14 offset0:32 offset1:32
    ds_read2_b32 v[62:63], v14 offset0:48 offset1:48
    v_mfma_f32_16x16x32_bf16 v[108:111], v[224:227], v[52:55], v[108:111]
    ds_read2_b32 v[64:65], v14 offset0:64 offset1:64
    ds_read2_b32 v[66:67], v14 offset0:80 offset1:80
    v_mfma_f32_16x16x32_bf16 v[116:119], v[228:231], v[40:43], v[116:119]
    ds_read2_b32 v[68:69], v13 offset0:0 offset1:0
    ds_read2_b32 v[70:71], v13 offset0:16 offset1:16
    v_mfma_f32_16x16x32_bf16 v[124:127], v[228:231], v[44:47], v[124:127]
    v_cvt_pk_bf16_f32 v249, v249, v249
    v_mfma_f32_16x16x32_bf16 v[132:135], v[228:231], v[48:51], v[132:135]
    v_mul_f32 v28, 0xbfb8aa3b, v29
    v_mfma_f32_16x16x32_bf16 v[140:143], v[228:231], v[52:55], v[140:143]
    v_cvt_pk_bf16_f32 v252, -v16, -v16
    v_mfma_f32_16x16x32_bf16 v[148:151], v[232:235], v[40:43], v[148:151]
    v_mov_b32 v254, 0
    v_mfma_f32_16x16x32_bf16 v[156:159], v[232:235], v[44:47], v[156:159]
    v_lshlrev_b32 v253, 16, v252
    v_mfma_f32_16x16x32_bf16 v[164:167], v[232:235], v[48:51], v[164:167]
    v_sub_f32 v253, -v16, v253
    v_mfma_f32_16x16x32_bf16 v[172:175], v[232:235], v[52:55], v[172:175]
    v_mov_b32 v255, 0
    v_mfma_f32_16x16x32_bf16 v[180:183], v[236:239], v[40:43], v[180:183]
    v_cvt_pk_bf16_f32 v253, v253, v253
    v_mfma_f32_16x16x32_bf16 v[188:191], v[236:239], v[44:47], v[188:191]
    v_mul_f32 v16, 0xbfb8aa3b, v17
    s_waitcnt lgkmcnt(0)
    v_mfma_f32_16x16x32_bf16 v[80:83], v[56:59], v[240:243], v[80:83]
    v_mfma_f32_16x16x32_bf16 v[84:87], v[58:61], v[240:243], v[84:87]
    v_mfma_f32_16x16x32_bf16 v[88:91], v[56:59], v[244:247], v[88:91]
    v_mfma_f32_16x16x32_bf16 v[92:95], v[58:61], v[244:247], v[92:95]
    v_mfma_f32_16x16x32_bf16 v[96:99], v[56:59], v[248:251], v[96:99]
    s_setprio 1
    s_nop 2
    v_pk_mul_f32 v[208:209], v[80:81], v[34:35] op_sel_hi:[1,0]
    v_pk_mul_f32 v[210:211], v[82:83], v[34:35] op_sel_hi:[1,0]
    v_pk_mul_f32 v[212:213], v[84:85], v[34:35] op_sel_hi:[1,0]
    v_pk_mul_f32 v[214:215], v[86:87], v[34:35] op_sel_hi:[1,0]
    v_pk_mul_f32 v[216:217], v[88:89], v[8:9] op_sel_hi:[1,0]
    v_pk_mul_f32 v[218:219], v[90:91], v[8:9] op_sel_hi:[1,0]
    v_pk_mul_f32 v[220:221], v[92:93], v[8:9] op_sel_hi:[1,0]
    v_pk_mul_f32 v[222:223], v[94:95], v[8:9] op_sel_hi:[1,0]
    v_mfma_f32_16x16x32_bf16 v[100:103], v[58:61], v[248:251], v[100:103]
    v_exp_f32 v208, v208
    v_exp_f32 v209, v209
    v_mfma_f32_16x16x32_bf16 v[104:107], v[56:59], v[252:255], v[104:107]
    v_exp_f32 v210, v210
    v_exp_f32 v211, v211
    v_mfma_f32_16x16x32_bf16 v[108:111], v[58:61], v[252:255], v[108:111]
    v_exp_f32 v212, v212
    v_exp_f32 v213, v213
    v_mfma_f32_16x16x32_bf16 v[112:115], v[60:63], v[240:243], v[112:115]
    v_exp_f32 v214, v214
    v_exp_f32 v215, v215
    v_mfma_f32_16x16x32_bf16 v[116:119], v[62:65], v[240:243], v[116:119]
    v_exp_f32 v216, v216
    v_exp_f32 v217, v217
    v_mfma_f32_16x16x32_bf16 v[120:123], v[60:63], v[244:247], v[120:123]
    v_exp_f32 v218, v218
    v_exp_f32 v219, v219
    v_mfma_f32_16x16x32_bf16 v[124:127], v[62:65], v[244:247], v[124:127]
    v_exp_f32 v220, v220
    v_exp_f32 v221, v221
    v_exp_f32 v222, v222
    v_exp_f32 v223, v223
    v_pk_fma_f32 v[208:209], v[208:209], v[36:37], v[36:37] op_sel_hi:[1,0,0]
    v_pk_fma_f32 v[210:211], v[210:211], v[36:37], v[36:37] op_sel_hi:[1,0,0]
    v_pk_fma_f32 v[212:213], v[212:213], v[36:37], v[36:37] op_sel_hi:[1,0,0]
    v_pk_fma_f32 v[214:215], v[214:215], v[36:37], v[36:37] op_sel_hi:[1,0,0]
    v_pk_fma_f32 v[216:217], v[216:217], v[10:11], v[10:11] op_sel_hi:[1,0,0]
    v_pk_fma_f32 v[218:219], v[218:219], v[10:11], v[10:11] op_sel_hi:[1,0,0]
    v_pk_fma_f32 v[220:221], v[220:221], v[10:11], v[10:11] op_sel_hi:[1,0,0]
    v_pk_fma_f32 v[222:223], v[222:223], v[10:11], v[10:11] op_sel_hi:[1,0,0]
    v_mfma_f32_16x16x32_bf16 v[128:131], v[60:63], v[248:251], v[128:131]
    v_rcp_f32 v208, v208
    v_rcp_f32 v209, v209
    v_mfma_f32_16x16x32_bf16 v[132:135], v[62:65], v[248:251], v[132:135]
    v_rcp_f32 v210, v210
    v_rcp_f32 v211, v211
    v_mfma_f32_16x16x32_bf16 v[136:139], v[60:63], v[252:255], v[136:139]
    v_rcp_f32 v212, v212
    v_rcp_f32 v213, v213
    v_mfma_f32_16x16x32_bf16 v[140:143], v[62:65], v[252:255], v[140:143]
    v_rcp_f32 v214, v214
    v_rcp_f32 v215, v215
    v_mfma_f32_16x16x32_bf16 v[144:147], v[64:67], v[240:243], v[144:147]
    v_rcp_f32 v216, v216
    v_rcp_f32 v217, v217
    v_mfma_f32_16x16x32_bf16 v[148:151], v[66:69], v[240:243], v[148:151]
    v_rcp_f32 v218, v218
    v_rcp_f32 v219, v219
    v_mfma_f32_16x16x32_bf16 v[152:155], v[64:67], v[244:247], v[152:155]
    v_rcp_f32 v220, v220
    v_rcp_f32 v221, v221
    v_rcp_f32 v222, v222
    v_rcp_f32 v223, v223
    v_pk_mul_f32 v[208:209], v[80:81], v[208:209]
    v_pk_mul_f32 v[210:211], v[82:83], v[210:211]
    v_pk_mul_f32 v[212:213], v[84:85], v[212:213]
    v_pk_mul_f32 v[214:215], v[86:87], v[214:215]
    v_pk_mul_f32 v[216:217], v[88:89], v[216:217]
    v_pk_mul_f32 v[218:219], v[90:91], v[218:219]
    v_pk_mul_f32 v[220:221], v[92:93], v[220:221]
    v_pk_mul_f32 v[222:223], v[94:95], v[222:223]
    v_cvt_pk_bf16_f32 v224, v208, v209
    v_cvt_pk_bf16_f32 v225, v210, v211
    v_cvt_pk_bf16_f32 v226, v212, v213
    v_cvt_pk_bf16_f32 v227, v214, v215
    v_cvt_pk_bf16_f32 v228, v216, v217
    v_cvt_pk_bf16_f32 v229, v218, v219
    v_cvt_pk_bf16_f32 v230, v220, v221
    v_cvt_pk_bf16_f32 v231, v222, v223
    buffer_store_dwordx4 v[224:227], v3, s[24:27], s63 offen offset:0 sc1
    buffer_store_dwordx4 v[228:231], v3, s[24:27], s63 offen offset:256 sc1
    s_add_u32 s63, s63, 16384
    v_pk_mul_f32 v[208:209], v[96:97], v[28:29] op_sel_hi:[1,0]
    v_pk_mul_f32 v[210:211], v[98:99], v[28:29] op_sel_hi:[1,0]
    v_pk_mul_f32 v[212:213], v[100:101], v[28:29] op_sel_hi:[1,0]
    v_pk_mul_f32 v[214:215], v[102:103], v[28:29] op_sel_hi:[1,0]
    v_pk_mul_f32 v[216:217], v[104:105], v[16:17] op_sel_hi:[1,0]
    v_pk_mul_f32 v[218:219], v[106:107], v[16:17] op_sel_hi:[1,0]
    v_pk_mul_f32 v[220:221], v[108:109], v[16:17] op_sel_hi:[1,0]
    v_pk_mul_f32 v[222:223], v[110:111], v[16:17] op_sel_hi:[1,0]
    v_mfma_f32_16x16x32_bf16 v[156:159], v[66:69], v[244:247], v[156:159]
    v_exp_f32 v208, v208
    v_exp_f32 v209, v209
    v_mfma_f32_16x16x32_bf16 v[160:163], v[64:67], v[248:251], v[160:163]
    v_exp_f32 v210, v210
    v_exp_f32 v211, v211
    v_mfma_f32_16x16x32_bf16 v[164:167], v[66:69], v[248:251], v[164:167]
    v_exp_f32 v212, v212
    v_exp_f32 v213, v213
    v_mfma_f32_16x16x32_bf16 v[168:171], v[64:67], v[252:255], v[168:171]
    v_exp_f32 v214, v214
    v_exp_f32 v215, v215
    v_mfma_f32_16x16x32_bf16 v[172:175], v[66:69], v[252:255], v[172:175]
    v_exp_f32 v216, v216
    v_exp_f32 v217, v217
    v_mfma_f32_16x16x32_bf16 v[176:179], v[68:71], v[240:243], v[176:179]
    v_exp_f32 v218, v218
    v_exp_f32 v219, v219
    v_mfma_f32_16x16x32_bf16 v[180:183], v[70:73], v[240:243], v[180:183]
    v_exp_f32 v220, v220
    v_exp_f32 v221, v221
    v_exp_f32 v222, v222
    v_exp_f32 v223, v223
    v_pk_fma_f32 v[208:209], v[208:209], v[30:31], v[30:31] op_sel_hi:[1,0,0]
    v_pk_fma_f32 v[210:211], v[210:211], v[30:31], v[30:31] op_sel_hi:[1,0,0]
    v_pk_fma_f32 v[212:213], v[212:213], v[30:31], v[30:31] op_sel_hi:[1,0,0]
    v_pk_fma_f32 v[214:215], v[214:215], v[30:31], v[30:31] op_sel_hi:[1,0,0]
    v_pk_fma_f32 v[216:217], v[216:217], v[18:19], v[18:19] op_sel_hi:[1,0,0]
    v_pk_fma_f32 v[218:219], v[218:219], v[18:19], v[18:19] op_sel_hi:[1,0,0]
    v_pk_fma_f32 v[220:221], v[220:221], v[18:19], v[18:19] op_sel_hi:[1,0,0]
    v_pk_fma_f32 v[222:223], v[222:223], v[18:19], v[18:19] op_sel_hi:[1,0,0]
    v_mfma_f32_16x16x32_bf16 v[184:187], v[68:71], v[244:247], v[184:187]
    v_rcp_f32 v208, v208
    v_rcp_f32 v209, v209
    v_mfma_f32_16x16x32_bf16 v[188:191], v[70:73], v[244:247], v[188:191]
    v_rcp_f32 v210, v210
    v_rcp_f32 v211, v211
    v_rcp_f32 v212, v212
    v_rcp_f32 v213, v213
    v_rcp_f32 v214, v214
    v_rcp_f32 v215, v215
    v_rcp_f32 v216, v216
    v_rcp_f32 v217, v217
    v_rcp_f32 v218, v218
    v_rcp_f32 v219, v219
    v_rcp_f32 v220, v220
    v_rcp_f32 v221, v221
    v_rcp_f32 v222, v222
    v_rcp_f32 v223, v223
    v_pk_mul_f32 v[208:209], v[96:97], v[208:209]
    v_pk_mul_f32 v[210:211], v[98:99], v[210:211]
    v_pk_mul_f32 v[212:213], v[100:101], v[212:213]
    v_pk_mul_f32 v[214:215], v[102:103], v[214:215]
    v_pk_mul_f32 v[216:217], v[104:105], v[216:217]
    v_pk_mul_f32 v[218:219], v[106:107], v[218:219]
    v_pk_mul_f32 v[220:221], v[108:109], v[220:221]
    v_pk_mul_f32 v[222:223], v[110:111], v[222:223]
    v_cvt_pk_bf16_f32 v232, v208, v209
    v_cvt_pk_bf16_f32 v233, v210, v211
    v_cvt_pk_bf16_f32 v234, v212, v213
    v_cvt_pk_bf16_f32 v235, v214, v215
    v_cvt_pk_bf16_f32 v236, v216, v217
    v_cvt_pk_bf16_f32 v237, v218, v219
    v_cvt_pk_bf16_f32 v238, v220, v221
    v_cvt_pk_bf16_f32 v239, v222, v223
    buffer_store_dwordx4 v[232:235], v3, s[24:27], s46 offen offset:0 sc1
    buffer_store_dwordx4 v[236:239], v3, s[24:27], s46 offen offset:256 sc1
    s_add_u32 s46, s46, 16384
    v_pk_mul_f32 v[208:209], v[112:113], v[34:35] op_sel_hi:[1,0]
    v_pk_mul_f32 v[210:211], v[114:115], v[34:35] op_sel_hi:[1,0]
    v_pk_mul_f32 v[212:213], v[116:117], v[34:35] op_sel_hi:[1,0]
    v_pk_mul_f32 v[214:215], v[118:119], v[34:35] op_sel_hi:[1,0]
    v_pk_mul_f32 v[216:217], v[120:121], v[8:9] op_sel_hi:[1,0]
    v_pk_mul_f32 v[218:219], v[122:123], v[8:9] op_sel_hi:[1,0]
    v_pk_mul_f32 v[220:221], v[124:125], v[8:9] op_sel_hi:[1,0]
    v_pk_mul_f32 v[222:223], v[126:127], v[8:9] op_sel_hi:[1,0]
    v_exp_f32 v208, v208
    v_exp_f32 v209, v209
    v_exp_f32 v210, v210
    v_exp_f32 v211, v211
    v_exp_f32 v212, v212
    v_exp_f32 v213, v213
    v_exp_f32 v214, v214
    v_exp_f32 v215, v215
    v_exp_f32 v216, v216
    v_exp_f32 v217, v217
    v_exp_f32 v218, v218
    v_exp_f32 v219, v219
    v_exp_f32 v220, v220
    v_exp_f32 v221, v221
    v_exp_f32 v222, v222
    v_exp_f32 v223, v223
    v_pk_fma_f32 v[208:209], v[208:209], v[36:37], v[36:37] op_sel_hi:[1,0,0]
    v_pk_fma_f32 v[210:211], v[210:211], v[36:37], v[36:37] op_sel_hi:[1,0,0]
    v_pk_fma_f32 v[212:213], v[212:213], v[36:37], v[36:37] op_sel_hi:[1,0,0]
    v_pk_fma_f32 v[214:215], v[214:215], v[36:37], v[36:37] op_sel_hi:[1,0,0]
    v_pk_fma_f32 v[216:217], v[216:217], v[10:11], v[10:11] op_sel_hi:[1,0,0]
    v_pk_fma_f32 v[218:219], v[218:219], v[10:11], v[10:11] op_sel_hi:[1,0,0]
    v_pk_fma_f32 v[220:221], v[220:221], v[10:11], v[10:11] op_sel_hi:[1,0,0]
    v_pk_fma_f32 v[222:223], v[222:223], v[10:11], v[10:11] op_sel_hi:[1,0,0]
    v_rcp_f32 v208, v208
    v_rcp_f32 v209, v209
    v_rcp_f32 v210, v210
    v_rcp_f32 v211, v211
    v_rcp_f32 v212, v212
    v_rcp_f32 v213, v213
    v_rcp_f32 v214, v214
    v_rcp_f32 v215, v215
    v_rcp_f32 v216, v216
    v_rcp_f32 v217, v217
    v_rcp_f32 v218, v218
    v_rcp_f32 v219, v219
    v_rcp_f32 v220, v220
    v_rcp_f32 v221, v221
    v_rcp_f32 v222, v222
    v_rcp_f32 v223, v223
    v_pk_mul_f32 v[208:209], v[112:113], v[208:209]
    v_pk_mul_f32 v[210:211], v[114:115], v[210:211]
    v_pk_mul_f32 v[212:213], v[116:117], v[212:213]
    v_pk_mul_f32 v[214:215], v[118:119], v[214:215]
    v_pk_mul_f32 v[216:217], v[120:121], v[216:217]
    v_pk_mul_f32 v[218:219], v[122:123], v[218:219]
    v_pk_mul_f32 v[220:221], v[124:125], v[220:221]
    v_pk_mul_f32 v[222:223], v[126:127], v[222:223]
    v_cvt_pk_bf16_f32 v224, v208, v209
    v_cvt_pk_bf16_f32 v225, v210, v211
    v_cvt_pk_bf16_f32 v226, v212, v213
    v_cvt_pk_bf16_f32 v227, v214, v215
    v_cvt_pk_bf16_f32 v228, v216, v217
    v_cvt_pk_bf16_f32 v229, v218, v219
    v_cvt_pk_bf16_f32 v230, v220, v221
    v_cvt_pk_bf16_f32 v231, v222, v223
    buffer_store_dwordx4 v[224:227], v3, s[24:27], s63 offen offset:0 sc1
    buffer_store_dwordx4 v[228:231], v3, s[24:27], s63 offen offset:256 sc1
    s_add_u32 s63, s63, 16384
    s_waitcnt vmcnt(2)
    s_mov_b64 exec, 0x3
    buffer_store_dword v37, v38, s[24:27], s70 offen offset:0 sc1
    s_mov_b64 exec, -1
    v_pk_mul_f32 v[208:209], v[128:129], v[28:29] op_sel_hi:[1,0]
    v_pk_mul_f32 v[210:211], v[130:131], v[28:29] op_sel_hi:[1,0]
    v_pk_mul_f32 v[212:213], v[132:133], v[28:29] op_sel_hi:[1,0]
    v_pk_mul_f32 v[214:215], v[134:135], v[28:29] op_sel_hi:[1,0]
    v_pk_mul_f32 v[216:217], v[136:137], v[16:17] op_sel_hi:[1,0]
    v_pk_mul_f32 v[218:219], v[138:139], v[16:17] op_sel_hi:[1,0]
    v_pk_mul_f32 v[220:221], v[140:141], v[16:17] op_sel_hi:[1,0]
    v_pk_mul_f32 v[222:223], v[142:143], v[16:17] op_sel_hi:[1,0]
    v_exp_f32 v208, v208
    v_exp_f32 v209, v209
    v_exp_f32 v210, v210
    v_exp_f32 v211, v211
    v_exp_f32 v212, v212
    v_exp_f32 v213, v213
    v_exp_f32 v214, v214
    v_exp_f32 v215, v215
    v_exp_f32 v216, v216
    v_exp_f32 v217, v217
    v_exp_f32 v218, v218
    v_exp_f32 v219, v219
    v_exp_f32 v220, v220
    v_exp_f32 v221, v221
    v_exp_f32 v222, v222
    v_exp_f32 v223, v223
    v_pk_fma_f32 v[208:209], v[208:209], v[30:31], v[30:31] op_sel_hi:[1,0,0]
    v_pk_fma_f32 v[210:211], v[210:211], v[30:31], v[30:31] op_sel_hi:[1,0,0]
    v_pk_fma_f32 v[212:213], v[212:213], v[30:31], v[30:31] op_sel_hi:[1,0,0]
    v_pk_fma_f32 v[214:215], v[214:215], v[30:31], v[30:31] op_sel_hi:[1,0,0]
    v_pk_fma_f32 v[216:217], v[216:217], v[18:19], v[18:19] op_sel_hi:[1,0,0]
    v_pk_fma_f32 v[218:219], v[218:219], v[18:19], v[18:19] op_sel_hi:[1,0,0]
    v_pk_fma_f32 v[220:221], v[220:221], v[18:19], v[18:19] op_sel_hi:[1,0,0]
    v_pk_fma_f32 v[222:223], v[222:223], v[18:19], v[18:19] op_sel_hi:[1,0,0]
    v_rcp_f32 v208, v208
    v_rcp_f32 v209, v209
    v_rcp_f32 v210, v210
    v_rcp_f32 v211, v211
    v_rcp_f32 v212, v212
    v_rcp_f32 v213, v213
    v_rcp_f32 v214, v214
    v_rcp_f32 v215, v215
    v_rcp_f32 v216, v216
    v_rcp_f32 v217, v217
    v_rcp_f32 v218, v218
    v_rcp_f32 v219, v219
    v_rcp_f32 v220, v220
    v_rcp_f32 v221, v221
    v_rcp_f32 v222, v222
    v_rcp_f32 v223, v223
    v_pk_mul_f32 v[208:209], v[128:129], v[208:209]
    v_pk_mul_f32 v[210:211], v[130:131], v[210:211]
    v_pk_mul_f32 v[212:213], v[132:133], v[212:213]
    v_pk_mul_f32 v[214:215], v[134:135], v[214:215]
    v_pk_mul_f32 v[216:217], v[136:137], v[216:217]
    v_pk_mul_f32 v[218:219], v[138:139], v[218:219]
    v_pk_mul_f32 v[220:221], v[140:141], v[220:221]
    v_pk_mul_f32 v[222:223], v[142:143], v[222:223]
    v_cvt_pk_bf16_f32 v232, v208, v209
    v_cvt_pk_bf16_f32 v233, v210, v211
    v_cvt_pk_bf16_f32 v234, v212, v213
    v_cvt_pk_bf16_f32 v235, v214, v215
    v_cvt_pk_bf16_f32 v236, v216, v217
    v_cvt_pk_bf16_f32 v237, v218, v219
    v_cvt_pk_bf16_f32 v238, v220, v221
    v_cvt_pk_bf16_f32 v239, v222, v223
    buffer_store_dwordx4 v[232:235], v3, s[24:27], s46 offen offset:0 sc1
    buffer_store_dwordx4 v[236:239], v3, s[24:27], s46 offen offset:256 sc1
    s_add_u32 s46, s46, 16384
WMA_45:
SEG_A0_0:
    s_cbranch_execz RET0_A
    v_pk_mul_f32 v[208:209], v[144:145], v[34:35] op_sel_hi:[1,0]
    v_pk_mul_f32 v[210:211], v[146:147], v[34:35] op_sel_hi:[1,0]
    v_pk_mul_f32 v[212:213], v[148:149], v[34:35] op_sel_hi:[1,0]
    v_pk_mul_f32 v[214:215], v[150:151], v[34:35] op_sel_hi:[1,0]
    v_pk_mul_f32 v[216:217], v[152:153], v[8:9] op_sel_hi:[1,0]
    v_pk_mul_f32 v[218:219], v[154:155], v[8:9] op_sel_hi:[1,0]
    v_pk_mul_f32 v[220:221], v[156:157], v[8:9] op_sel_hi:[1,0]
    v_pk_mul_f32 v[222:223], v[158:159], v[8:9] op_sel_hi:[1,0]
    v_exp_f32 v208, v208
    v_exp_f32 v209, v209
    v_exp_f32 v210, v210
    v_exp_f32 v211, v211
    v_exp_f32 v212, v212
    v_exp_f32 v213, v213
    v_exp_f32 v214, v214
    v_exp_f32 v215, v215
    v_exp_f32 v216, v216
    v_exp_f32 v217, v217
    v_exp_f32 v218, v218
    v_exp_f32 v219, v219
    v_exp_f32 v220, v220
    v_exp_f32 v221, v221
    v_exp_f32 v222, v222
    v_exp_f32 v223, v223
    v_pk_fma_f32 v[208:209], v[208:209], v[36:37], v[36:37] op_sel_hi:[1,0,0]
    v_pk_fma_f32 v[210:211], v[210:211], v[36:37], v[36:37] op_sel_hi:[1,0,0]
    v_pk_fma_f32 v[212:213], v[212:213], v[36:37], v[36:37] op_sel_hi:[1,0,0]
    v_pk_fma_f32 v[214:215], v[214:215], v[36:37], v[36:37] op_sel_hi:[1,0,0]
    v_pk_fma_f32 v[216:217], v[216:217], v[10:11], v[10:11] op_sel_hi:[1,0,0]
    v_pk_fma_f32 v[218:219], v[218:219], v[10:11], v[10:11] op_sel_hi:[1,0,0]
    v_pk_fma_f32 v[220:221], v[220:221], v[10:11], v[10:11] op_sel_hi:[1,0,0]
SEG_A0_1:
    s_cbranch_execz PAD_A1_1
    v_pk_fma_f32 v[222:223], v[222:223], v[10:11], v[10:11] op_sel_hi:[1,0,0]
    v_rcp_f32 v208, v208
    v_rcp_f32 v209, v209
    v_rcp_f32 v210, v210
    v_rcp_f32 v211, v211
    v_rcp_f32 v212, v212
    v_rcp_f32 v213, v213
    v_rcp_f32 v214, v214
    v_rcp_f32 v215, v215
    v_rcp_f32 v216, v216
    v_rcp_f32 v217, v217
    v_rcp_f32 v218, v218
    v_rcp_f32 v219, v219
    v_rcp_f32 v220, v220
    v_rcp_f32 v221, v221
    v_rcp_f32 v222, v222
    v_rcp_f32 v223, v223
    v_pk_mul_f32 v[208:209], v[144:145], v[208:209]
    v_pk_mul_f32 v[210:211], v[146:147], v[210:211]
    v_pk_mul_f32 v[212:213], v[148:149], v[212:213]
    v_pk_mul_f32 v[214:215], v[150:151], v[214:215]
    v_pk_mul_f32 v[216:217], v[152:153], v[216:217]
    v_pk_mul_f32 v[218:219], v[154:155], v[218:219]
    v_pk_mul_f32 v[220:221], v[156:157], v[220:221]
    v_pk_mul_f32 v[222:223], v[158:159], v[222:223]
    v_cvt_pk_bf16_f32 v224, v208, v209
    v_cvt_pk_bf16_f32 v225, v210, v211
    v_cvt_pk_bf16_f32 v226, v212, v213
    v_cvt_pk_bf16_f32 v227, v214, v215
    v_cvt_pk_bf16_f32 v228, v216, v217
    v_cvt_pk_bf16_f32 v229, v218, v219
    v_cvt_pk_bf16_f32 v230, v220, v221
    v_cvt_pk_bf16_f32 v231, v222, v223
    buffer_store_dwordx4 v[224:227], v3, s[24:27], s63 offen offset:0 sc1
    buffer_store_dwordx4 v[228:231], v3, s[24:27], s63 offen offset:256 sc1
    s_waitcnt vmcnt(2)
    s_mov_b64 exec, 0x3
    buffer_store_dword v37, v38, s[24:27], s70 offen offset:32 sc1
    s_mov_b64 exec, -1
    v_pk_mul_f32 v[208:209], v[160:161], v[28:29] op_sel_hi:[1,0]
    v_pk_mul_f32 v[210:211], v[162:163], v[28:29] op_sel_hi:[1,0]
PAD_A1_1:
    s_cbranch_execz RET0_A
    v_pk_mul_f32 v[212:213], v[164:165], v[28:29] op_sel_hi:[1,0]
    v_pk_mul_f32 v[214:215], v[166:167], v[28:29] op_sel_hi:[1,0]
    v_pk_mul_f32 v[216:217], v[168:169], v[16:17] op_sel_hi:[1,0]
    v_pk_mul_f32 v[218:219], v[170:171], v[16:17] op_sel_hi:[1,0]
    v_pk_mul_f32 v[220:221], v[172:173], v[16:17] op_sel_hi:[1,0]
    v_pk_mul_f32 v[222:223], v[174:175], v[16:17] op_sel_hi:[1,0]
    v_exp_f32 v208, v208
    v_exp_f32 v209, v209
    v_exp_f32 v210, v210
    v_exp_f32 v211, v211
    v_exp_f32 v212, v212
    v_exp_f32 v213, v213
    v_exp_f32 v214, v214
    v_exp_f32 v215, v215
    v_exp_f32 v216, v216
    v_exp_f32 v217, v217
    v_exp_f32 v218, v218
    v_exp_f32 v219, v219
    v_exp_f32 v220, v220
    v_exp_f32 v221, v221
    v_exp_f32 v222, v222
    v_exp_f32 v223, v223
    v_pk_fma_f32 v[208:209], v[208:209], v[30:31], v[30:31] op_sel_hi:[1,0,0]
    v_pk_fma_f32 v[210:211], v[210:211], v[30:31], v[30:31] op_sel_hi:[1,0,0]
    v_pk_fma_f32 v[212:213], v[212:213], v[30:31], v[30:31] op_sel_hi:[1,0,0]
    v_pk_fma_f32 v[214:215], v[214:215], v[30:31], v[30:31] op_sel_hi:[1,0,0]
    v_pk_fma_f32 v[216:217], v[216:217], v[18:19], v[18:19] op_sel_hi:[1,0,0]
    v_pk_fma_f32 v[218:219], v[218:219], v[18:19], v[18:19] op_sel_hi:[1,0,0]
    v_pk_fma_f32 v[220:221], v[220:221], v[18:19], v[18:19] op_sel_hi:[1,0,0]
    v_pk_fma_f32 v[222:223], v[222:223], v[18:19], v[18:19] op_sel_hi:[1,0,0]
    v_rcp_f32 v208, v208
    v_rcp_f32 v209, v209
    v_rcp_f32 v210, v210
    v_rcp_f32 v211, v211
    v_rcp_f32 v212, v212
    v_rcp_f32 v213, v213
    v_rcp_f32 v214, v214
    v_rcp_f32 v215, v215
    v_rcp_f32 v216, v216
    v_rcp_f32 v217, v217
    v_rcp_f32 v218, v218
    v_rcp_f32 v219, v219
    v_rcp_f32 v220, v220
    v_rcp_f32 v221, v221
    v_rcp_f32 v222, v222
    v_rcp_f32 v223, v223
    v_pk_mul_f32 v[208:209], v[160:161], v[208:209]
SEG_A0_2:
    s_cbranch_execz RET0_A
    v_pk_mul_f32 v[210:211], v[162:163], v[210:211]
    v_pk_mul_f32 v[212:213], v[164:165], v[212:213]
    v_pk_mul_f32 v[214:215], v[166:167], v[214:215]
    v_pk_mul_f32 v[216:217], v[168:169], v[216:217]
    v_pk_mul_f32 v[218:219], v[170:171], v[218:219]
    v_pk_mul_f32 v[220:221], v[172:173], v[220:221]
    v_pk_mul_f32 v[222:223], v[174:175], v[222:223]
    v_cvt_pk_bf16_f32 v232, v208, v209
    v_cvt_pk_bf16_f32 v233, v210, v211
    v_cvt_pk_bf16_f32 v234, v212, v213
    v_cvt_pk_bf16_f32 v235, v214, v215
    v_cvt_pk_bf16_f32 v236, v216, v217
    v_cvt_pk_bf16_f32 v237, v218, v219
    v_cvt_pk_bf16_f32 v238, v220, v221
    v_cvt_pk_bf16_f32 v239, v222, v223
    buffer_store_dwordx4 v[232:235], v3, s[24:27], s46 offen offset:0 sc1
    buffer_store_dwordx4 v[236:239], v3, s[24:27], s46 offen offset:256 sc1
    v_pk_mul_f32 v[208:209], v[176:177], v[34:35] op_sel_hi:[1,0]
    v_pk_mul_f32 v[210:211], v[178:179], v[34:35] op_sel_hi:[1,0]
    v_pk_mul_f32 v[212:213], v[180:181], v[34:35] op_sel_hi:[1,0]
    v_pk_mul_f32 v[214:215], v[182:183], v[34:35] op_sel_hi:[1,0]
    v_pk_mul_f32 v[216:217], v[184:185], v[8:9] op_sel_hi:[1,0]
    v_pk_mul_f32 v[218:219], v[186:187], v[8:9] op_sel_hi:[1,0]
    v_pk_mul_f32 v[220:221], v[188:189], v[8:9] op_sel_hi:[1,0]
    v_pk_mul_f32 v[222:223], v[190:191], v[8:9] op_sel_hi:[1,0]
    v_exp_f32 v208, v208
    v_exp_f32 v209, v209
    v_exp_f32 v210, v210
    v_exp_f32 v211, v211
    v_exp_f32 v212, v212
    v_exp_f32 v213, v213
    v_exp_f32 v214, v214
    v_exp_f32 v215, v215
    v_exp_f32 v216, v216
    v_exp_f32 v217, v217
    v_exp_f32 v218, v218
    v_exp_f32 v219, v219
    v_exp_f32 v220, v220
SEG_A0_3:
    s_cbranch_execz PAD_A3_1
    v_exp_f32 v221, v221
    v_exp_f32 v222, v222
    v_exp_f32 v223, v223
    v_pk_fma_f32 v[208:209], v[208:209], v[36:37], v[36:37] op_sel_hi:[1,0,0]
    v_pk_fma_f32 v[210:211], v[210:211], v[36:37], v[36:37] op_sel_hi:[1,0,0]
    v_pk_fma_f32 v[212:213], v[212:213], v[36:37], v[36:37] op_sel_hi:[1,0,0]
    v_pk_fma_f32 v[214:215], v[214:215], v[36:37], v[36:37] op_sel_hi:[1,0,0]
    v_pk_fma_f32 v[216:217], v[216:217], v[10:11], v[10:11] op_sel_hi:[1,0,0]
    v_pk_fma_f32 v[218:219], v[218:219], v[10:11], v[10:11] op_sel_hi:[1,0,0]
    v_pk_fma_f32 v[220:221], v[220:221], v[10:11], v[10:11] op_sel_hi:[1,0,0]
    v_pk_fma_f32 v[222:223], v[222:223], v[10:11], v[10:11] op_sel_hi:[1,0,0]
    v_rcp_f32 v208, v208
    v_rcp_f32 v209, v209
    v_rcp_f32 v210, v210
    v_rcp_f32 v211, v211
    v_rcp_f32 v212, v212
    v_rcp_f32 v213, v213
    v_rcp_f32 v214, v214
    v_rcp_f32 v215, v215
    v_rcp_f32 v216, v216
    v_rcp_f32 v217, v217
    v_rcp_f32 v218, v218
    v_rcp_f32 v219, v219
    v_rcp_f32 v220, v220
    v_rcp_f32 v221, v221
    v_rcp_f32 v222, v222
    v_rcp_f32 v223, v223
    v_pk_mul_f32 v[208:209], v[176:177], v[208:209]
    v_pk_mul_f32 v[210:211], v[178:179], v[210:211]
    v_pk_mul_f32 v[212:213], v[180:181], v[212:213]
    v_pk_mul_f32 v[214:215], v[182:183], v[214:215]
    v_pk_mul_f32 v[216:217], v[184:185], v[216:217]
    v_pk_mul_f32 v[218:219], v[186:187], v[218:219]
    v_pk_mul_f32 v[220:221], v[188:189], v[220:221]
    v_pk_mul_f32 v[222:223], v[190:191], v[222:223]
    v_cvt_pk_bf16_f32 v224, v208, v209
    v_cvt_pk_bf16_f32 v225, v210, v211
    v_cvt_pk_bf16_f32 v226, v212, v213
    v_cvt_pk_bf16_f32 v227, v214, v215
    v_cvt_pk_bf16_f32 v228, v216, v217
    v_cvt_pk_bf16_f32 v229, v218, v219
PAD_A3_1:
    s_cbranch_execz RET0_A
    v_cvt_pk_bf16_f32 v230, v220, v221
    v_cvt_pk_bf16_f32 v231, v222, v223
    buffer_store_dwordx4 v[224:227], v3, s[24:27], s62 offen offset:0 sc1
    buffer_store_dwordx4 v[228:231], v3, s[24:27], s62 offen offset:256 sc1
    s_waitcnt vmcnt(2)
    s_mov_b64 exec, 0x3
    buffer_store_dword v37, v38, s[24:27], s70 offen offset:64 sc1
    s_mov_b64 exec, -1
    s_add_u32 s70, s70, 96
    s_branch L_PH2M
L_MB:
    s_and_b32 s48, s45, 15
    s_lshl4_add_u32 s48, s100, s48
    s_lshl_b32 s48, s48, 10
    v_lshlrev_b32 v26, 16, v1
    s_cmp_eq_u32 s55, 0
    s_cselect_b64 exec, 0xffffff, 0
    buffer_load_dword v27, v26, s[12:15], s48 offen offset:384
    s_mov_b64 exec, -1
    s_mov_b32 s20, s34
    s_mov_b32 s21, s35
    s_mov_b32 s34, s30
    s_mov_b32 s35, s31
    s_mov_b32 s66, 0xffff0000
    s_lshr_b32 s56, s45, 2
    s_xor_b32 s56, s56, 6
    s_bfe_u32 s48, s2, 0x10002
    s_lshl2_add_u32 s54, s48, s54
    s_mov_b32 s30, 0x200000
    s_mov_b32 s31, 0x20000
    s_mov_b32 s22, 0x80000
    s_mov_b32 s23, 0x20000
    s_mov_b32 s16, s18
    s_mov_b32 s17, s19
    s_mov_b32 s18, 0x1c0000
    s_mov_b32 s19, 0x20000
    s_add_u32 s24, s24, 0x0
    s_addc_u32 s25, s25, 0
    s_mov_b32 s26, 25165824
    s_mov_b32 s27, 0x20000
    s_and_b32 s53, s100, 1
    s_lshr_b32 s52, s100, 1
    v_bfe_u32 v22, v1, 2, 2
    v_lshl_add_u32 v22, v21, 3, v22
    v_bfe_u32 v23, v1, 4, 1
    v_lshlrev_b32 v23, 5, v23
    v_and_b32 v24, 1, v1
    v_lshl_add_u32 v23, v24, 4, v23
    v_bfe_u32 v24, v1, 1, 1
    v_lshl_add_u32 v23, v24, 3, v23
    v_bfe_u32 v24, v1, 3, 1
    v_lshl_add_u32 v23, v24, 6, v23
    v_lshl_add_u32 v7, v22, 7, v23
    s_mov_b32 s97, s52
    s_mov_b32 s96, s53
    v_bfe_u32 v23, v1, 1, 3
    v_xor_b32 v23, v23, v21
    v_lshlrev_b32 v23, 4, v23
    v_lshl_add_u32 v23, v20, 7, v23
    s_add_u32 s48, s40, 49152
    v_add_u32 v192, s48, v23
    v_xor_b32 v193, 32, v192
    v_xor_b32 v194, 64, v192
    v_xor_b32 v195, 0x60, v192
    s_lshl1_add_u32 s48, s47, s97
    s_lshr_b32 s49, s101, 2
    s_lshl1_add_u32 s48, s48, s49
    s_lshl_b32 s48, s48, 10
    s_and_b32 s49, s101, 3
    s_lshl1_add_u32 s49, s49, s96
    s_lshl2_add_u32 s48, s49, s48
    s_add_u32 s70, s48, 12189696
    v_and_b32 v2, 15, v1
    v_lshrrev_b32 v3, 4, v1
    v_bfe_u32 v23, v1, 1, 3
    v_xor_b32 v23, v23, v3
    v_lshlrev_b32 v23, 4, v23
    v_lshl_add_u32 v23, v2, 7, v23
    s_add_u32 s48, s40, 49152
    v_add_u32 v192, s48, v23
    v_xor_b32 v193, 64, v192
    v_xor_b32 v194, 0x1000, v192
    v_xor_b32 v195, 0x1000, v193
    v_bfe_u32 v22, v1, 2, 2
    v_lshl_add_u32 v22, v3, 3, v22
    v_and_b32 v23, 0x18, v7
    v_lshlrev_b32 v23, 0, v23
    v_bfe_u32 v24, v1, 4, 1
    v_lshl_add_u32 v23, v24, 5, v23
    v_bfe_u32 v24, v1, 3, 1
    v_lshl_add_u32 v23, v24, 6, v23
    v_lshl_add_u32 v15, v22, 7, v23
    v_and_b32 v4, 3, v1
    v_lshl_add_u32 v4, v24, 2, v4
    v_bfe_u32 v24, v1, 2, 1
    v_lshl_add_u32 v4, v24, 3, v4
    v_lshlrev_b32 v2, 4, v2
    v_lshl_add_u32 v3, v3, 9, v2
    s_and_b32 s48, s96, 1
    s_lshl_b32 s48, s48, 6
    v_xor_b32 v200, s48, v15
    s_lshr_b32 s48, s96, 1
    s_lshl_b32 s48, s48, 13
    s_add_u32 s48, s48, 65536
    v_add_u32 v200, s48, v200
    s_lshl_b32 s48, s97, 5
    v_xor_b32 v200, s48, v200
    s_lshl_b32 s49, s96, 7
    s_add_u32 s49, s49, 162816
    s_lshl_b32 s48, s97, 6
    v_lshrrev_b32 v14, 2, v2
    v_xor_b32 v14, s48, v14
    v_add_u32 v14, s49, v14
    v_xor_b32 v236, 64, v14
    v_xor_b32 v203, 32, v200
    s_lshl_b32 s48, s101, 4
    s_add_u32 s48, s48, s47
    s_mul_i32 s48, s48, 4608
    s_add_u32 s48, s48, 10485760
    s_xor_b32 s50, s97, 1
    s_lshl_b32 s49, s96, 1
    s_add_u32 s49, s49, s50
    s_lshl_b32 s50, s49, 10
    s_add_u32 s62, s48, s50
    s_lshl_b32 s50, s49, 7
    s_add_u32 s57, s48, s50
    s_add_u32 s57, s57, 4096
    s_lshl2_add_u32 s98, s101, s49
    s_lshl_b32 s98, s98, 11
    s_lshl2_add_u32 s98, s47, s98
    s_add_u32 s98, s98, 12320768
    v_and_b32 v22, 0x13, v1
    v_and_b32 v25, 4, v1
    v_lshl_or_b32 v22, v25, 1, v22
    v_and_b32 v25, 8, v1
    v_lshrrev_b32 v25, 1, v25
    v_or_b32 v22, v22, v25
    v_lshlrev_b32 v3, 2, v22
    v_mov_b32 v56, -1
    v_mov_b32 v57, -1
    v_mov_b32 v58, -1
    v_mov_b32 v59, -1
    buffer_store_dwordx4 v[56:59], v6, s[24:27], s62 offen sc1
    buffer_store_dword v56, v3, s[24:27], s57 offen sc1
    v_lshlrev_b32 v23, 4, v21
    v_sub_u32 v22, v22, v23
    v_ashrrev_i32 v32, 1, v22
    v_and_b32 v33, 1, v22
    v_lshlrev_b32 v33, 4, v33
    v_mov_b32 v22, 0x3f80
    v_lshlrev_b32 v33, v33, v22
    v_bfe_u32 v16, v1, 2, 2
    v_lshl_add_u32 v16, v21, 2, v16
    v_lshlrev_b32 v16, 5, v16
    v_bfe_u32 v22, v1, 4, 1
    v_lshl_add_u32 v16, v22, 4, v16
    v_bfe_u32 v22, v1, 1, 1
    v_lshl_add_u32 v16, v22, 3, v16
    s_lshl_b32 s48, s96, 10
    s_lshl_b32 s49, s97, 9
    s_add_u32 s48, s48, s49
    s_add_u32 s48, s48, 155648
    v_add_u32 v16, s48, v16
    v_xor_b32 v15, 0x200, v16
    s_lshl_b32 s48, s100, 9
    s_add_u32 s49, s48, 157696
    v_lshrrev_b32 v17, 4, v1
    v_lshlrev_b32 v17, 6, v17
    v_add_u32 v17, s49, v17
    v_xor_b32 v18, 0x200, v17
    s_add_u32 s49, s48, 159744
    v_lshlrev_b32 v2, 3, v1
    v_add_u32 v2, s49, v2
    v_bfe_u32 v19, v1, 2, 1
    v_mul_u32_u24 v19, 0x8000, v19
    v_lshl_or_b32 v19, v19, 16, v19
    v_and_b32 v11, 15, v1
    v_add_u32 v11, v11, v23
    v_lshlrev_b32 v11, 4, v11
    s_lshl_b32 s48, s100, 11
    s_add_u32 s48, s48, 147456
    v_and_b32 v5, 0x2f0, v6
    v_add_u32 v5, s48, v5
    v_min_u32 v12, 16, v20
    v_mul_u32_u24 v12, 80, v12
    v_lshl_add_u32 v12, v21, 5, v12
    v_add_u32 v12, s48, v12
    v_xor_b32 v13, 0x1000, v12
    v_lshlrev_b32 v10, 1, v20
    v_add_u32 v10, s48, v10
    v_lshrrev_b32 v8, 4, v1
    v_and_b32 v9, 15, v1
    v_mul_u32_u24 v9, 80, v9
    v_lshl_add_u32 v9, v8, 4, v9
    v_add_u32 v9, s48, v9
    s_xor_b32 s48, s48, 0x1000
    v_add_u32 v4, s48, v6
    s_lshl1_add_u32 s48, s96, s97
    s_mul_i32 s49, s48, 896
    s_sub_u32 s49, 4096, s49
    v_lshlrev_b32 v8, 2, v20
    v_add_u32 v8, s49, v8
    s_mul_i32 s49, s101, 73728
    s_lshl_b32 s50, s48, 10
    s_add_u32 s49, s49, s50
    s_add_u32 s58, s49, 10485760
    s_lshl2_add_u32 s48, s101, s48
    s_and_b32 s49, s47, 3
    s_lshl4_add_u32 s48, s48, s49
    s_lshl_b32 s48, s48, 7
    s_add_u32 s6, s48, 12320768
    s_mov_b32 s59, 0xff
    s_mov_b32 s3, 0
    s_lshl_b32 s48, s47, 2
    s_add_u32 s48, s48, s100
    s_xor_b32 s50, s48, 1
    s_mul_i32 s48, s48, 144
    s_mul_i32 s50, s50, 144
    s_lshl_b32 s49, s101, 2
    s_lshl_b32 s51, s96, 1
    s_add_u32 s49, s49, s51
    s_add_u32 s49, s49, s97
    s_add_u32 s49, s49, 112
    s_add_u32 s48, s48, s49
    s_add_u32 s50, s50, s49
    s_lshl_b32 s63, s48, 10
    s_lshl_b32 s64, s50, 10
    s_lshl1_add_u32 s48, s47, s55
    s_lshl1_add_u32 s49, s48, s52
    s_and_b32 s50, s56, 1
    s_lshl3_add_u32 s49, s49, s50
    s_lshl_b32 s49, s49, 7
    s_add_u32 s71, s49, 12189696
    s_lshl1_add_u32 s48, s48, s53
    s_mul_i32 s49, s48, 144
    s_lshl4_add_u32 s49, s52, s49
    s_add_u32 s49, s49, 112
    s_lshl_b32 s4, s49, 10
    s_lshl_b32 s48, s100, 5
    s_add_u32 s48, s48, 161856
    v_lshlrev_b32 v39, 4, v21
    v_add_u32 v39, s48, v39
    s_mov_b64 exec, 0
    s_mov_b64 vcc, 1
    s_cmp_eq_u32 s100, 0
    s_cbranch_scc1 SEG_B0_0
    s_cmp_eq_u32 s100, 1
    s_cbranch_scc1 SEG_B0_1
    s_cmp_eq_u32 s100, 2
    s_cbranch_scc1 SEG_B0_2
    s_branch SEG_B0_3
RET0_B:
    s_mov_b64 exec, -1
    s_waitcnt lgkmcnt(0)
    s_setprio 2
    s_barrier
    ds_read_b128 v[176:179], v192 offset:0
    ds_read_b64_tr_b16 v[208:209], v200 offset:0
    ds_read_b64_tr_b16 v[210:211], v200 offset:512
    ds_read_b128 v[180:183], v192 offset:2048
    ds_read_b128 v[184:187], v194 offset:0
    ds_read_b128 v[188:191], v194 offset:2048
    ds_read_b64_tr_b16 v[212:213], v200 offset:8192
    ds_read_b64_tr_b16 v[214:215], v200 offset:8704
    ds_read_b64_tr_b16 v[216:217], v200 offset:16384
    ds_read_b64_tr_b16 v[218:219], v200 offset:16896
    s_waitcnt lgkmcnt(6)
    v_mfma_f32_16x16x32_bf16 v[80:83], v[208:211], v[176:179], 0
    ds_read_b64_tr_b16 v[224:225], v203 offset:0
    v_mfma_f32_16x16x32_bf16 v[88:91], v[208:211], v[180:183], 0
    ds_read_b64_tr_b16 v[226:227], v203 offset:512
    s_waitcnt lgkmcnt(6)
    v_mfma_f32_16x16x32_bf16 v[96:99], v[208:211], v[184:187], 0
    ds_read_b64_tr_b16 v[228:229], v203 offset:8192
    v_mfma_f32_16x16x32_bf16 v[104:107], v[208:211], v[188:191], 0
    ds_read_b64_tr_b16 v[230:231], v203 offset:8704
    s_waitcnt lgkmcnt(6)
    v_mfma_f32_16x16x32_bf16 v[112:115], v[212:215], v[176:179], 0
    ds_read_b64_tr_b16 v[232:233], v203 offset:16384
    v_mfma_f32_16x16x32_bf16 v[120:123], v[212:215], v[180:183], 0
    ds_read_b64_tr_b16 v[234:235], v203 offset:16896
    v_mfma_f32_16x16x32_bf16 v[128:131], v[212:215], v[184:187], 0
    ds_read_b128 v[40:43], v193 offset:0
    v_mfma_f32_16x16x32_bf16 v[136:139], v[212:215], v[188:191], 0
    ds_read_b128 v[44:47], v193 offset:2048
    s_waitcnt lgkmcnt(8)
    v_mfma_f32_16x16x32_bf16 v[144:147], v[176:179], v[216:219], 0
    v_add_u32 v192, 0xc000, v192
    v_mfma_f32_16x16x32_bf16 v[152:155], v[180:183], v[216:219], 0
    v_add_u32 v194, 0xc000, v194
    v_mfma_f32_16x16x32_bf16 v[160:163], v[184:187], v[216:219], 0
    v_mfma_f32_16x16x32_bf16 v[168:171], v[188:191], v[216:219], 0
    s_waitcnt lgkmcnt(6)
    v_mfma_f32_16x16x32_bf16 v[84:87], v[224:227], v[176:179], 0
    ds_read_b128 v[48:51], v195 offset:0
    v_mfma_f32_16x16x32_bf16 v[92:95], v[224:227], v[180:183], 0
    ds_read_b128 v[52:55], v195 offset:2048
    v_mfma_f32_16x16x32_bf16 v[100:103], v[224:227], v[184:187], 0
    ds_read_b64_tr_b16 v[208:209], v200 offset:4096
    v_mfma_f32_16x16x32_bf16 v[108:111], v[224:227], v[188:191], 0
    ds_read_b64_tr_b16 v[210:211], v200 offset:4608
    s_waitcnt lgkmcnt(8)
    v_mfma_f32_16x16x32_bf16 v[116:119], v[228:231], v[176:179], 0
    ds_read_b64_tr_b16 v[212:213], v200 offset:12288
    v_mfma_f32_16x16x32_bf16 v[124:127], v[228:231], v[180:183], 0
    ds_read_b64_tr_b16 v[214:215], v200 offset:12800
    v_mfma_f32_16x16x32_bf16 v[132:135], v[228:231], v[184:187], 0
    ds_read_b64_tr_b16 v[216:217], v200 offset:20480
    v_mfma_f32_16x16x32_bf16 v[140:143], v[228:231], v[188:191], 0
    ds_read_b64_tr_b16 v[218:219], v200 offset:20992
    s_waitcnt lgkmcnt(10)
    v_mfma_f32_16x16x32_bf16 v[148:151], v[176:179], v[232:235], 0
    v_add_u32 v193, 0xc000, v193
    v_mfma_f32_16x16x32_bf16 v[156:159], v[180:183], v[232:235], 0
    v_add_u32 v200, 0xc000, v200
    v_mfma_f32_16x16x32_bf16 v[164:167], v[184:187], v[232:235], 0
    v_mfma_f32_16x16x32_bf16 v[172:175], v[188:191], v[232:235], 0
    s_waitcnt lgkmcnt(4)
    v_mfma_f32_16x16x32_bf16 v[80:83], v[208:211], v[40:43], v[80:83]
    ds_read_b64_tr_b16 v[224:225], v203 offset:4096
    v_mfma_f32_16x16x32_bf16 v[88:91], v[208:211], v[44:47], v[88:91]
    ds_read_b64_tr_b16 v[226:227], v203 offset:4608
    v_mfma_f32_16x16x32_bf16 v[96:99], v[208:211], v[48:51], v[96:99]
    ds_read_b64_tr_b16 v[228:229], v203 offset:12288
    v_mfma_f32_16x16x32_bf16 v[104:107], v[208:211], v[52:55], v[104:107]
    ds_read_b64_tr_b16 v[230:231], v203 offset:12800
    s_waitcnt lgkmcnt(6)
    v_mfma_f32_16x16x32_bf16 v[112:115], v[212:215], v[40:43], v[112:115]
    ds_read_b64_tr_b16 v[232:233], v203 offset:20480
    v_mfma_f32_16x16x32_bf16 v[120:123], v[212:215], v[44:47], v[120:123]
    ds_read_b64_tr_b16 v[234:235], v203 offset:20992
    v_mfma_f32_16x16x32_bf16 v[128:131], v[212:215], v[48:51], v[128:131]
    v_mfma_f32_16x16x32_bf16 v[136:139], v[212:215], v[52:55], v[136:139]
    v_add_u32 v195, 0xc000, v195
    s_waitcnt lgkmcnt(6)
    v_mfma_f32_16x16x32_bf16 v[144:147], v[40:43], v[216:219], v[144:147]
    v_add_u32 v203, 0xc000, v203
    v_mfma_f32_16x16x32_bf16 v[152:155], v[44:47], v[216:219], v[152:155]
    v_mfma_f32_16x16x32_bf16 v[160:163], v[48:51], v[216:219], v[160:163]
    v_mfma_f32_16x16x32_bf16 v[168:171], v[52:55], v[216:219], v[168:171]
    s_waitcnt lgkmcnt(4)
    v_mfma_f32_16x16x32_bf16 v[84:87], v[224:227], v[40:43], v[84:87]
    v_mfma_f32_16x16x32_bf16 v[92:95], v[224:227], v[44:47], v[92:95]
    s_waitcnt lgkmcnt(0)
    s_barrier
    ds_read_b128 v[176:179], v192 offset:0
    v_mfma_f32_16x16x32_bf16 v[100:103], v[224:227], v[48:51], v[100:103]
    ds_read_b64_tr_b16 v[208:209], v200 offset:0
    v_mfma_f32_16x16x32_bf16 v[108:111], v[224:227], v[52:55], v[108:111]
    ds_read_b64_tr_b16 v[210:211], v200 offset:512
    v_mfma_f32_16x16x32_bf16 v[116:119], v[228:231], v[40:43], v[116:119]
    ds_read_b128 v[180:183], v192 offset:2048
    v_mfma_f32_16x16x32_bf16 v[124:127], v[228:231], v[44:47], v[124:127]
    ds_read_b128 v[184:187], v194 offset:0
    v_mfma_f32_16x16x32_bf16 v[132:135], v[228:231], v[48:51], v[132:135]
    ds_read_b128 v[188:191], v194 offset:2048
    v_mfma_f32_16x16x32_bf16 v[140:143], v[228:231], v[52:55], v[140:143]
    ds_read_b64_tr_b16 v[212:213], v200 offset:8192
    v_mfma_f32_16x16x32_bf16 v[148:151], v[40:43], v[232:235], v[148:151]
    ds_read_b64_tr_b16 v[214:215], v200 offset:8704
    v_mfma_f32_16x16x32_bf16 v[156:159], v[44:47], v[232:235], v[156:159]
    ds_read_b64_tr_b16 v[216:217], v200 offset:16384
    v_mfma_f32_16x16x32_bf16 v[164:167], v[48:51], v[232:235], v[164:167]
    ds_read_b64_tr_b16 v[218:219], v200 offset:16896
    v_mfma_f32_16x16x32_bf16 v[172:175], v[52:55], v[232:235], v[172:175]
    s_waitcnt lgkmcnt(6)
    v_mfma_f32_16x16x32_bf16 v[80:83], v[208:211], v[176:179], v[80:83]
    ds_read_b64_tr_b16 v[224:225], v203 offset:0
    v_mfma_f32_16x16x32_bf16 v[88:91], v[208:211], v[180:183], v[88:91]
    ds_read_b64_tr_b16 v[226:227], v203 offset:512
    s_waitcnt lgkmcnt(6)
    v_mfma_f32_16x16x32_bf16 v[96:99], v[208:211], v[184:187], v[96:99]
    ds_read_b64_tr_b16 v[228:229], v203 offset:8192
    v_mfma_f32_16x16x32_bf16 v[104:107], v[208:211], v[188:191], v[104:107]
    ds_read_b64_tr_b16 v[230:231], v203 offset:8704
    s_waitcnt lgkmcnt(6)
    v_mfma_f32_16x16x32_bf16 v[112:115], v[212:215], v[176:179], v[112:115]
    ds_read_b64_tr_b16 v[232:233], v203 offset:16384
    v_mfma_f32_16x16x32_bf16 v[120:123], v[212:215], v[180:183], v[120:123]
    ds_read_b64_tr_b16 v[234:235], v203 offset:16896
    v_mfma_f32_16x16x32_bf16 v[128:131], v[212:215], v[184:187], v[128:131]
    ds_read_b128 v[40:43], v193 offset:0
    v_mfma_f32_16x16x32_bf16 v[136:139], v[212:215], v[188:191], v[136:139]
    ds_read_b128 v[44:47], v193 offset:2048
    s_waitcnt lgkmcnt(8)
    v_mfma_f32_16x16x32_bf16 v[144:147], v[176:179], v[216:219], v[144:147]
    v_add_u32 v192, 0xfffe8000, v192
    v_mfma_f32_16x16x32_bf16 v[152:155], v[180:183], v[216:219], v[152:155]
    s_waitcnt vmcnt(3)
    v_lshlrev_b32 v240, 16, v64
    v_and_b32 v241, s66, v64
    v_lshlrev_b32 v242, 16, v65
    v_and_b32 v243, s66, v65
    v_lshlrev_b32 v244, 16, v66
    v_and_b32 v245, s66, v66
    v_lshlrev_b32 v246, 16, v67
    v_and_b32 v247, s66, v67
    v_lshlrev_b32 v248, 16, v68
    v_and_b32 v249, s66, v68
    v_lshlrev_b32 v250, 16, v69
    v_and_b32 v251, s66, v69
    v_lshlrev_b32 v252, 16, v70
    v_and_b32 v253, s66, v70
    v_lshlrev_b32 v254, 16, v71
    v_and_b32 v255, s66, v71
    v_pk_add_f32 v[64:65], v[240:241], v[242:243]
    v_pk_add_f32 v[66:67], v[244:245], v[246:247]
    v_pk_add_f32 v[64:65], v[64:65], v[248:249]
    v_pk_add_f32 v[66:67], v[66:67], v[250:251]
    v_pk_add_f32 v[64:65], v[64:65], v[252:253]
    v_pk_add_f32 v[66:67], v[66:67], v[254:255]
    v_pk_add_f32 v[64:65], v[64:65], v[66:67]
    v_add_f32 v34, v64, v65
    s_nop 1
    v_add_f32_dpp v34, v34, v34 quad_perm:[1,0,3,2] row_mask:0xf bank_mask:0xf
    s_nop 1
    v_add_f32_dpp v34, v34, v34 quad_perm:[2,3,0,1] row_mask:0xf bank_mask:0xf
    s_nop 1
    v_add_f32_dpp v34, v34, v34 row_half_mirror row_mask:0xf bank_mask:0xf
    s_nop 1
    v_add_f32_dpp v34, v34, v34 row_mirror row_mask:0xf bank_mask:0xf
    v_mov_b32 v64, v34
    s_nop 1
    v_permlane16_swap_b32 v34, v64
    v_add_f32 v34, v34, v64
    v_mul_f32 v34, 0x3b000000, v34
    v_pk_add_f32 v[240:241], v[240:241], v[34:35] op_sel_hi:[1,0] neg_lo:[0,1] neg_hi:[0,1]
    v_pk_add_f32 v[242:243], v[242:243], v[34:35] op_sel_hi:[1,0] neg_lo:[0,1] neg_hi:[0,1]
    v_pk_add_f32 v[244:245], v[244:245], v[34:35] op_sel_hi:[1,0] neg_lo:[0,1] neg_hi:[0,1]
    v_pk_add_f32 v[246:247], v[246:247], v[34:35] op_sel_hi:[1,0] neg_lo:[0,1] neg_hi:[0,1]
    v_pk_add_f32 v[248:249], v[248:249], v[34:35] op_sel_hi:[1,0] neg_lo:[0,1] neg_hi:[0,1]
    v_pk_add_f32 v[250:251], v[250:251], v[34:35] op_sel_hi:[1,0] neg_lo:[0,1] neg_hi:[0,1]
    v_pk_add_f32 v[252:253], v[252:253], v[34:35] op_sel_hi:[1,0] neg_lo:[0,1] neg_hi:[0,1]
    v_pk_add_f32 v[254:255], v[254:255], v[34:35] op_sel_hi:[1,0] neg_lo:[0,1] neg_hi:[0,1]
    v_pk_mul_f32 v[64:65], v[240:241], v[240:241]
    v_pk_mul_f32 v[66:67], v[242:243], v[242:243]
    v_pk_fma_f32 v[64:65], v[244:245], v[244:245], v[64:65]
    v_pk_fma_f32 v[66:67], v[246:247], v[246:247], v[66:67]
    v_pk_fma_f32 v[64:65], v[248:249], v[248:249], v[64:65]
    v_pk_fma_f32 v[66:67], v[250:251], v[250:251], v[66:67]
    v_pk_fma_f32 v[64:65], v[252:253], v[252:253], v[64:65]
    v_pk_fma_f32 v[66:67], v[254:255], v[254:255], v[66:67]
    v_pk_add_f32 v[64:65], v[64:65], v[66:67]
    v_add_f32 v36, v64, v65
    s_nop 1
    v_add_f32_dpp v36, v36, v36 quad_perm:[1,0,3,2] row_mask:0xf bank_mask:0xf
    s_nop 1
    v_add_f32_dpp v36, v36, v36 quad_perm:[2,3,0,1] row_mask:0xf bank_mask:0xf
    s_nop 1
    v_add_f32_dpp v36, v36, v36 row_half_mirror row_mask:0xf bank_mask:0xf
    s_nop 1
    v_add_f32_dpp v36, v36, v36 row_mirror row_mask:0xf bank_mask:0xf
    v_mov_b32 v64, v36
    s_nop 1
    v_permlane16_swap_b32 v36, v64
    v_add_f32 v36, v36, v64
    v_mov_b32 v64, 0x3727c5ac
    v_fmac_f32 v64, 0x3b000000, v36
    v_rsq_f32 v35, v64
    v_sqrt_f32 v36, v64
    ds_write_b96 v39, v[34:36]
    v_add_u32 v194, 0xfffe8000, v194
    v_mfma_f32_16x16x32_bf16 v[160:163], v[184:187], v[216:219], v[160:163]
    v_mfma_f32_16x16x32_bf16 v[168:171], v[188:191], v[216:219], v[168:171]
    s_waitcnt lgkmcnt(7)
    v_mfma_f32_16x16x32_bf16 v[84:87], v[224:227], v[176:179], v[84:87]
    ds_read_b128 v[48:51], v195 offset:0
    v_mfma_f32_16x16x32_bf16 v[92:95], v[224:227], v[180:183], v[92:95]
    ds_read_b128 v[52:55], v195 offset:2048
    v_mfma_f32_16x16x32_bf16 v[100:103], v[224:227], v[184:187], v[100:103]
    ds_read_b64_tr_b16 v[208:209], v200 offset:4096
    v_mfma_f32_16x16x32_bf16 v[108:111], v[224:227], v[188:191], v[108:111]
    ds_read_b64_tr_b16 v[210:211], v200 offset:4608
    s_waitcnt lgkmcnt(9)
    v_mfma_f32_16x16x32_bf16 v[116:119], v[228:231], v[176:179], v[116:119]
    ds_read_b64_tr_b16 v[212:213], v200 offset:12288
    v_mfma_f32_16x16x32_bf16 v[124:127], v[228:231], v[180:183], v[124:127]
    ds_read_b64_tr_b16 v[214:215], v200 offset:12800
    v_mfma_f32_16x16x32_bf16 v[132:135], v[228:231], v[184:187], v[132:135]
    ds_read_b64_tr_b16 v[216:217], v200 offset:20480
    v_mfma_f32_16x16x32_bf16 v[140:143], v[228:231], v[188:191], v[140:143]
    ds_read_b64_tr_b16 v[218:219], v200 offset:20992
    s_waitcnt lgkmcnt(11)
    v_mfma_f32_16x16x32_bf16 v[148:151], v[176:179], v[232:235], v[148:151]
    v_add_u32 v193, 0xfffe8000, v193
    v_mfma_f32_16x16x32_bf16 v[156:159], v[180:183], v[232:235], v[156:159]
    v_add_u32 v200, 0xfffe8000, v200
    v_mfma_f32_16x16x32_bf16 v[164:167], v[184:187], v[232:235], v[164:167]
    v_mfma_f32_16x16x32_bf16 v[172:175], v[188:191], v[232:235], v[172:175]
    s_waitcnt lgkmcnt(4)
    v_mfma_f32_16x16x32_bf16 v[80:83], v[208:211], v[40:43], v[80:83]
    ds_read_b64_tr_b16 v[224:225], v203 offset:4096
    v_mfma_f32_16x16x32_bf16 v[88:91], v[208:211], v[44:47], v[88:91]
    ds_read_b64_tr_b16 v[226:227], v203 offset:4608
    v_mfma_f32_16x16x32_bf16 v[96:99], v[208:211], v[48:51], v[96:99]
    ds_read_b64_tr_b16 v[228:229], v203 offset:12288
    v_mfma_f32_16x16x32_bf16 v[104:107], v[208:211], v[52:55], v[104:107]
    ds_read_b64_tr_b16 v[230:231], v203 offset:12800
    s_waitcnt lgkmcnt(6)
    v_mfma_f32_16x16x32_bf16 v[112:115], v[212:215], v[40:43], v[112:115]
    ds_read_b64_tr_b16 v[232:233], v203 offset:20480
    v_mfma_f32_16x16x32_bf16 v[120:123], v[212:215], v[44:47], v[120:123]
    ds_read_b64_tr_b16 v[234:235], v203 offset:20992
    v_mfma_f32_16x16x32_bf16 v[128:131], v[212:215], v[48:51], v[128:131]
    v_mfma_f32_16x16x32_bf16 v[136:139], v[212:215], v[52:55], v[136:139]
    v_add_u32 v195, 0xfffe8000, v195
    s_waitcnt lgkmcnt(6)
    v_mfma_f32_16x16x32_bf16 v[144:147], v[40:43], v[216:219], v[144:147]
    v_add_u32 v203, 0xfffe8000, v203
    v_mfma_f32_16x16x32_bf16 v[152:155], v[44:47], v[216:219], v[152:155]
    v_mfma_f32_16x16x32_bf16 v[160:163], v[48:51], v[216:219], v[160:163]
    v_mfma_f32_16x16x32_bf16 v[168:171], v[52:55], v[216:219], v[168:171]
    s_waitcnt lgkmcnt(4)
    v_mfma_f32_16x16x32_bf16 v[84:87], v[224:227], v[40:43], v[84:87]
    v_mfma_f32_16x16x32_bf16 v[92:95], v[224:227], v[44:47], v[92:95]
    s_waitcnt lgkmcnt(0)
    s_barrier
    ds_read_b128 v[176:179], v192 offset:0
    v_mfma_f32_16x16x32_bf16 v[100:103], v[224:227], v[48:51], v[100:103]
    ds_read_b64_tr_b16 v[208:209], v200 offset:0
    v_mfma_f32_16x16x32_bf16 v[108:111], v[224:227], v[52:55], v[108:111]
    ds_read_b64_tr_b16 v[210:211], v200 offset:512
    v_mfma_f32_16x16x32_bf16 v[116:119], v[228:231], v[40:43], v[116:119]
    ds_read_b128 v[180:183], v192 offset:2048
    v_mfma_f32_16x16x32_bf16 v[124:127], v[228:231], v[44:47], v[124:127]
    ds_read_b128 v[184:187], v194 offset:0
    v_mfma_f32_16x16x32_bf16 v[132:135], v[228:231], v[48:51], v[132:135]
    ds_read_b128 v[188:191], v194 offset:2048
    v_mfma_f32_16x16x32_bf16 v[140:143], v[228:231], v[52:55], v[140:143]
    ds_read_b64_tr_b16 v[212:213], v200 offset:8192
    v_mfma_f32_16x16x32_bf16 v[148:151], v[40:43], v[232:235], v[148:151]
    ds_read_b64_tr_b16 v[214:215], v200 offset:8704
    v_mfma_f32_16x16x32_bf16 v[156:159], v[44:47], v[232:235], v[156:159]
    ds_read_b64_tr_b16 v[216:217], v200 offset:16384
    v_mfma_f32_16x16x32_bf16 v[164:167], v[48:51], v[232:235], v[164:167]
    ds_read_b64_tr_b16 v[218:219], v200 offset:16896
    v_mfma_f32_16x16x32_bf16 v[172:175], v[52:55], v[232:235], v[172:175]
    s_waitcnt lgkmcnt(6)
    v_mfma_f32_16x16x32_bf16 v[80:83], v[208:211], v[176:179], v[80:83]
    ds_read_b64_tr_b16 v[224:225], v203 offset:0
    v_mfma_f32_16x16x32_bf16 v[88:91], v[208:211], v[180:183], v[88:91]
    ds_read_b64_tr_b16 v[226:227], v203 offset:512
    s_waitcnt lgkmcnt(6)
    v_mfma_f32_16x16x32_bf16 v[96:99], v[208:211], v[184:187], v[96:99]
    ds_read_b64_tr_b16 v[228:229], v203 offset:8192
    v_mfma_f32_16x16x32_bf16 v[104:107], v[208:211], v[188:191], v[104:107]
    ds_read_b64_tr_b16 v[230:231], v203 offset:8704
    s_waitcnt lgkmcnt(6)
    v_mfma_f32_16x16x32_bf16 v[112:115], v[212:215], v[176:179], v[112:115]
    ds_read_b64_tr_b16 v[232:233], v203 offset:16384
    v_mfma_f32_16x16x32_bf16 v[120:123], v[212:215], v[180:183], v[120:123]
    ds_read_b64_tr_b16 v[234:235], v203 offset:16896
    v_mfma_f32_16x16x32_bf16 v[128:131], v[212:215], v[184:187], v[128:131]
    ds_read_b128 v[40:43], v193 offset:0
    v_mfma_f32_16x16x32_bf16 v[136:139], v[212:215], v[188:191], v[136:139]
    ds_read_b128 v[44:47], v193 offset:2048
    s_waitcnt lgkmcnt(8)
    v_mfma_f32_16x16x32_bf16 v[144:147], v[176:179], v[216:219], v[144:147]
    v_add_u32 v192, 0xc000, v192
    v_mfma_f32_16x16x32_bf16 v[152:155], v[180:183], v[216:219], v[152:155]
    v_add_u32 v194, 0xc000, v194
    v_mfma_f32_16x16x32_bf16 v[160:163], v[184:187], v[216:219], v[160:163]
    v_mfma_f32_16x16x32_bf16 v[168:171], v[188:191], v[216:219], v[168:171]
    s_waitcnt lgkmcnt(6)
    v_mfma_f32_16x16x32_bf16 v[84:87], v[224:227], v[176:179], v[84:87]
    ds_read_b128 v[48:51], v195 offset:0
    v_mfma_f32_16x16x32_bf16 v[92:95], v[224:227], v[180:183], v[92:95]
    ds_read_b128 v[52:55], v195 offset:2048
    v_mfma_f32_16x16x32_bf16 v[100:103], v[224:227], v[184:187], v[100:103]
    ds_read_b64_tr_b16 v[208:209], v200 offset:4096
    v_mfma_f32_16x16x32_bf16 v[108:111], v[224:227], v[188:191], v[108:111]
    ds_read_b64_tr_b16 v[210:211], v200 offset:4608
    s_waitcnt lgkmcnt(8)
    v_mfma_f32_16x16x32_bf16 v[116:119], v[228:231], v[176:179], v[116:119]
    ds_read_b64_tr_b16 v[212:213], v200 offset:12288
    v_mfma_f32_16x16x32_bf16 v[124:127], v[228:231], v[180:183], v[124:127]
    ds_read_b64_tr_b16 v[214:215], v200 offset:12800
    v_mfma_f32_16x16x32_bf16 v[132:135], v[228:231], v[184:187], v[132:135]
    ds_read_b64_tr_b16 v[216:217], v200 offset:20480
    v_mfma_f32_16x16x32_bf16 v[140:143], v[228:231], v[188:191], v[140:143]
    ds_read_b64_tr_b16 v[218:219], v200 offset:20992
    s_waitcnt lgkmcnt(10)
    v_mfma_f32_16x16x32_bf16 v[148:151], v[176:179], v[232:235], v[148:151]
    v_add_u32 v193, 0xc000, v193
    v_mfma_f32_16x16x32_bf16 v[156:159], v[180:183], v[232:235], v[156:159]
    v_add_u32 v200, 0xc000, v200
    v_mfma_f32_16x16x32_bf16 v[164:167], v[184:187], v[232:235], v[164:167]
    v_mfma_f32_16x16x32_bf16 v[172:175], v[188:191], v[232:235], v[172:175]
    s_waitcnt lgkmcnt(4)
    v_mfma_f32_16x16x32_bf16 v[80:83], v[208:211], v[40:43], v[80:83]
    ds_read_b64_tr_b16 v[224:225], v203 offset:4096
    v_mfma_f32_16x16x32_bf16 v[88:91], v[208:211], v[44:47], v[88:91]
    ds_read_b64_tr_b16 v[226:227], v203 offset:4608
    v_mfma_f32_16x16x32_bf16 v[96:99], v[208:211], v[48:51], v[96:99]
    ds_read_b64_tr_b16 v[228:229], v203 offset:12288
    v_mfma_f32_16x16x32_bf16 v[104:107], v[208:211], v[52:55], v[104:107]
    ds_read_b64_tr_b16 v[230:231], v203 offset:12800
    s_waitcnt lgkmcnt(6)
    v_mfma_f32_16x16x32_bf16 v[112:115], v[212:215], v[40:43], v[112:115]
    ds_read_b64_tr_b16 v[232:233], v203 offset:20480
    v_mfma_f32_16x16x32_bf16 v[120:123], v[212:215], v[44:47], v[120:123]
    ds_read_b64_tr_b16 v[234:235], v203 offset:20992
    v_mfma_f32_16x16x32_bf16 v[128:131], v[212:215], v[48:51], v[128:131]
    v_mfma_f32_16x16x32_bf16 v[136:139], v[212:215], v[52:55], v[136:139]
    v_add_u32 v195, 0xc000, v195
    s_waitcnt lgkmcnt(6)
    v_mfma_f32_16x16x32_bf16 v[144:147], v[40:43], v[216:219], v[144:147]
    v_add_u32 v203, 0xc000, v203
    v_mfma_f32_16x16x32_bf16 v[152:155], v[44:47], v[216:219], v[152:155]
    ds_read_b64_tr_b16 v[248:249], v16
    ds_read_b64_tr_b16 v[250:251], v16 offset:256
    v_mfma_f32_16x16x32_bf16 v[160:163], v[48:51], v[216:219], v[160:163]
    v_mfma_f32_16x16x32_bf16 v[168:171], v[52:55], v[216:219], v[168:171]
    ds_read_b64_tr_b16 v[252:253], v15
    ds_read_b64_tr_b16 v[254:255], v15 offset:256
    s_waitcnt lgkmcnt(8)
    v_mfma_f32_16x16x32_bf16 v[84:87], v[224:227], v[40:43], v[84:87]
    v_mfma_f32_16x16x32_bf16 v[92:95], v[224:227], v[44:47], v[92:95]
    s_waitcnt lgkmcnt(0)
    s_barrier
    ds_read_b128 v[176:179], v192 offset:0
    v_mfma_f32_16x16x32_bf16 v[100:103], v[224:227], v[48:51], v[100:103]
    ds_read_b64_tr_b16 v[208:209], v200 offset:0
    v_mfma_f32_16x16x32_bf16 v[108:111], v[224:227], v[52:55], v[108:111]
    ds_read_b64_tr_b16 v[210:211], v200 offset:512
    v_mfma_f32_16x16x32_bf16 v[116:119], v[228:231], v[40:43], v[116:119]
    ds_read_b128 v[180:183], v192 offset:2048
    v_mfma_f32_16x16x32_bf16 v[124:127], v[228:231], v[44:47], v[124:127]
    ds_read_b128 v[184:187], v194 offset:0
    s_load_dword s60, s[34:35], 0
    v_mfma_f32_16x16x32_bf16 v[132:135], v[228:231], v[48:51], v[132:135]
    ds_read_b128 v[188:191], v194 offset:2048
    v_mfma_f32_16x16x32_bf16 v[140:143], v[228:231], v[52:55], v[140:143]
    ds_read_b64_tr_b16 v[212:213], v200 offset:8192
    v_mfma_f32_16x16x32_bf16 v[148:151], v[40:43], v[232:235], v[148:151]
    ds_read_b64_tr_b16 v[214:215], v200 offset:8704
    v_mfma_f32_16x16x32_bf16 v[156:159], v[44:47], v[232:235], v[156:159]
    ds_read_b64_tr_b16 v[216:217], v200 offset:16384
    v_mfma_f32_16x16x32_bf16 v[164:167], v[48:51], v[232:235], v[164:167]
    ds_read_b64_tr_b16 v[218:219], v200 offset:16896
    v_mfma_f32_16x16x32_bf16 v[172:175], v[52:55], v[232:235], v[172:175]
    s_waitcnt lgkmcnt(6)
    v_mfma_f32_16x16x32_bf16 v[80:83], v[208:211], v[176:179], v[80:83]
    ds_read_b64_tr_b16 v[224:225], v203 offset:0
    v_mfma_f32_16x16x32_bf16 v[88:91], v[208:211], v[180:183], v[88:91]
    ds_read_b64_tr_b16 v[226:227], v203 offset:512
    s_waitcnt lgkmcnt(6)
    v_mfma_f32_16x16x32_bf16 v[96:99], v[208:211], v[184:187], v[96:99]
    ds_read_b64_tr_b16 v[228:229], v203 offset:8192
    v_mfma_f32_16x16x32_bf16 v[104:107], v[208:211], v[188:191], v[104:107]
    ds_read_b64_tr_b16 v[230:231], v203 offset:8704
    s_waitcnt lgkmcnt(6)
    v_mfma_f32_16x16x32_bf16 v[112:115], v[212:215], v[176:179], v[112:115]
    ds_read_b64_tr_b16 v[232:233], v203 offset:16384
    v_mfma_f32_16x16x32_bf16 v[120:123], v[212:215], v[180:183], v[120:123]
    ds_read_b64_tr_b16 v[234:235], v203 offset:16896
    v_mfma_f32_16x16x32_bf16 v[128:131], v[212:215], v[184:187], v[128:131]
    ds_read_b128 v[40:43], v193 offset:0
    v_mfma_f32_16x16x32_bf16 v[136:139], v[212:215], v[188:191], v[136:139]
    ds_read_b128 v[44:47], v193 offset:2048
    s_waitcnt lgkmcnt(8)
    v_mfma_f32_16x16x32_bf16 v[144:147], v[176:179], v[216:219], v[144:147]
    v_add_u32 v192, 0xc000, v192
    v_mfma_f32_16x16x32_bf16 v[152:155], v[180:183], v[216:219], v[152:155]
    v_xor_b32 v248, v19, v248
    v_xor_b32 v249, v19, v249
    v_add_u32 v194, 0xc000, v194
    v_mfma_f32_16x16x32_bf16 v[160:163], v[184:187], v[216:219], v[160:163]
    v_mfma_f32_16x16x32_bf16 v[168:171], v[188:191], v[216:219], v[168:171]
    v_cmp_eq_u32 vcc, 0, v32
    s_nop 1
    v_cndmask_b32 v72, 0, v33, vcc
    s_waitcnt lgkmcnt(6)
    v_mfma_f32_16x16x32_bf16 v[84:87], v[224:227], v[176:179], v[84:87]
    ds_read_b128 v[48:51], v195 offset:0
    v_mfma_f32_16x16x32_bf16 v[92:95], v[224:227], v[180:183], v[92:95]
    ds_read_b128 v[52:55], v195 offset:2048
    v_mfma_f32_16x16x32_bf16 v[100:103], v[224:227], v[184:187], v[100:103]
    ds_read_b64_tr_b16 v[208:209], v200 offset:4096
    v_mfma_f32_16x16x32_bf16 v[108:111], v[224:227], v[188:191], v[108:111]
    ds_read_b64_tr_b16 v[210:211], v200 offset:4608
    s_waitcnt lgkmcnt(8)
    v_mfma_f32_16x16x32_bf16 v[116:119], v[228:231], v[176:179], v[116:119]
    ds_read_b64_tr_b16 v[212:213], v200 offset:12288
    v_mfma_f32_16x16x32_bf16 v[124:127], v[228:231], v[180:183], v[124:127]
    ds_read_b64_tr_b16 v[214:215], v200 offset:12800
    v_mfma_f32_16x16x32_bf16 v[132:135], v[228:231], v[184:187], v[132:135]
    ds_read_b64_tr_b16 v[216:217], v200 offset:20480
    v_mfma_f32_16x16x32_bf16 v[140:143], v[228:231], v[188:191], v[140:143]
    ds_read_b64_tr_b16 v[218:219], v200 offset:20992
    s_waitcnt lgkmcnt(10)
    v_mfma_f32_16x16x32_bf16 v[148:151], v[176:179], v[232:235], v[148:151]
    v_add_u32 v193, 0xc000, v193
    v_mfma_f32_16x16x32_bf16 v[156:159], v[180:183], v[232:235], v[156:159]
    v_xor_b32 v250, v19, v250
    v_xor_b32 v251, v19, v251
    v_add_u32 v200, 0xc000, v200
    v_mfma_f32_16x16x32_bf16 v[164:167], v[184:187], v[232:235], v[164:167]
    v_mfma_f32_16x16x32_bf16 v[172:175], v[188:191], v[232:235], v[172:175]
    v_cmp_eq_u32 vcc, 1, v32
    s_nop 1
    v_cndmask_b32 v73, 0, v33, vcc
    s_waitcnt lgkmcnt(4)
    v_mfma_f32_16x16x32_bf16 v[80:83], v[208:211], v[40:43], v[80:83]
    ds_read_b64_tr_b16 v[224:225], v203 offset:4096
    v_mfma_f32_16x16x32_bf16 v[88:91], v[208:211], v[44:47], v[88:91]
    ds_read_b64_tr_b16 v[226:227], v203 offset:4608
    v_mfma_f32_16x16x32_bf16 v[96:99], v[208:211], v[48:51], v[96:99]
    ds_read_b64_tr_b16 v[228:229], v203 offset:12288
    v_mfma_f32_16x16x32_bf16 v[104:107], v[208:211], v[52:55], v[104:107]
    ds_read_b64_tr_b16 v[230:231], v203 offset:12800
    s_waitcnt lgkmcnt(6)
    v_mfma_f32_16x16x32_bf16 v[112:115], v[212:215], v[40:43], v[112:115]
    ds_read_b64_tr_b16 v[232:233], v203 offset:20480
    v_mfma_f32_16x16x32_bf16 v[120:123], v[212:215], v[44:47], v[120:123]
    ds_read_b64_tr_b16 v[234:235], v203 offset:20992
    v_mfma_f32_16x16x32_bf16 v[128:131], v[212:215], v[48:51], v[128:131]
    v_mfma_f32_16x16x32_bf16 v[136:139], v[212:215], v[52:55], v[136:139]
    v_add_u32 v195, 0xc000, v195
    s_waitcnt lgkmcnt(6)
    v_mfma_f32_16x16x32_bf16 v[144:147], v[40:43], v[216:219], v[144:147]
    v_add_u32 v203, 0xc000, v203
    v_mfma_f32_16x16x32_bf16 v[152:155], v[44:47], v[216:219], v[152:155]
    v_xor_b32 v252, v19, v252
    v_xor_b32 v253, v19, v253
    v_mfma_f32_16x16x32_bf16 v[160:163], v[48:51], v[216:219], v[160:163]
    v_mfma_f32_16x16x32_bf16 v[168:171], v[52:55], v[216:219], v[168:171]
    v_cmp_eq_u32 vcc, 2, v32
    s_nop 1
    v_cndmask_b32 v74, 0, v33, vcc
    s_waitcnt lgkmcnt(4)
    v_mfma_f32_16x16x32_bf16 v[84:87], v[224:227], v[40:43], v[84:87]
    v_mfma_f32_16x16x32_bf16 v[92:95], v[224:227], v[44:47], v[92:95]
    s_waitcnt lgkmcnt(0)
    s_barrier
    ds_read_b128 v[176:179], v192 offset:0
    v_mfma_f32_16x16x32_bf16 v[100:103], v[224:227], v[48:51], v[100:103]
    ds_read_b64_tr_b16 v[208:209], v200 offset:0
    v_mfma_f32_16x16x32_bf16 v[108:111], v[224:227], v[52:55], v[108:111]
    ds_read_b64_tr_b16 v[210:211], v200 offset:512
    v_mfma_f32_16x16x32_bf16 v[116:119], v[228:231], v[40:43], v[116:119]
    ds_read_b128 v[180:183], v192 offset:2048
    v_mfma_f32_16x16x32_bf16 v[124:127], v[228:231], v[44:47], v[124:127]
    ds_read_b128 v[184:187], v194 offset:0
    v_mfma_f32_16x16x32_bf16 v[132:135], v[228:231], v[48:51], v[132:135]
    ds_read_b128 v[188:191], v194 offset:2048
    v_mfma_f32_16x16x32_bf16 v[140:143], v[228:231], v[52:55], v[140:143]
    ds_read_b64_tr_b16 v[212:213], v200 offset:8192
    v_mfma_f32_16x16x32_bf16 v[148:151], v[40:43], v[232:235], v[148:151]
    ds_read_b64_tr_b16 v[214:215], v200 offset:8704
    v_mfma_f32_16x16x32_bf16 v[156:159], v[44:47], v[232:235], v[156:159]
    ds_read_b64_tr_b16 v[216:217], v200 offset:16384
    v_xor_b32 v254, v19, v254
    v_xor_b32 v255, v19, v255
    v_mfma_f32_16x16x32_bf16 v[164:167], v[48:51], v[232:235], v[164:167]
    ds_read_b64_tr_b16 v[218:219], v200 offset:16896
    v_mfma_f32_16x16x32_bf16 v[172:175], v[52:55], v[232:235], v[172:175]
    v_cmp_eq_u32 vcc, 3, v32
    s_nop 1
    v_cndmask_b32 v75, 0, v33, vcc
    s_waitcnt lgkmcnt(6)
    v_mfma_f32_16x16x32_bf16 v[80:83], v[208:211], v[176:179], v[80:83]
    ds_read_b64_tr_b16 v[224:225], v203 offset:0
    v_mfma_f32_16x16x32_bf16 v[88:91], v[208:211], v[180:183], v[88:91]
    ds_read_b64_tr_b16 v[226:227], v203 offset:512
    s_waitcnt lgkmcnt(6)
    v_mfma_f32_16x16x32_bf16 v[96:99], v[208:211], v[184:187], v[96:99]
    ds_read_b64_tr_b16 v[228:229], v203 offset:8192
    v_mfma_f32_16x16x32_bf16 v[104:107], v[208:211], v[188:191], v[104:107]
    ds_read_b64_tr_b16 v[230:231], v203 offset:8704
    s_waitcnt lgkmcnt(6)
    v_mfma_f32_16x16x32_bf16 v[112:115], v[212:215], v[176:179], v[112:115]
    ds_read_b64_tr_b16 v[232:233], v203 offset:16384
    v_mfma_f32_16x16x32_bf16 v[120:123], v[212:215], v[180:183], v[120:123]
    ds_read_b64_tr_b16 v[234:235], v203 offset:16896
    v_mfma_f32_16x16x32_bf16 v[128:131], v[212:215], v[184:187], v[128:131]
    ds_read_b128 v[40:43], v193 offset:0
    v_mfma_f32_16x16x32_bf16 v[136:139], v[212:215], v[188:191], v[136:139]
    ds_read_b128 v[44:47], v193 offset:2048
    s_waitcnt lgkmcnt(8)
    v_mfma_f32_16x16x32_bf16 v[144:147], v[176:179], v[216:219], v[144:147]
    v_add_u32 v192, 0xfffe8000, v192
    v_mfma_f32_16x16x32_bf16 v[152:155], v[180:183], v[216:219], v[152:155]
    s_cmp_eq_u32 s60, 0
    s_cselect_b64 vcc, -1, 0
    s_cbranch_vccnz SL_46
SE_47:
    v_add_u32 v194, 0xfffe8000, v194
    v_mfma_f32_16x16x32_bf16 v[160:163], v[184:187], v[216:219], v[160:163]
    v_mfma_f32_16x16x32_bf16 v[168:171], v[188:191], v[216:219], v[168:171]
    v_cmp_eq_u32 vcc, 4, v32
    s_nop 1
    v_cndmask_b32 v76, 0, v33, vcc
    s_waitcnt lgkmcnt(6)
    v_mfma_f32_16x16x32_bf16 v[84:87], v[224:227], v[176:179], v[84:87]
    ds_read_b128 v[48:51], v195 offset:0
    v_mfma_f32_16x16x32_bf16 v[92:95], v[224:227], v[180:183], v[92:95]
    ds_read_b128 v[52:55], v195 offset:2048
    v_mfma_f32_16x16x32_bf16 v[100:103], v[224:227], v[184:187], v[100:103]
    ds_read_b64_tr_b16 v[208:209], v200 offset:4096
    v_mfma_f32_16x16x32_bf16 v[108:111], v[224:227], v[188:191], v[108:111]
    ds_read_b64_tr_b16 v[210:211], v200 offset:4608
    s_waitcnt lgkmcnt(8)
    v_mfma_f32_16x16x32_bf16 v[116:119], v[228:231], v[176:179], v[116:119]
    ds_read_b64_tr_b16 v[212:213], v200 offset:12288
    v_mfma_f32_16x16x32_bf16 v[124:127], v[228:231], v[180:183], v[124:127]
    ds_read_b64_tr_b16 v[214:215], v200 offset:12800
    v_mfma_f32_16x16x32_bf16 v[132:135], v[228:231], v[184:187], v[132:135]
    ds_read_b64_tr_b16 v[216:217], v200 offset:20480
    v_mfma_f32_16x16x32_bf16 v[140:143], v[228:231], v[188:191], v[140:143]
    ds_read_b64_tr_b16 v[218:219], v200 offset:20992
    s_waitcnt lgkmcnt(10)
    v_mfma_f32_16x16x32_bf16 v[148:151], v[176:179], v[232:235], v[148:151]
    v_add_u32 v193, 0xfffe8000, v193
    v_mfma_f32_16x16x32_bf16 v[156:159], v[180:183], v[232:235], v[156:159]
    v_add_u32 v200, 0xfffe8000, v200
    v_mfma_f32_16x16x32_bf16 v[164:167], v[184:187], v[232:235], v[164:167]
    v_mfma_f32_16x16x32_bf16 v[172:175], v[188:191], v[232:235], v[172:175]
    v_cmp_eq_u32 vcc, 5, v32
    s_nop 1
    v_cndmask_b32 v77, 0, v33, vcc
    s_waitcnt lgkmcnt(4)
    v_mfma_f32_16x16x32_bf16 v[80:83], v[208:211], v[40:43], v[80:83]
    ds_read_b64_tr_b16 v[224:225], v203 offset:4096
    v_mfma_f32_16x16x32_bf16 v[88:91], v[208:211], v[44:47], v[88:91]
    ds_read_b64_tr_b16 v[226:227], v203 offset:4608
    v_mfma_f32_16x16x32_bf16 v[96:99], v[208:211], v[48:51], v[96:99]
    ds_read_b64_tr_b16 v[228:229], v203 offset:12288
    v_mfma_f32_16x16x32_bf16 v[104:107], v[208:211], v[52:55], v[104:107]
    ds_read_b64_tr_b16 v[230:231], v203 offset:12800
    s_waitcnt lgkmcnt(6)
    v_mfma_f32_16x16x32_bf16 v[112:115], v[212:215], v[40:43], v[112:115]
    ds_read_b64_tr_b16 v[232:233], v203 offset:20480
    v_mfma_f32_16x16x32_bf16 v[120:123], v[212:215], v[44:47], v[120:123]
    ds_read_b64_tr_b16 v[234:235], v203 offset:20992
    v_mfma_f32_16x16x32_bf16 v[128:131], v[212:215], v[48:51], v[128:131]
    v_mfma_f32_16x16x32_bf16 v[136:139], v[212:215], v[52:55], v[136:139]
    v_add_u32 v195, 0xfffe8000, v195
    s_waitcnt lgkmcnt(6)
    v_mfma_f32_16x16x32_bf16 v[144:147], v[40:43], v[216:219], v[144:147]
    v_add_u32 v203, 0xfffe8000, v203
    v_mfma_f32_16x16x32_bf16 v[152:155], v[44:47], v[216:219], v[152:155]
    v_mfma_f32_16x16x32_bf16 v[160:163], v[48:51], v[216:219], v[160:163]
    v_mfma_f32_16x16x32_bf16 v[168:171], v[52:55], v[216:219], v[168:171]
    v_cmp_eq_u32 vcc, 6, v32
    s_nop 1
    v_cndmask_b32 v78, 0, v33, vcc
    s_waitcnt lgkmcnt(4)
    v_mfma_f32_16x16x32_bf16 v[84:87], v[224:227], v[40:43], v[84:87]
    v_mfma_f32_16x16x32_bf16 v[92:95], v[224:227], v[44:47], v[92:95]
    s_waitcnt lgkmcnt(0)
    s_barrier
    ds_read_b128 v[176:179], v192 offset:0
    v_mfma_f32_16x16x32_bf16 v[100:103], v[224:227], v[48:51], v[100:103]
    ds_read_b64_tr_b16 v[208:209], v200 offset:0
    v_mfma_f32_16x16x32_bf16 v[108:111], v[224:227], v[52:55], v[108:111]
    ds_read_b64_tr_b16 v[210:211], v200 offset:512
    v_mfma_f32_16x16x32_bf16 v[116:119], v[228:231], v[40:43], v[116:119]
    ds_read_b128 v[180:183], v192 offset:2048
    v_mfma_f32_16x16x32_bf16 v[124:127], v[228:231], v[44:47], v[124:127]
    ds_read_b128 v[184:187], v194 offset:0
    v_mfma_f32_16x16x32_bf16 v[132:135], v[228:231], v[48:51], v[132:135]
    ds_read_b128 v[188:191], v194 offset:2048
    v_mfma_f32_16x16x32_bf16 v[140:143], v[228:231], v[52:55], v[140:143]
    ds_read_b64_tr_b16 v[212:213], v200 offset:8192
    v_mfma_f32_16x16x32_bf16 v[148:151], v[40:43], v[232:235], v[148:151]
    ds_read_b64_tr_b16 v[214:215], v200 offset:8704
    v_mfma_f32_16x16x32_bf16 v[156:159], v[44:47], v[232:235], v[156:159]
    ds_read_b64_tr_b16 v[216:217], v200 offset:16384
    v_mfma_f32_16x16x32_bf16 v[164:167], v[48:51], v[232:235], v[164:167]
    ds_read_b64_tr_b16 v[218:219], v200 offset:16896
    v_mfma_f32_16x16x32_bf16 v[172:175], v[52:55], v[232:235], v[172:175]
    v_cmp_eq_u32 vcc, 7, v32
    s_nop 1
    v_cndmask_b32 v79, 0, v33, vcc
    s_waitcnt lgkmcnt(6)
    v_mfma_f32_16x16x32_bf16 v[80:83], v[208:211], v[176:179], v[80:83]
    ds_read_b64_tr_b16 v[224:225], v203 offset:0
    v_mfma_f32_16x16x32_bf16 v[88:91], v[208:211], v[180:183], v[88:91]
    ds_read_b64_tr_b16 v[226:227], v203 offset:512
    s_waitcnt lgkmcnt(6)
    v_mfma_f32_16x16x32_bf16 v[96:99], v[208:211], v[184:187], v[96:99]
    ds_read_b64_tr_b16 v[228:229], v203 offset:8192
    v_mfma_f32_16x16x32_bf16 v[104:107], v[208:211], v[188:191], v[104:107]
    ds_read_b64_tr_b16 v[230:231], v203 offset:8704
    s_waitcnt lgkmcnt(6)
    v_mfma_f32_16x16x32_bf16 v[112:115], v[212:215], v[176:179], v[112:115]
    ds_read_b64_tr_b16 v[232:233], v203 offset:16384
    v_mfma_f32_16x16x32_bf16 v[120:123], v[212:215], v[180:183], v[120:123]
    ds_read_b64_tr_b16 v[234:235], v203 offset:16896
    v_mfma_f32_16x16x32_bf16 v[128:131], v[212:215], v[184:187], v[128:131]
    ds_read_b128 v[40:43], v193 offset:0
    v_mfma_f32_16x16x32_bf16 v[136:139], v[212:215], v[188:191], v[136:139]
    ds_read_b128 v[44:47], v193 offset:2048
    s_waitcnt lgkmcnt(8)
    v_mfma_f32_16x16x32_bf16 v[144:147], v[176:179], v[216:219], v[144:147]
    v_add_u32 v192, 0xc000, v192
    v_mfma_f32_16x16x32_bf16 v[152:155], v[180:183], v[216:219], v[152:155]
    s_waitcnt vmcnt(0)
    s_lshl_b32 s48, s47, 11
    s_lshl_b32 s49, s100, 9
    s_add_u32 s67, s48, s49
    s_add_u32 s67, s67, 11599872
    s_xor_b32 s5, s67, 512
    v_lshlrev_b32 v38, 4, v20
    s_add_u32 s49, s49, 157696
    v_add_u32 v26, s49, v38
    v_xor_b32 v27, 0x200, v26
    v_add_u32 v194, 0xc000, v194
    v_mfma_f32_16x16x32_bf16 v[160:163], v[184:187], v[216:219], v[160:163]
    v_mfma_f32_16x16x32_bf16 v[168:171], v[188:191], v[216:219], v[168:171]
    s_waitcnt lgkmcnt(6)
    v_mfma_f32_16x16x32_bf16 v[84:87], v[224:227], v[176:179], v[84:87]
    ds_read_b128 v[48:51], v195 offset:0
    v_mfma_f32_16x16x32_bf16 v[92:95], v[224:227], v[180:183], v[92:95]
    ds_read_b128 v[52:55], v195 offset:2048
    v_mfma_f32_16x16x32_bf16 v[100:103], v[224:227], v[184:187], v[100:103]
    ds_read_b64_tr_b16 v[208:209], v200 offset:4096
    v_mfma_f32_16x16x32_bf16 v[108:111], v[224:227], v[188:191], v[108:111]
    ds_read_b64_tr_b16 v[210:211], v200 offset:4608
    s_waitcnt lgkmcnt(8)
    v_mfma_f32_16x16x32_bf16 v[116:119], v[228:231], v[176:179], v[116:119]
    ds_read_b64_tr_b16 v[212:213], v200 offset:12288
    v_mfma_f32_16x16x32_bf16 v[124:127], v[228:231], v[180:183], v[124:127]
    ds_read_b64_tr_b16 v[214:215], v200 offset:12800
    v_mfma_f32_16x16x32_bf16 v[132:135], v[228:231], v[184:187], v[132:135]
    ds_read_b64_tr_b16 v[216:217], v200 offset:20480
    v_mfma_f32_16x16x32_bf16 v[140:143], v[228:231], v[188:191], v[140:143]
    ds_read_b64_tr_b16 v[218:219], v200 offset:20992
    s_waitcnt lgkmcnt(10)
    v_mfma_f32_16x16x32_bf16 v[148:151], v[176:179], v[232:235], v[148:151]
    v_add_u32 v193, 0xc000, v193
    v_mfma_f32_16x16x32_bf16 v[156:159], v[180:183], v[232:235], v[156:159]
    v_xor_b32 v15, 0x400, v2
    v_add_u32 v200, 0xc000, v200
    v_mfma_f32_16x16x32_bf16 v[164:167], v[184:187], v[232:235], v[164:167]
    v_mfma_f32_16x16x32_bf16 v[172:175], v[188:191], v[232:235], v[172:175]
    s_waitcnt lgkmcnt(4)
    v_mfma_f32_16x16x32_bf16 v[80:83], v[208:211], v[40:43], v[80:83]
    ds_read_b64_tr_b16 v[224:225], v203 offset:4096
    v_mfma_f32_16x16x32_bf16 v[88:91], v[208:211], v[44:47], v[88:91]
    ds_read_b64_tr_b16 v[226:227], v203 offset:4608
    v_mfma_f32_16x16x32_bf16 v[96:99], v[208:211], v[48:51], v[96:99]
    ds_read_b64_tr_b16 v[228:229], v203 offset:12288
    v_mfma_f32_16x16x32_bf16 v[104:107], v[208:211], v[52:55], v[104:107]
    ds_read_b64_tr_b16 v[230:231], v203 offset:12800
    s_waitcnt lgkmcnt(6)
    v_mfma_f32_16x16x32_bf16 v[112:115], v[212:215], v[40:43], v[112:115]
    ds_read_b64_tr_b16 v[232:233], v203 offset:20480
    v_mfma_f32_16x16x32_bf16 v[120:123], v[212:215], v[44:47], v[120:123]
    ds_read_b64_tr_b16 v[234:235], v203 offset:20992
    v_mfma_f32_16x16x32_bf16 v[128:131], v[212:215], v[48:51], v[128:131]
    v_mfma_f32_16x16x32_bf16 v[136:139], v[212:215], v[52:55], v[136:139]
    v_add_u32 v195, 0xc000, v195
    s_waitcnt lgkmcnt(6)
    v_mfma_f32_16x16x32_bf16 v[144:147], v[40:43], v[216:219], v[144:147]
    v_add_u32 v203, 0xc000, v203
    v_mfma_f32_16x16x32_bf16 v[152:155], v[44:47], v[216:219], v[152:155]
    v_mfma_f32_16x16x32_bf16 v[160:163], v[48:51], v[216:219], v[160:163]
    v_mfma_f32_16x16x32_bf16 v[168:171], v[52:55], v[216:219], v[168:171]
    s_waitcnt lgkmcnt(4)
    v_mfma_f32_16x16x32_bf16 v[84:87], v[224:227], v[40:43], v[84:87]
    v_mfma_f32_16x16x32_bf16 v[92:95], v[224:227], v[44:47], v[92:95]
    s_waitcnt lgkmcnt(0)
    s_barrier
    ds_read_b128 v[176:179], v192 offset:0
    v_mfma_f32_16x16x32_bf16 v[100:103], v[224:227], v[48:51], v[100:103]
    ds_read_b64_tr_b16 v[208:209], v200 offset:0
    v_mfma_f32_16x16x32_bf16 v[108:111], v[224:227], v[52:55], v[108:111]
    ds_read_b64_tr_b16 v[210:211], v200 offset:512
    v_mfma_f32_16x16x32_bf16 v[116:119], v[228:231], v[40:43], v[116:119]
    ds_read_b128 v[180:183], v192 offset:2048
    v_mfma_f32_16x16x32_bf16 v[124:127], v[228:231], v[44:47], v[124:127]
    ds_read_b128 v[184:187], v194 offset:0
    v_mfma_f32_16x16x32_bf16 v[132:135], v[228:231], v[48:51], v[132:135]
    ds_read_b128 v[188:191], v194 offset:2048
    v_mfma_f32_16x16x32_bf16 v[140:143], v[228:231], v[52:55], v[140:143]
    ds_read_b64_tr_b16 v[212:213], v200 offset:8192
    v_mfma_f32_16x16x32_bf16 v[148:151], v[40:43], v[232:235], v[148:151]
    ds_read_b64_tr_b16 v[214:215], v200 offset:8704
    v_mfma_f32_16x16x32_bf16 v[156:159], v[44:47], v[232:235], v[156:159]
    ds_read_b64_tr_b16 v[216:217], v200 offset:16384
    v_mfma_f32_16x16x32_bf16 v[164:167], v[48:51], v[232:235], v[164:167]
    ds_read_b64_tr_b16 v[218:219], v200 offset:16896
    v_mfma_f32_16x16x32_bf16 v[172:175], v[52:55], v[232:235], v[172:175]
    s_waitcnt lgkmcnt(6)
    v_mfma_f32_16x16x32_bf16 v[80:83], v[208:211], v[176:179], v[80:83]
    ds_read_b64_tr_b16 v[224:225], v203 offset:0
    v_mfma_f32_16x16x32_bf16 v[88:91], v[208:211], v[180:183], v[88:91]
    ds_read_b64_tr_b16 v[226:227], v203 offset:512
    s_waitcnt lgkmcnt(6)
    v_mfma_f32_16x16x32_bf16 v[96:99], v[208:211], v[184:187], v[96:99]
    ds_read_b64_tr_b16 v[228:229], v203 offset:8192
    v_mfma_f32_16x16x32_bf16 v[104:107], v[208:211], v[188:191], v[104:107]
    ds_read_b64_tr_b16 v[230:231], v203 offset:8704
    s_waitcnt lgkmcnt(6)
    v_mfma_f32_16x16x32_bf16 v[112:115], v[212:215], v[176:179], v[112:115]
    ds_read_b64_tr_b16 v[232:233], v203 offset:16384
    v_mfma_f32_16x16x32_bf16 v[120:123], v[212:215], v[180:183], v[120:123]
    ds_read_b64_tr_b16 v[234:235], v203 offset:16896
    v_mfma_f32_16x16x32_bf16 v[128:131], v[212:215], v[184:187], v[128:131]
    ds_read_b128 v[40:43], v193 offset:0
    v_and_b32 v237, 0xfffffeff, v26
    v_xor_b32 v238, 0x200, v237
    v_mfma_f32_16x16x32_bf16 v[136:139], v[212:215], v[188:191], v[136:139]
    ds_read_b128 v[44:47], v193 offset:2048
    s_waitcnt lgkmcnt(8)
    v_mfma_f32_16x16x32_bf16 v[144:147], v[176:179], v[216:219], v[144:147]
    v_add_u32 v192, 0xc000, v192
    v_mfma_f32_16x16x32_bf16 v[152:155], v[180:183], v[216:219], v[152:155]
    s_mov_b64 s[32:33], 0
    s_mov_b64 s[34:35], 0
    s_mov_b64 s[36:37], 0
    s_mov_b64 s[38:39], 0
    s_mov_b64 s[0:1], 0
    v_add_u32 v194, 0xc000, v194
    v_mfma_f32_16x16x32_bf16 v[160:163], v[184:187], v[216:219], v[160:163]
    v_mfma_f32_16x16x32_bf16 v[168:171], v[188:191], v[216:219], v[168:171]
    s_waitcnt lgkmcnt(6)
    v_mfma_f32_16x16x32_bf16 v[84:87], v[224:227], v[176:179], v[84:87]
    ds_read_b128 v[48:51], v195 offset:0
    v_mfma_f32_16x16x32_bf16 v[92:95], v[224:227], v[180:183], v[92:95]
    ds_read_b128 v[52:55], v195 offset:2048
    v_mfma_f32_16x16x32_bf16 v[100:103], v[224:227], v[184:187], v[100:103]
    ds_read_b64_tr_b16 v[208:209], v200 offset:4096
    v_mfma_f32_16x16x32_bf16 v[108:111], v[224:227], v[188:191], v[108:111]
    ds_read_b64_tr_b16 v[210:211], v200 offset:4608
    s_waitcnt lgkmcnt(8)
    v_mfma_f32_16x16x32_bf16 v[116:119], v[228:231], v[176:179], v[116:119]
    ds_read_b64_tr_b16 v[212:213], v200 offset:12288
    v_mfma_f32_16x16x32_bf16 v[124:127], v[228:231], v[180:183], v[124:127]
    ds_read_b64_tr_b16 v[214:215], v200 offset:12800
    v_mfma_f32_16x16x32_bf16 v[132:135], v[228:231], v[184:187], v[132:135]
    ds_read_b64_tr_b16 v[216:217], v200 offset:20480
    v_mfma_f32_16x16x32_bf16 v[140:143], v[228:231], v[188:191], v[140:143]
    ds_read_b64_tr_b16 v[218:219], v200 offset:20992
    s_waitcnt lgkmcnt(10)
    v_mfma_f32_16x16x32_bf16 v[148:151], v[176:179], v[232:235], v[148:151]
    v_add_u32 v193, 0xc000, v193
    v_mfma_f32_16x16x32_bf16 v[156:159], v[180:183], v[232:235], v[156:159]
    s_mov_b64 s[40:41], 0
    s_mov_b64 s[42:43], 0
    s_mov_b64 s[44:45], 0
    s_mov_b64 s[46:47], 0
    v_add_u32 v200, 0xc000, v200
    v_mfma_f32_16x16x32_bf16 v[164:167], v[184:187], v[232:235], v[164:167]
    v_mov_b32 v68, 0
    v_mov_b32 v69, 0
    v_mfma_f32_16x16x32_bf16 v[172:175], v[188:191], v[232:235], v[172:175]
    s_waitcnt lgkmcnt(4)
    v_mfma_f32_16x16x32_bf16 v[80:83], v[208:211], v[40:43], v[80:83]
    ds_read_b64_tr_b16 v[224:225], v203 offset:4096
    v_mfma_f32_16x16x32_bf16 v[88:91], v[208:211], v[44:47], v[88:91]
    ds_read_b64_tr_b16 v[226:227], v203 offset:4608
    v_mfma_f32_16x16x32_bf16 v[96:99], v[208:211], v[48:51], v[96:99]
    ds_read_b64_tr_b16 v[228:229], v203 offset:12288
    v_mfma_f32_16x16x32_bf16 v[104:107], v[208:211], v[52:55], v[104:107]
    ds_read_b64_tr_b16 v[230:231], v203 offset:12800
    s_waitcnt lgkmcnt(6)
    v_mfma_f32_16x16x32_bf16 v[112:115], v[212:215], v[40:43], v[112:115]
    ds_read_b64_tr_b16 v[232:233], v203 offset:20480
    v_mfma_f32_16x16x32_bf16 v[120:123], v[212:215], v[44:47], v[120:123]
    ds_read_b64_tr_b16 v[234:235], v203 offset:20992
    v_mfma_f32_16x16x32_bf16 v[128:131], v[212:215], v[48:51], v[128:131]
    v_mfma_f32_16x16x32_bf16 v[136:139], v[212:215], v[52:55], v[136:139]
    v_add_u32 v195, 0xc000, v195
    s_waitcnt lgkmcnt(6)
    v_mfma_f32_16x16x32_bf16 v[144:147], v[40:43], v[216:219], v[144:147]
    v_add_u32 v203, 0xc000, v203
    v_mfma_f32_16x16x32_bf16 v[152:155], v[44:47], v[216:219], v[152:155]
    s_mov_b32 s20, s60
    s_mov_b32 s21, s60
    v_mfma_f32_16x16x32_bf16 v[160:163], v[48:51], v[216:219], v[160:163]
    v_mfma_f32_16x16x32_bf16 v[168:171], v[52:55], v[216:219], v[168:171]
    s_waitcnt lgkmcnt(4)
    v_mfma_f32_16x16x32_bf16 v[84:87], v[224:227], v[40:43], v[84:87]
    v_mfma_f32_16x16x32_bf16 v[92:95], v[224:227], v[44:47], v[92:95]
    s_waitcnt lgkmcnt(0)
    s_barrier
    ds_read_b128 v[176:179], v192 offset:0
    v_mfma_f32_16x16x32_bf16 v[100:103], v[224:227], v[48:51], v[100:103]
    ds_read_b64_tr_b16 v[208:209], v200 offset:0
    v_mfma_f32_16x16x32_bf16 v[108:111], v[224:227], v[52:55], v[108:111]
    ds_read_b64_tr_b16 v[210:211], v200 offset:512
    v_mfma_f32_16x16x32_bf16 v[116:119], v[228:231], v[40:43], v[116:119]
    ds_read_b128 v[180:183], v192 offset:2048
    v_mfma_f32_16x16x32_bf16 v[124:127], v[228:231], v[44:47], v[124:127]
    ds_read_b128 v[184:187], v194 offset:0
    v_mfma_f32_16x16x32_bf16 v[132:135], v[228:231], v[48:51], v[132:135]
    ds_read_b128 v[188:191], v194 offset:2048
    v_mfma_f32_16x16x32_bf16 v[140:143], v[228:231], v[52:55], v[140:143]
    ds_read_b64_tr_b16 v[212:213], v200 offset:8192
    v_mfma_f32_16x16x32_bf16 v[148:151], v[40:43], v[232:235], v[148:151]
    ds_read_b64_tr_b16 v[214:215], v200 offset:8704
    v_mfma_f32_16x16x32_bf16 v[156:159], v[44:47], v[232:235], v[156:159]
    ds_read_b64_tr_b16 v[216:217], v200 offset:16384
    v_mfma_f32_16x16x32_bf16 v[164:167], v[48:51], v[232:235], v[164:167]
    ds_read_b64_tr_b16 v[218:219], v200 offset:16896
    v_mfma_f32_16x16x32_bf16 v[172:175], v[52:55], v[232:235], v[172:175]
    ds_read_b128 v[34:37], v26
    ds_read_b128 v[28:31], v27
    s_waitcnt lgkmcnt(8)
    v_mfma_f32_16x16x32_bf16 v[80:83], v[208:211], v[176:179], v[80:83]
    ds_read_b64_tr_b16 v[224:225], v203 offset:0
    v_mfma_f32_16x16x32_bf16 v[88:91], v[208:211], v[180:183], v[88:91]
    ds_read_b64_tr_b16 v[226:227], v203 offset:512
    s_waitcnt lgkmcnt(8)
    v_mfma_f32_16x16x32_bf16 v[96:99], v[208:211], v[184:187], v[96:99]
    ds_read_b64_tr_b16 v[228:229], v203 offset:8192
    v_mfma_f32_16x16x32_bf16 v[104:107], v[208:211], v[188:191], v[104:107]
    ds_read_b64_tr_b16 v[230:231], v203 offset:8704
    s_waitcnt lgkmcnt(8)
    v_mfma_f32_16x16x32_bf16 v[112:115], v[212:215], v[176:179], v[112:115]
    ds_read_b64_tr_b16 v[232:233], v203 offset:16384
    v_mfma_f32_16x16x32_bf16 v[120:123], v[212:215], v[180:183], v[120:123]
    ds_read_b64_tr_b16 v[234:235], v203 offset:16896
    v_mfma_f32_16x16x32_bf16 v[128:131], v[212:215], v[184:187], v[128:131]
    ds_read_b128 v[40:43], v193 offset:0
    v_mfma_f32_16x16x32_bf16 v[136:139], v[212:215], v[188:191], v[136:139]
    ds_read_b128 v[44:47], v193 offset:2048
    s_waitcnt lgkmcnt(10)
    v_mfma_f32_16x16x32_bf16 v[144:147], v[176:179], v[216:219], v[144:147]
    v_mfma_f32_16x16x32_bf16 v[152:155], v[180:183], v[216:219], v[152:155]
    v_mfma_f32_16x16x32_bf16 v[160:163], v[184:187], v[216:219], v[160:163]
    v_mfma_f32_16x16x32_bf16 v[168:171], v[188:191], v[216:219], v[168:171]
    s_waitcnt lgkmcnt(8)
    v_cmp_ne_u32 vcc, s60, v37
    v_cmp_ne_u32 s[68:69], s60, v31
    s_or_b64 vcc, vcc, s[68:69]
    s_cbranch_vccnz SL_48
SE_49:
    s_waitcnt lgkmcnt(6)
    v_mfma_f32_16x16x32_bf16 v[84:87], v[224:227], v[176:179], v[84:87]
    ds_read_b128 v[48:51], v195 offset:0
    v_lshlrev_b32 v38, 7, v1
    v_mfma_f32_16x16x32_bf16 v[92:95], v[224:227], v[180:183], v[92:95]
    ds_read_b128 v[52:55], v195 offset:2048
    v_mfma_f32_16x16x32_bf16 v[100:103], v[224:227], v[184:187], v[100:103]
    ds_read_b64_tr_b16 v[208:209], v200 offset:4096
    v_mfma_f32_16x16x32_bf16 v[108:111], v[224:227], v[188:191], v[108:111]
    ds_read_b64_tr_b16 v[210:211], v200 offset:4608
    s_waitcnt lgkmcnt(8)
    v_mfma_f32_16x16x32_bf16 v[116:119], v[228:231], v[176:179], v[116:119]
    ds_read_b64_tr_b16 v[212:213], v200 offset:12288
    v_mfma_f32_16x16x32_bf16 v[124:127], v[228:231], v[180:183], v[124:127]
    ds_read_b64_tr_b16 v[214:215], v200 offset:12800
    v_mfma_f32_16x16x32_bf16 v[132:135], v[228:231], v[184:187], v[132:135]
    ds_read_b64_tr_b16 v[216:217], v200 offset:20480
    v_mfma_f32_16x16x32_bf16 v[140:143], v[228:231], v[188:191], v[140:143]
    ds_read_b64_tr_b16 v[218:219], v200 offset:20992
    s_waitcnt lgkmcnt(10)
    v_mfma_f32_16x16x32_bf16 v[148:151], v[176:179], v[232:235], v[148:151]
    ds_read_b32 v240, v237 offset:0
    v_mfma_f32_16x16x32_bf16 v[156:159], v[180:183], v[232:235], v[156:159]
    ds_read_b32 v241, v237 offset:256
    v_mfma_f32_16x16x32_bf16 v[164:167], v[184:187], v[232:235], v[164:167]
    ds_read_b32 v242, v238 offset:0
    v_mfma_f32_16x16x32_bf16 v[172:175], v[188:191], v[232:235], v[172:175]
    ds_read_b32 v243, v238 offset:256
    s_waitcnt lgkmcnt(8)
    v_mfma_f32_16x16x32_bf16 v[80:83], v[208:211], v[40:43], v[80:83]
    ds_read_b64_tr_b16 v[224:225], v203 offset:4096
    v_mfma_f32_16x16x32_bf16 v[88:91], v[208:211], v[44:47], v[88:91]
    ds_read_b64_tr_b16 v[226:227], v203 offset:4608
    v_mfma_f32_16x16x32_bf16 v[96:99], v[208:211], v[48:51], v[96:99]
    ds_read_b64_tr_b16 v[228:229], v203 offset:12288
    v_mfma_f32_16x16x32_bf16 v[104:107], v[208:211], v[52:55], v[104:107]
    ds_read_b64_tr_b16 v[230:231], v203 offset:12800
    v_mul_f32 v34, 0x3fb8aa3b, v35
    v_mul_f32 v28, 0x3fb8aa3b, v29
    s_waitcnt lgkmcnt(10)
    v_mfma_f32_16x16x32_bf16 v[112:115], v[212:215], v[40:43], v[112:115]
    ds_read_b64_tr_b16 v[232:233], v203 offset:20480
    v_mfma_f32_16x16x32_bf16 v[120:123], v[212:215], v[44:47], v[120:123]
    ds_read_b64_tr_b16 v[234:235], v203 offset:20992
    s_waitcnt lgkmcnt(6)
    v_cvt_pk_bf16_f32 v176, -v240, -v240
    v_mfma_f32_16x16x32_bf16 v[128:131], v[212:215], v[48:51], v[128:131]
    v_mov_b32 v178, 0
    ds_read2_b32 v[192:193], v17 offset0:1 offset1:5
    v_mfma_f32_16x16x32_bf16 v[136:139], v[212:215], v[52:55], v[136:139]
    v_lshlrev_b32 v177, 16, v176
    ds_read2_b32 v[194:195], v17 offset0:9 offset1:13
    v_mfma_f32_16x16x32_bf16 v[144:147], v[40:43], v[216:219], v[144:147]
    v_sub_f32 v177, -v240, v177
    ds_read2_b32 v[196:197], v17 offset0:65 offset1:69
    v_mfma_f32_16x16x32_bf16 v[152:155], v[44:47], v[216:219], v[152:155]
    v_mov_b32 v179, 0
    ds_read2_b32 v[198:199], v17 offset0:73 offset1:77
    v_mfma_f32_16x16x32_bf16 v[160:163], v[48:51], v[216:219], v[160:163]
    v_cvt_pk_bf16_f32 v177, v177, v177
    v_cvt_pk_bf16_f32 v180, -v241, -v241
    v_mov_b32 v182, 0
    v_mfma_f32_16x16x32_bf16 v[168:171], v[52:55], v[216:219], v[168:171]
    v_lshlrev_b32 v181, 16, v180
    v_sub_f32 v181, -v241, v181
    v_mov_b32 v183, 0
    s_waitcnt lgkmcnt(8)
    v_mfma_f32_16x16x32_bf16 v[84:87], v[224:227], v[40:43], v[84:87]
    v_cvt_pk_bf16_f32 v181, v181, v181
    v_mfma_f32_16x16x32_bf16 v[92:95], v[224:227], v[44:47], v[92:95]
    s_waitcnt lgkmcnt(0)
    s_barrier
    ds_read2_b32 v[56:57], v14 offset0:0 offset1:0
    ds_read2_b32 v[58:59], v236 offset0:0 offset1:0
    v_mfma_f32_16x16x32_bf16 v[100:103], v[224:227], v[48:51], v[100:103]
    ds_read2_b32 v[60:61], v14 offset0:64 offset1:64
    ds_read2_b32 v[62:63], v236 offset0:64 offset1:64
    v_mfma_f32_16x16x32_bf16 v[108:111], v[224:227], v[52:55], v[108:111]
    ds_read2_b32 v[64:65], v14 offset0:128 offset1:128
    ds_read2_b32 v[66:67], v236 offset0:128 offset1:128
    v_mfma_f32_16x16x32_bf16 v[116:119], v[228:231], v[40:43], v[116:119]
    v_cvt_pk_bf16_f32 v184, -v242, -v242
    ds_read2_b32 v[200:201], v18 offset0:1 offset1:5
    v_mfma_f32_16x16x32_bf16 v[124:127], v[228:231], v[44:47], v[124:127]
    v_mov_b32 v186, 0
    ds_read2_b32 v[202:203], v18 offset0:9 offset1:13
    v_mfma_f32_16x16x32_bf16 v[132:135], v[228:231], v[48:51], v[132:135]
    v_lshlrev_b32 v185, 16, v184
    ds_read2_b32 v[204:205], v18 offset0:65 offset1:69
    v_mfma_f32_16x16x32_bf16 v[140:143], v[228:231], v[52:55], v[140:143]
    v_sub_f32 v185, -v242, v185
    ds_read2_b32 v[206:207], v18 offset0:73 offset1:77
    v_mfma_f32_16x16x32_bf16 v[148:151], v[40:43], v[232:235], v[148:151]
    v_mov_b32 v187, 0
    v_cvt_pk_bf16_f32 v185, v185, v185
    v_mfma_f32_16x16x32_bf16 v[156:159], v[44:47], v[232:235], v[156:159]
    v_cvt_pk_bf16_f32 v188, -v243, -v243
    v_mov_b32 v190, 0
    v_mfma_f32_16x16x32_bf16 v[164:167], v[48:51], v[232:235], v[164:167]
    v_lshlrev_b32 v189, 16, v188
    v_sub_f32 v189, -v243, v189
    v_mfma_f32_16x16x32_bf16 v[172:175], v[52:55], v[232:235], v[172:175]
    v_mov_b32 v191, 0
    v_cvt_pk_bf16_f32 v189, v189, v189
    s_waitcnt lgkmcnt(0)
    v_mfma_f32_16x16x32_bf16 v[112:115], v[60:63], v[176:179], v[112:115]
    v_mfma_f32_16x16x32_bf16 v[116:119], v[62:65], v[176:179], v[116:119]
    v_mfma_f32_16x16x32_bf16 v[120:123], v[60:63], v[180:183], v[120:123]
    v_mfma_f32_16x16x32_bf16 v[124:127], v[62:65], v[180:183], v[124:127]
    v_mfma_f32_16x16x32_bf16 v[128:131], v[60:63], v[184:187], v[128:131]
    v_mfma_f32_16x16x32_bf16 v[132:135], v[62:65], v[184:187], v[132:135]
    v_mfma_f32_16x16x32_bf16 v[136:139], v[60:63], v[188:191], v[136:139]
    v_mfma_f32_16x16x32_bf16 v[140:143], v[62:65], v[188:191], v[140:143]
    s_nop 0
    v_cvt_pk_bf16_f32 v40, v112, v113
    s_nop 0
    v_cvt_pk_bf16_f32 v42, v120, v121
    v_cvt_pk_bf16_f32 v41, v114, v115
    v_cvt_pk_bf16_f32 v43, v122, v123
    v_permlane16_swap_b32 v40, v42
    s_nop 0
    v_permlane16_swap_b32 v41, v43
    s_nop 1
    v_mfma_f32_32x32x16_bf16 v[224:239], v[248:251], v[40:43], 0
    v_cvt_pk_bf16_f32 v48, v128, v129
    v_cvt_pk_bf16_f32 v50, v136, v137
    v_cvt_pk_bf16_f32 v49, v130, v131
    v_cvt_pk_bf16_f32 v51, v138, v139
    v_mfma_f32_16x16x32_bf16 v[144:147], v[176:179], v[64:67], v[144:147]
    v_mfma_f32_16x16x32_bf16 v[148:151], v[176:179], v[66:69], v[148:151]
    v_permlane16_swap_b32 v48, v50
    v_permlane16_swap_b32 v49, v51
    s_nop 1
    v_mfma_f32_32x32x16_bf16 v[208:223], v[248:251], v[48:51], 0
    v_cvt_pk_bf16_f32 v44, v116, v117
    v_cvt_pk_bf16_f32 v46, v124, v125
    v_cvt_pk_bf16_f32 v45, v118, v119
    v_cvt_pk_bf16_f32 v47, v126, v127
    v_mfma_f32_16x16x32_bf16 v[152:155], v[180:183], v[64:67], v[152:155]
    v_mfma_f32_16x16x32_bf16 v[156:159], v[180:183], v[66:69], v[156:159]
    v_permlane16_swap_b32 v44, v46
    v_permlane16_swap_b32 v45, v47
    v_cvt_pk_bf16_f32 v52, v132, v133
    v_cvt_pk_bf16_f32 v54, v140, v141
    v_mfma_f32_16x16x32_bf16 v[160:163], v[184:187], v[64:67], v[160:163]
    v_mfma_f32_16x16x32_bf16 v[164:167], v[184:187], v[66:69], v[164:167]
    v_cvt_pk_bf16_f32 v53, v134, v135
    v_cvt_pk_bf16_f32 v55, v142, v143
    v_permlane16_swap_b32 v52, v54
    s_nop 0
    v_permlane16_swap_b32 v53, v55
    v_mul_f32 v144, v144, v192
    v_mul_f32 v145, v145, v193
    v_mfma_f32_16x16x32_bf16 v[168:171], v[188:191], v[64:67], v[168:171]
    v_mfma_f32_16x16x32_bf16 v[172:175], v[188:191], v[66:69], v[172:175]
    v_mul_f32 v146, v146, v194
    v_mul_f32 v147, v147, v195
    v_mul_f32 v148, v148, v192
    v_mul_f32 v149, v149, v193
    v_mul_f32 v150, v150, v194
    v_mul_f32 v151, v151, v195
    v_max3_f32 v16, v224, v225, v226
    v_max3_f32 v17, v227, v228, v229
    v_max3_f32 v18, v230, v231, v232
    v_max3_f32 v16, v16, v233, v234
    v_max3_f32 v17, v17, v235, v236
    v_max3_f32 v18, v18, v237, v238
    v_max3_f32 v16, v16, v17, v239
    v_max_f32 v16, v16, v18
    v_mul_f32 v16, -v34, v16
    v_pk_fma_f32 v[224:225], v[224:225], v[34:35], v[16:17] op_sel_hi:[1,0,0]
    v_pk_fma_f32 v[226:227], v[226:227], v[34:35], v[16:17] op_sel_hi:[1,0,0]
    v_pk_fma_f32 v[228:229], v[228:229], v[34:35], v[16:17] op_sel_hi:[1,0,0]
    v_pk_fma_f32 v[230:231], v[230:231], v[34:35], v[16:17] op_sel_hi:[1,0,0]
    v_pk_fma_f32 v[232:233], v[232:233], v[34:35], v[16:17] op_sel_hi:[1,0,0]
    v_pk_fma_f32 v[234:235], v[234:235], v[34:35], v[16:17] op_sel_hi:[1,0,0]
    v_pk_fma_f32 v[236:237], v[236:237], v[34:35], v[16:17] op_sel_hi:[1,0,0]
    v_pk_fma_f32 v[238:239], v[238:239], v[34:35], v[16:17] op_sel_hi:[1,0,0]
    v_pk_mul_f32 v[152:153], v[152:153], v[196:197]
    v_pk_mul_f32 v[154:155], v[154:155], v[198:199]
    v_pk_mul_f32 v[156:157], v[156:157], v[196:197]
    v_pk_mul_f32 v[158:159], v[158:159], v[198:199]
    v_pk_mul_f32 v[160:161], v[160:161], v[200:201]
    v_pk_mul_f32 v[162:163], v[162:163], v[202:203]
    v_pk_mul_f32 v[164:165], v[164:165], v[200:201]
    v_pk_mul_f32 v[166:167], v[166:167], v[202:203]
    v_pk_mul_f32 v[168:169], v[168:169], v[204:205]
    v_pk_mul_f32 v[170:171], v[170:171], v[206:207]
    v_pk_mul_f32 v[172:173], v[172:173], v[204:205]
    v_pk_mul_f32 v[174:175], v[174:175], v[206:207]
    v_mfma_f32_32x32x16_bf16 v[112:127], v[252:255], v[44:47], 0
    v_exp_f32 v224, v224
    v_exp_f32 v225, v225
    v_exp_f32 v226, v226
    v_exp_f32 v227, v227
    v_mfma_f32_32x32x16_bf16 v[128:143], v[252:255], v[52:55], 0
    v_exp_f32 v228, v228
    v_exp_f32 v229, v229
    v_exp_f32 v230, v230
    v_exp_f32 v231, v231
    v_mfma_f32_16x16x32_bf16 v[80:83], v[56:59], v[176:179], v[80:83]
    v_mfma_f32_16x16x32_bf16 v[84:87], v[58:61], v[176:179], v[84:87]
    v_mfma_f32_16x16x32_bf16 v[88:91], v[56:59], v[180:183], v[88:91]
    v_mfma_f32_16x16x32_bf16 v[92:95], v[58:61], v[180:183], v[92:95]
    v_exp_f32 v232, v232
    v_exp_f32 v233, v233
    v_exp_f32 v234, v234
    v_exp_f32 v235, v235
    v_mfma_f32_16x16x32_bf16 v[96:99], v[56:59], v[184:187], v[96:99]
    v_mfma_f32_16x16x32_bf16 v[100:103], v[58:61], v[184:187], v[100:103]
    v_mfma_f32_16x16x32_bf16 v[104:107], v[56:59], v[188:191], v[104:107]
    v_mfma_f32_16x16x32_bf16 v[108:111], v[58:61], v[188:191], v[108:111]
    v_exp_f32 v236, v236
    v_exp_f32 v237, v237
    v_exp_f32 v238, v238
    v_exp_f32 v239, v239
    v_cvt_pk_bf16_f32 v176, v144, v145
    v_cvt_pk_bf16_f32 v177, v146, v147
    v_cvt_pk_bf16_f32 v178, v148, v149
    v_cvt_pk_bf16_f32 v179, v150, v151
    v_cvt_pk_bf16_f32 v180, v152, v153
    v_cvt_pk_bf16_f32 v181, v154, v155
    v_cvt_pk_bf16_f32 v182, v156, v157
    v_cvt_pk_bf16_f32 v183, v158, v159
    v_cvt_pk_bf16_f32 v184, v160, v161
    v_cvt_pk_bf16_f32 v185, v162, v163
    v_cvt_pk_bf16_f32 v186, v164, v165
    v_cvt_pk_bf16_f32 v187, v166, v167
    v_cvt_pk_bf16_f32 v188, v168, v169
    v_cvt_pk_bf16_f32 v189, v170, v171
    v_cvt_pk_bf16_f32 v190, v172, v173
    v_cvt_pk_bf16_f32 v191, v174, v175
    v_permlane16_swap_b32 v176, v178
    v_permlane16_swap_b32 v177, v179
    v_permlane16_swap_b32 v180, v182
    v_permlane16_swap_b32 v181, v183
    v_permlane16_swap_b32 v184, v186
    v_permlane16_swap_b32 v185, v187
    v_permlane16_swap_b32 v188, v190
    v_permlane16_swap_b32 v189, v191
    v_permlane32_swap_b32 v176, v178
    v_permlane32_swap_b32 v177, v179
    v_permlane32_swap_b32 v180, v182
    v_permlane32_swap_b32 v181, v183
    v_permlane32_swap_b32 v184, v186
    v_permlane32_swap_b32 v185, v187
    v_permlane32_swap_b32 v188, v190
    v_permlane32_swap_b32 v189, v191
    v_pk_add_f32 v[16:17], v[224:225], v[226:227]
    v_pk_add_f32 v[18:19], v[228:229], v[230:231]
    v_pk_add_f32 v[16:17], v[16:17], v[232:233]
    v_pk_add_f32 v[18:19], v[18:19], v[234:235]
    v_pk_add_f32 v[16:17], v[16:17], v[236:237]
    v_pk_add_f32 v[18:19], v[18:19], v[238:239]
    v_pk_add_f32 v[16:17], v[16:17], v[18:19]
    v_add_f32 v16, v16, v17
    v_rcp_f32 v16, v16
    s_nop 0
    v_pk_mul_f32 v[224:225], v[224:225], v[16:17] op_sel_hi:[1,0]
    v_pk_mul_f32 v[226:227], v[226:227], v[16:17] op_sel_hi:[1,0]
    v_pk_mul_f32 v[228:229], v[228:229], v[16:17] op_sel_hi:[1,0]
    v_pk_mul_f32 v[230:231], v[230:231], v[16:17] op_sel_hi:[1,0]
    v_pk_mul_f32 v[232:233], v[232:233], v[16:17] op_sel_hi:[1,0]
    v_pk_mul_f32 v[234:235], v[234:235], v[16:17] op_sel_hi:[1,0]
    v_pk_mul_f32 v[236:237], v[236:237], v[16:17] op_sel_hi:[1,0]
    v_pk_mul_f32 v[238:239], v[238:239], v[16:17] op_sel_hi:[1,0]
    v_cvt_pk_bf16_f32 v56, v224, v225
    v_cvt_pk_bf16_f32 v57, v226, v227
    v_cvt_pk_bf16_f32 v58, v228, v229
    v_cvt_pk_bf16_f32 v59, v230, v231
    v_cvt_pk_bf16_f32 v60, v232, v233
    v_cvt_pk_bf16_f32 v61, v234, v235
    v_cvt_pk_bf16_f32 v62, v236, v237
    v_cvt_pk_bf16_f32 v63, v238, v239
    v_max3_f32 v16, v208, v209, v210
    v_max3_f32 v17, v211, v212, v213
    v_max3_f32 v18, v214, v215, v216
    v_max3_f32 v16, v16, v217, v218
    v_max3_f32 v17, v17, v219, v220
    v_max3_f32 v18, v18, v221, v222
    v_max3_f32 v16, v16, v17, v223
    v_max_f32 v16, v16, v18
    v_mul_f32 v16, -v28, v16
    v_pk_fma_f32 v[208:209], v[208:209], v[28:29], v[16:17] op_sel_hi:[1,0,0]
    v_pk_fma_f32 v[210:211], v[210:211], v[28:29], v[16:17] op_sel_hi:[1,0,0]
    v_pk_fma_f32 v[212:213], v[212:213], v[28:29], v[16:17] op_sel_hi:[1,0,0]
    v_pk_fma_f32 v[214:215], v[214:215], v[28:29], v[16:17] op_sel_hi:[1,0,0]
    v_pk_fma_f32 v[216:217], v[216:217], v[28:29], v[16:17] op_sel_hi:[1,0,0]
    v_pk_fma_f32 v[218:219], v[218:219], v[28:29], v[16:17] op_sel_hi:[1,0,0]
    v_pk_fma_f32 v[220:221], v[220:221], v[28:29], v[16:17] op_sel_hi:[1,0,0]
    v_pk_fma_f32 v[222:223], v[222:223], v[28:29], v[16:17] op_sel_hi:[1,0,0]
    v_mfma_f32_32x32x16_bf16 v[192:207], v[56:59], v[72:75], 0
    v_exp_f32 v208, v208
    v_exp_f32 v209, v209
    v_exp_f32 v210, v210
    v_exp_f32 v211, v211
    v_mfma_f32_32x32x16_bf16 v[192:207], v[60:63], v[76:79], v[192:207]
    v_exp_f32 v212, v212
    v_exp_f32 v213, v213
    v_exp_f32 v214, v214
    v_exp_f32 v215, v215
    v_exp_f32 v216, v216
    v_exp_f32 v217, v217
    v_exp_f32 v218, v218
    v_exp_f32 v219, v219
    v_exp_f32 v220, v220
    v_exp_f32 v221, v221
    v_exp_f32 v222, v222
    v_exp_f32 v223, v223
    v_cvt_pk_bf16_f32 v56, v192, v193
    v_cvt_pk_bf16_f32 v57, v194, v195
    v_cvt_pk_bf16_f32 v58, v196, v197
    v_cvt_pk_bf16_f32 v59, v198, v199
    v_cvt_pk_bf16_f32 v60, v200, v201
    v_cvt_pk_bf16_f32 v61, v202, v203
    v_cvt_pk_bf16_f32 v62, v204, v205
    v_cvt_pk_bf16_f32 v63, v206, v207
    v_pk_add_f32 v[240:241], v[192:193], v[194:195]
    v_pk_add_f32 v[242:243], v[196:197], v[198:199]
    v_pk_add_f32 v[240:241], v[240:241], v[200:201]
    v_pk_add_f32 v[242:243], v[242:243], v[202:203]
    v_pk_add_f32 v[240:241], v[240:241], v[204:205]
    v_pk_add_f32 v[242:243], v[242:243], v[206:207]
    v_pk_add_f32 v[240:241], v[240:241], v[242:243]
    v_add_f32 v22, v240, v241
    v_pk_add_f32 v[16:17], v[208:209], v[210:211]
    v_pk_add_f32 v[18:19], v[212:213], v[214:215]
    v_pk_add_f32 v[16:17], v[16:17], v[216:217]
    v_pk_add_f32 v[18:19], v[18:19], v[218:219]
    v_pk_add_f32 v[16:17], v[16:17], v[220:221]
    v_pk_add_f32 v[18:19], v[18:19], v[222:223]
    v_pk_add_f32 v[16:17], v[16:17], v[18:19]
    v_add_f32 v16, v16, v17
    v_rcp_f32 v16, v16
    s_nop 0
    v_pk_mul_f32 v[208:209], v[208:209], v[16:17] op_sel_hi:[1,0]
    v_pk_mul_f32 v[210:211], v[210:211], v[16:17] op_sel_hi:[1,0]
    v_pk_mul_f32 v[212:213], v[212:213], v[16:17] op_sel_hi:[1,0]
    v_pk_mul_f32 v[214:215], v[214:215], v[16:17] op_sel_hi:[1,0]
    v_pk_mul_f32 v[216:217], v[216:217], v[16:17] op_sel_hi:[1,0]
    v_pk_mul_f32 v[218:219], v[218:219], v[16:17] op_sel_hi:[1,0]
    v_pk_mul_f32 v[220:221], v[220:221], v[16:17] op_sel_hi:[1,0]
    v_pk_mul_f32 v[222:223], v[222:223], v[16:17] op_sel_hi:[1,0]
    v_mfma_f32_32x32x16_bf16 v[144:159], v[56:59], v[176:179], 0
    v_cvt_pk_bf16_f32 v64, v208, v209
    v_cvt_pk_bf16_f32 v65, v210, v211
    v_cvt_pk_bf16_f32 v66, v212, v213
    v_cvt_pk_bf16_f32 v67, v214, v215
    v_cvt_pk_bf16_f32 v68, v216, v217
    v_cvt_pk_bf16_f32 v69, v218, v219
    v_cvt_pk_bf16_f32 v70, v220, v221
    v_cvt_pk_bf16_f32 v71, v222, v223
    v_mfma_f32_32x32x16_bf16 v[144:159], v[60:63], v[180:183], v[144:159]
    v_max3_f32 v16, v112, v113, v114
    v_max3_f32 v17, v115, v116, v117
    v_max3_f32 v18, v118, v119, v120
    v_max3_f32 v16, v16, v121, v122
    v_max3_f32 v17, v17, v123, v124
    v_max3_f32 v18, v18, v125, v126
    v_max3_f32 v16, v16, v17, v127
    v_max_f32 v16, v16, v18
    v_mul_f32 v16, -v34, v16
    v_pk_fma_f32 v[112:113], v[112:113], v[34:35], v[16:17] op_sel_hi:[1,0,0]
    v_pk_fma_f32 v[114:115], v[114:115], v[34:35], v[16:17] op_sel_hi:[1,0,0]
    v_pk_fma_f32 v[116:117], v[116:117], v[34:35], v[16:17] op_sel_hi:[1,0,0]
    v_pk_fma_f32 v[118:119], v[118:119], v[34:35], v[16:17] op_sel_hi:[1,0,0]
    v_pk_fma_f32 v[120:121], v[120:121], v[34:35], v[16:17] op_sel_hi:[1,0,0]
    v_pk_fma_f32 v[122:123], v[122:123], v[34:35], v[16:17] op_sel_hi:[1,0,0]
    v_pk_fma_f32 v[124:125], v[124:125], v[34:35], v[16:17] op_sel_hi:[1,0,0]
    v_pk_fma_f32 v[126:127], v[126:127], v[34:35], v[16:17] op_sel_hi:[1,0,0]
    v_mfma_f32_32x32x16_bf16 v[192:207], v[64:67], v[72:75], 0
    v_exp_f32 v112, v112
    v_exp_f32 v113, v113
    v_exp_f32 v114, v114
    v_exp_f32 v115, v115
    v_mfma_f32_32x32x16_bf16 v[192:207], v[68:71], v[76:79], v[192:207]
    v_exp_f32 v116, v116
    v_exp_f32 v117, v117
    v_exp_f32 v118, v118
    v_exp_f32 v119, v119
    v_exp_f32 v120, v120
    v_exp_f32 v121, v121
    v_exp_f32 v122, v122
    v_exp_f32 v123, v123
    v_exp_f32 v124, v124
    v_exp_f32 v125, v125
    v_exp_f32 v126, v126
    v_exp_f32 v127, v127
    v_cvt_pk_bf16_f32 v64, v192, v193
    v_cvt_pk_bf16_f32 v65, v194, v195
    v_cvt_pk_bf16_f32 v66, v196, v197
    v_cvt_pk_bf16_f32 v67, v198, v199
    v_cvt_pk_bf16_f32 v68, v200, v201
    v_cvt_pk_bf16_f32 v69, v202, v203
    v_cvt_pk_bf16_f32 v70, v204, v205
    v_cvt_pk_bf16_f32 v71, v206, v207
    v_pk_add_f32 v[240:241], v[192:193], v[194:195]
    v_pk_add_f32 v[242:243], v[196:197], v[198:199]
    v_pk_add_f32 v[240:241], v[240:241], v[200:201]
    v_pk_add_f32 v[242:243], v[242:243], v[202:203]
    v_pk_add_f32 v[240:241], v[240:241], v[204:205]
    v_pk_add_f32 v[242:243], v[242:243], v[206:207]
    v_pk_add_f32 v[240:241], v[240:241], v[242:243]
    v_add_f32 v23, v240, v241
    v_pk_add_f32 v[16:17], v[112:113], v[114:115]
    v_pk_add_f32 v[18:19], v[116:117], v[118:119]
    v_pk_add_f32 v[16:17], v[16:17], v[120:121]
    v_pk_add_f32 v[18:19], v[18:19], v[122:123]
    v_pk_add_f32 v[16:17], v[16:17], v[124:125]
    v_pk_add_f32 v[18:19], v[18:19], v[126:127]
    v_pk_add_f32 v[16:17], v[16:17], v[18:19]
    v_add_f32 v16, v16, v17
    v_rcp_f32 v16, v16
    s_nop 0
    v_pk_mul_f32 v[112:113], v[112:113], v[16:17] op_sel_hi:[1,0]
    v_pk_mul_f32 v[114:115], v[114:115], v[16:17] op_sel_hi:[1,0]
    v_pk_mul_f32 v[116:117], v[116:117], v[16:17] op_sel_hi:[1,0]
    v_pk_mul_f32 v[118:119], v[118:119], v[16:17] op_sel_hi:[1,0]
    v_pk_mul_f32 v[120:121], v[120:121], v[16:17] op_sel_hi:[1,0]
    v_pk_mul_f32 v[122:123], v[122:123], v[16:17] op_sel_hi:[1,0]
    v_pk_mul_f32 v[124:125], v[124:125], v[16:17] op_sel_hi:[1,0]
    v_pk_mul_f32 v[126:127], v[126:127], v[16:17] op_sel_hi:[1,0]
    v_mfma_f32_32x32x16_bf16 v[144:159], v[64:67], v[184:187], v[144:159]
    v_cvt_pk_bf16_f32 v56, v112, v113
    v_cvt_pk_bf16_f32 v57, v114, v115
    v_cvt_pk_bf16_f32 v58, v116, v117
    v_cvt_pk_bf16_f32 v59, v118, v119
    v_cvt_pk_bf16_f32 v60, v120, v121
    v_cvt_pk_bf16_f32 v61, v122, v123
    v_cvt_pk_bf16_f32 v62, v124, v125
    v_cvt_pk_bf16_f32 v63, v126, v127
    v_mfma_f32_32x32x16_bf16 v[144:159], v[68:71], v[188:191], v[144:159]
    v_max3_f32 v16, v128, v129, v130
    v_max3_f32 v17, v131, v132, v133
    v_max3_f32 v18, v134, v135, v136
    v_max3_f32 v16, v16, v137, v138
    v_max3_f32 v17, v17, v139, v140
    v_max3_f32 v18, v18, v141, v142
    v_max3_f32 v16, v16, v17, v143
    v_max_f32 v16, v16, v18
    v_mul_f32 v16, -v28, v16
    v_pk_fma_f32 v[128:129], v[128:129], v[28:29], v[16:17] op_sel_hi:[1,0,0]
    v_pk_fma_f32 v[130:131], v[130:131], v[28:29], v[16:17] op_sel_hi:[1,0,0]
    v_pk_fma_f32 v[132:133], v[132:133], v[28:29], v[16:17] op_sel_hi:[1,0,0]
    v_pk_fma_f32 v[134:135], v[134:135], v[28:29], v[16:17] op_sel_hi:[1,0,0]
    v_pk_fma_f32 v[136:137], v[136:137], v[28:29], v[16:17] op_sel_hi:[1,0,0]
    v_pk_fma_f32 v[138:139], v[138:139], v[28:29], v[16:17] op_sel_hi:[1,0,0]
    v_pk_fma_f32 v[140:141], v[140:141], v[28:29], v[16:17] op_sel_hi:[1,0,0]
    v_pk_fma_f32 v[142:143], v[142:143], v[28:29], v[16:17] op_sel_hi:[1,0,0]
    v_mfma_f32_32x32x16_bf16 v[192:207], v[56:59], v[72:75], 0
    v_exp_f32 v128, v128
    v_exp_f32 v129, v129
    v_exp_f32 v130, v130
    v_exp_f32 v131, v131
    v_mfma_f32_32x32x16_bf16 v[192:207], v[60:63], v[76:79], v[192:207]
    v_exp_f32 v132, v132
    v_exp_f32 v133, v133
    v_exp_f32 v134, v134
    v_exp_f32 v135, v135
    v_add_f32 v22, v22, v23
    v_mov_b32 v23, 1
    v_permlane16_swap_b32 v144, v152
    v_permlane16_swap_b32 v145, v153
    v_permlane16_swap_b32 v146, v154
    v_permlane16_swap_b32 v147, v155
    v_permlane16_swap_b32 v148, v156
    v_permlane16_swap_b32 v149, v157
    v_permlane16_swap_b32 v150, v158
    v_permlane16_swap_b32 v151, v159
    ds_write_b128 v4, v[144:147] offset:0
    ds_write_b128 v4, v[148:151] offset:1024
    ds_write_b64 v15, v[22:23]
    v_exp_f32 v136, v136
    v_exp_f32 v137, v137
    v_exp_f32 v138, v138
    v_exp_f32 v139, v139
    v_exp_f32 v140, v140
    v_exp_f32 v141, v141
    v_exp_f32 v142, v142
    v_exp_f32 v143, v143
    v_cvt_pk_bf16_f32 v56, v192, v193
    v_cvt_pk_bf16_f32 v57, v194, v195
    v_cvt_pk_bf16_f32 v58, v196, v197
    v_cvt_pk_bf16_f32 v59, v198, v199
    v_cvt_pk_bf16_f32 v60, v200, v201
    v_cvt_pk_bf16_f32 v61, v202, v203
    v_cvt_pk_bf16_f32 v62, v204, v205
    v_cvt_pk_bf16_f32 v63, v206, v207
    v_pk_add_f32 v[240:241], v[192:193], v[194:195]
    v_pk_add_f32 v[242:243], v[196:197], v[198:199]
    v_pk_add_f32 v[240:241], v[240:241], v[200:201]
    v_pk_add_f32 v[242:243], v[242:243], v[202:203]
    v_pk_add_f32 v[240:241], v[240:241], v[204:205]
    v_pk_add_f32 v[242:243], v[242:243], v[206:207]
    v_pk_add_f32 v[240:241], v[240:241], v[242:243]
    v_add_f32 v24, v240, v241
    v_pk_add_f32 v[16:17], v[128:129], v[130:131]
    v_pk_add_f32 v[18:19], v[132:133], v[134:135]
    v_pk_add_f32 v[16:17], v[16:17], v[136:137]
    v_pk_add_f32 v[18:19], v[18:19], v[138:139]
    v_pk_add_f32 v[16:17], v[16:17], v[140:141]
    v_pk_add_f32 v[18:19], v[18:19], v[142:143]
    v_pk_add_f32 v[16:17], v[16:17], v[18:19]
    v_add_f32 v16, v16, v17
    v_rcp_f32 v16, v16
    s_nop 0
    v_pk_mul_f32 v[128:129], v[128:129], v[16:17] op_sel_hi:[1,0]
    v_pk_mul_f32 v[130:131], v[130:131], v[16:17] op_sel_hi:[1,0]
    v_pk_mul_f32 v[132:133], v[132:133], v[16:17] op_sel_hi:[1,0]
    v_pk_mul_f32 v[134:135], v[134:135], v[16:17] op_sel_hi:[1,0]
    v_pk_mul_f32 v[136:137], v[136:137], v[16:17] op_sel_hi:[1,0]
    v_pk_mul_f32 v[138:139], v[138:139], v[16:17] op_sel_hi:[1,0]
    v_pk_mul_f32 v[140:141], v[140:141], v[16:17] op_sel_hi:[1,0]
    v_pk_mul_f32 v[142:143], v[142:143], v[16:17] op_sel_hi:[1,0]
    ds_read_b64 v[22:23], v2
    ds_read_b128 v[160:163], v5 offset:0
    ds_read_b128 v[164:167], v5 offset:1024
    ds_read_b128 v[168:171], v5 offset:256
    ds_read_b128 v[172:175], v5 offset:1280
    v_cvt_pk_bf16_f32 v64, v128, v129
    v_cvt_pk_bf16_f32 v65, v130, v131
    v_cvt_pk_bf16_f32 v66, v132, v133
    v_cvt_pk_bf16_f32 v67, v134, v135
    v_cvt_pk_bf16_f32 v68, v136, v137
    v_cvt_pk_bf16_f32 v69, v138, v139
    v_cvt_pk_bf16_f32 v70, v140, v141
    v_cvt_pk_bf16_f32 v71, v142, v143
WMB_50:
SEG_B0_0:
    s_cbranch_execz PAD_B0_1
    v_mfma_f32_32x32x16_bf16 v[192:207], v[64:67], v[72:75], 0
    v_cvt_pk_bf16_f32 v40, v80, v81
    v_cvt_pk_bf16_f32 v42, v88, v89
    v_cvt_pk_bf16_f32 v41, v82, v83
    v_cvt_pk_bf16_f32 v43, v90, v91
    v_permlane16_swap_b32 v40, v42
PAD_B0_1:
    s_cbranch_execz PAD_B0_2
    s_nop 0
    v_permlane16_swap_b32 v41, v43
    v_mfma_f32_32x32x16_bf16 v[192:207], v[68:71], v[76:79], v[192:207]
    s_waitcnt lgkmcnt(0)
    v_cmp_eq_u32 vcc, 0, v23
    s_cbranch_vccnz SL_51
SE_52:
    v_cvt_pk_bf16_f32 v44, v84, v85
    v_cvt_pk_bf16_f32 v46, v92, v93
    v_cvt_pk_bf16_f32 v45, v86, v87
    v_cvt_pk_bf16_f32 v47, v94, v95
    v_permlane16_swap_b32 v44, v46
    s_nop 0
    v_permlane16_swap_b32 v45, v47
    v_cvt_pk_bf16_f32 v48, v96, v97
    v_cvt_pk_bf16_f32 v50, v104, v105
    v_mfma_f32_32x32x16_bf16 v[160:175], v[56:59], v[176:179], v[160:175]
    v_cvt_pk_bf16_f32 v49, v98, v99
    v_cvt_pk_bf16_f32 v51, v106, v107
    v_permlane16_swap_b32 v48, v50
    s_nop 0
    v_permlane16_swap_b32 v49, v51
    v_cvt_pk_bf16_f32 v52, v100, v101
    v_cvt_pk_bf16_f32 v54, v108, v109
    v_cvt_pk_bf16_f32 v53, v102, v103
    v_cvt_pk_bf16_f32 v55, v110, v111
    v_permlane16_swap_b32 v52, v54
    s_nop 0
    v_permlane16_swap_b32 v53, v55
    v_mfma_f32_32x32x16_bf16 v[160:175], v[60:63], v[180:183], v[160:175]
    v_cvt_pk_bf16_f32 v64, v192, v193
    v_cvt_pk_bf16_f32 v65, v194, v195
    v_cvt_pk_bf16_f32 v66, v196, v197
    v_cvt_pk_bf16_f32 v67, v198, v199
    v_cvt_pk_bf16_f32 v68, v200, v201
    v_cvt_pk_bf16_f32 v69, v202, v203
    v_cvt_pk_bf16_f32 v70, v204, v205
    v_cvt_pk_bf16_f32 v71, v206, v207
    v_mfma_f32_32x32x16_bf16 v[160:175], v[64:67], v[184:187], v[160:175]
    v_add_f32 v192, v192, v200
PAD_B0_2:
    s_cbranch_execz PAD_B0_3
    s_nop 4
    v_add_f32 v193, v193, v201
    v_add_f32 v194, v194, v202
    v_add_f32 v195, v195, v203
    v_add_f32 v196, v196, v204
    v_add_f32 v197, v197, v205
    v_mfma_f32_32x32x16_bf16 v[160:175], v[68:71], v[188:191], v[160:175]
    v_add_f32 v198, v198, v206
    v_add_f32 v199, v199, v207
    v_add_f32 v192, v192, v196
    v_add_f32 v193, v193, v197
    v_add_f32 v194, v194, v198
    v_add_f32 v195, v195, v199
    v_add_f32 v192, v192, v194
    v_add_f32 v193, v193, v195
    v_add_f32 v22, v22, v24
    v_add_f32 v192, v192, v193
    v_add_f32 v22, v22, v192
    v_mfma_f32_32x32x16_bf16 v[224:239], v[248:251], v[40:43], 0
    v_mov_b32 v23, v22
    s_nop 1
    v_permlane32_swap_b32 v22, v23
    v_add_f32 v22, v22, v23
    buffer_store_dword v22, v3, s[24:27], s57 offen sc1
    v_cvt_pk_bf16_f32 v56, v160, v161
    v_cvt_pk_bf16_f32 v57, v162, v163
    v_cvt_pk_bf16_f32 v58, v164, v165
    v_cvt_pk_bf16_f32 v59, v166, v167
    v_cvt_pk_bf16_f32 v60, v168, v169
    v_cvt_pk_bf16_f32 v61, v170, v171
    v_cvt_pk_bf16_f32 v62, v172, v173
    v_cvt_pk_bf16_f32 v63, v174, v175
    s_mov_b32 exec_lo, s66
    s_mov_b32 exec_hi, s66
    buffer_store_dwordx4 v[56:59], v11, s[24:27], s62 offen offset:0 sc1
    buffer_store_dwordx4 v[60:63], v11, s[24:27], s62 offen offset:512 sc1
    s_mov_b64 exec, 0xf
    buffer_store_dword v37, v38, s[24:27], s98 offen offset:0 sc1
    s_mov_b64 exec, -1
    s_xor_b32 s57, s63, 1024
    s_xor_b32 s62, s64, 1024
    s_mov_b32 s65, 0
    s_setprio 3
    v_max3_f32 v16, v224, v225, v226
    v_max3_f32 v17, v227, v228, v229
    v_max3_f32 v18, v230, v231, v232
PAD_B0_3:
    s_cbranch_execz RET0_B
    v_max3_f32 v16, v16, v233, v234
    v_max3_f32 v17, v17, v235, v236
    v_max3_f32 v18, v18, v237, v238
    v_max3_f32 v16, v16, v17, v239
    v_max_f32 v16, v16, v18
    v_mul_f32 v16, -v34, v16
    v_pk_fma_f32 v[224:225], v[224:225], v[34:35], v[16:17] op_sel_hi:[1,0,0]
    v_pk_fma_f32 v[226:227], v[226:227], v[34:35], v[16:17] op_sel_hi:[1,0,0]
    v_pk_fma_f32 v[228:229], v[228:229], v[34:35], v[16:17] op_sel_hi:[1,0,0]
    v_pk_fma_f32 v[230:231], v[230:231], v[34:35], v[16:17] op_sel_hi:[1,0,0]
    v_pk_fma_f32 v[232:233], v[232:233], v[34:35], v[16:17] op_sel_hi:[1,0,0]
    v_pk_fma_f32 v[234:235], v[234:235], v[34:35], v[16:17] op_sel_hi:[1,0,0]
    v_pk_fma_f32 v[236:237], v[236:237], v[34:35], v[16:17] op_sel_hi:[1,0,0]
    v_pk_fma_f32 v[238:239], v[238:239], v[34:35], v[16:17] op_sel_hi:[1,0,0]
    v_mfma_f32_32x32x16_bf16 v[208:223], v[248:251], v[48:51], 0
    v_exp_f32 v224, v224
    v_exp_f32 v225, v225
    v_exp_f32 v226, v226
    v_exp_f32 v227, v227
    v_mfma_f32_32x32x16_bf16 v[112:127], v[252:255], v[44:47], 0
    v_exp_f32 v228, v228
    v_exp_f32 v229, v229
    v_exp_f32 v230, v230
    v_exp_f32 v231, v231
    v_mfma_f32_32x32x16_bf16 v[128:143], v[252:255], v[52:55], 0
    v_exp_f32 v232, v232
    v_exp_f32 v233, v233
    v_exp_f32 v234, v234
    v_exp_f32 v235, v235
    v_exp_f32 v236, v236
    v_exp_f32 v237, v237
    v_exp_f32 v238, v238
    v_exp_f32 v239, v239
    v_pk_add_f32 v[16:17], v[224:225], v[226:227]
    v_pk_add_f32 v[18:19], v[228:229], v[230:231]
    v_pk_add_f32 v[16:17], v[16:17], v[232:233]
    v_pk_add_f32 v[18:19], v[18:19], v[234:235]
    v_pk_add_f32 v[16:17], v[16:17], v[236:237]
    v_pk_add_f32 v[18:19], v[18:19], v[238:239]
    v_pk_add_f32 v[16:17], v[16:17], v[18:19]
SEG_B0_1:
    s_cbranch_execz PAD_B1_1
    v_add_f32 v16, v16, v17
    v_rcp_f32 v16, v16
    s_nop 0
    v_pk_mul_f32 v[224:225], v[224:225], v[16:17] op_sel_hi:[1,0]
    v_pk_mul_f32 v[226:227], v[226:227], v[16:17] op_sel_hi:[1,0]
    v_pk_mul_f32 v[228:229], v[228:229], v[16:17] op_sel_hi:[1,0]
    v_pk_mul_f32 v[230:231], v[230:231], v[16:17] op_sel_hi:[1,0]
    v_pk_mul_f32 v[232:233], v[232:233], v[16:17] op_sel_hi:[1,0]
    v_pk_mul_f32 v[234:235], v[234:235], v[16:17] op_sel_hi:[1,0]
    v_pk_mul_f32 v[236:237], v[236:237], v[16:17] op_sel_hi:[1,0]
    v_pk_mul_f32 v[238:239], v[238:239], v[16:17] op_sel_hi:[1,0]
    v_cvt_pk_bf16_f32 v80, v224, v225
    v_cvt_pk_bf16_f32 v81, v226, v227
    v_cvt_pk_bf16_f32 v82, v228, v229
    v_cvt_pk_bf16_f32 v83, v230, v231
    v_cvt_pk_bf16_f32 v84, v232, v233
    v_cvt_pk_bf16_f32 v85, v234, v235
    v_cvt_pk_bf16_f32 v86, v236, v237
    v_cvt_pk_bf16_f32 v87, v238, v239
    v_max3_f32 v16, v208, v209, v210
    v_max3_f32 v17, v211, v212, v213
    v_max3_f32 v18, v214, v215, v216
    v_max3_f32 v16, v16, v217, v218
    v_max3_f32 v17, v17, v219, v220
    v_max3_f32 v18, v18, v221, v222
    v_max3_f32 v16, v16, v17, v223
    v_max_f32 v16, v16, v18
    v_mul_f32 v16, -v28, v16
    v_pk_fma_f32 v[208:209], v[208:209], v[28:29], v[16:17] op_sel_hi:[1,0,0]
    v_pk_fma_f32 v[210:211], v[210:211], v[28:29], v[16:17] op_sel_hi:[1,0,0]
    v_pk_fma_f32 v[212:213], v[212:213], v[28:29], v[16:17] op_sel_hi:[1,0,0]
    v_pk_fma_f32 v[214:215], v[214:215], v[28:29], v[16:17] op_sel_hi:[1,0,0]
    v_pk_fma_f32 v[216:217], v[216:217], v[28:29], v[16:17] op_sel_hi:[1,0,0]
PAD_B1_1:
    s_cbranch_execz PAD_B1_2
    v_pk_fma_f32 v[218:219], v[218:219], v[28:29], v[16:17] op_sel_hi:[1,0,0]
    v_pk_fma_f32 v[220:221], v[220:221], v[28:29], v[16:17] op_sel_hi:[1,0,0]
    v_pk_fma_f32 v[222:223], v[222:223], v[28:29], v[16:17] op_sel_hi:[1,0,0]
    v_exp_f32 v208, v208
    v_exp_f32 v209, v209
    v_exp_f32 v210, v210
    v_exp_f32 v211, v211
    v_exp_f32 v212, v212
    v_exp_f32 v213, v213
    v_exp_f32 v214, v214
    v_exp_f32 v215, v215
    v_exp_f32 v216, v216
    v_exp_f32 v217, v217
    v_exp_f32 v218, v218
    v_exp_f32 v219, v219
    v_exp_f32 v220, v220
    v_exp_f32 v221, v221
    v_exp_f32 v222, v222
    v_exp_f32 v223, v223
    v_pk_add_f32 v[16:17], v[208:209], v[210:211]
    v_pk_add_f32 v[18:19], v[212:213], v[214:215]
    v_pk_add_f32 v[16:17], v[16:17], v[216:217]
    v_pk_add_f32 v[18:19], v[18:19], v[218:219]
    v_pk_add_f32 v[16:17], v[16:17], v[220:221]
    v_pk_add_f32 v[18:19], v[18:19], v[222:223]
    v_pk_add_f32 v[16:17], v[16:17], v[18:19]
    v_add_f32 v16, v16, v17
    v_rcp_f32 v16, v16
    s_nop 0
    v_pk_mul_f32 v[208:209], v[208:209], v[16:17] op_sel_hi:[1,0]
    v_pk_mul_f32 v[210:211], v[210:211], v[16:17] op_sel_hi:[1,0]
    v_pk_mul_f32 v[212:213], v[212:213], v[16:17] op_sel_hi:[1,0]
    v_pk_mul_f32 v[214:215], v[214:215], v[16:17] op_sel_hi:[1,0]
    v_pk_mul_f32 v[216:217], v[216:217], v[16:17] op_sel_hi:[1,0]
    v_pk_mul_f32 v[218:219], v[218:219], v[16:17] op_sel_hi:[1,0]
    v_pk_mul_f32 v[220:221], v[220:221], v[16:17] op_sel_hi:[1,0]
    v_pk_mul_f32 v[222:223], v[222:223], v[16:17] op_sel_hi:[1,0]
    v_cvt_pk_bf16_f32 v88, v208, v209
    v_cvt_pk_bf16_f32 v89, v210, v211
    v_cvt_pk_bf16_f32 v90, v212, v213
    v_cvt_pk_bf16_f32 v91, v214, v215
PAD_B1_2:
    s_cbranch_execz PAD_B1_3
    v_cvt_pk_bf16_f32 v92, v216, v217
    v_cvt_pk_bf16_f32 v93, v218, v219
    v_cvt_pk_bf16_f32 v94, v220, v221
    v_cvt_pk_bf16_f32 v95, v222, v223
    s_buffer_load_dwordx16 s[32:47], s[24:27], s6 glc
    v_max3_f32 v16, v112, v113, v114
    v_max3_f32 v17, v115, v116, v117
    v_max3_f32 v18, v118, v119, v120
    v_max3_f32 v16, v16, v121, v122
    v_max3_f32 v17, v17, v123, v124
    v_max3_f32 v18, v18, v125, v126
    v_max3_f32 v16, v16, v17, v127
    v_max_f32 v16, v16, v18
    v_mul_f32 v16, -v34, v16
    v_pk_fma_f32 v[112:113], v[112:113], v[34:35], v[16:17] op_sel_hi:[1,0,0]
    v_pk_fma_f32 v[114:115], v[114:115], v[34:35], v[16:17] op_sel_hi:[1,0,0]
    v_pk_fma_f32 v[116:117], v[116:117], v[34:35], v[16:17] op_sel_hi:[1,0,0]
    v_pk_fma_f32 v[118:119], v[118:119], v[34:35], v[16:17] op_sel_hi:[1,0,0]
    v_pk_fma_f32 v[120:121], v[120:121], v[34:35], v[16:17] op_sel_hi:[1,0,0]
    v_pk_fma_f32 v[122:123], v[122:123], v[34:35], v[16:17] op_sel_hi:[1,0,0]
    v_pk_fma_f32 v[124:125], v[124:125], v[34:35], v[16:17] op_sel_hi:[1,0,0]
    v_pk_fma_f32 v[126:127], v[126:127], v[34:35], v[16:17] op_sel_hi:[1,0,0]
    v_exp_f32 v112, v112
    v_exp_f32 v113, v113
    v_exp_f32 v114, v114
    v_exp_f32 v115, v115
    v_exp_f32 v116, v116
    v_exp_f32 v117, v117
    v_exp_f32 v118, v118
    v_exp_f32 v119, v119
    v_exp_f32 v120, v120
    v_exp_f32 v121, v121
    v_exp_f32 v122, v122
    v_exp_f32 v123, v123
    v_exp_f32 v124, v124
    v_exp_f32 v125, v125
    v_exp_f32 v126, v126
    v_exp_f32 v127, v127
    v_pk_add_f32 v[16:17], v[112:113], v[114:115]
    v_pk_add_f32 v[18:19], v[116:117], v[118:119]
PAD_B1_3:
    s_cbranch_execz RET0_B
    v_pk_add_f32 v[16:17], v[16:17], v[120:121]
    v_pk_add_f32 v[18:19], v[18:19], v[122:123]
    v_pk_add_f32 v[16:17], v[16:17], v[124:125]
    v_pk_add_f32 v[18:19], v[18:19], v[126:127]
    v_pk_add_f32 v[16:17], v[16:17], v[18:19]
    v_add_f32 v16, v16, v17
    v_rcp_f32 v16, v16
    s_nop 0
    v_pk_mul_f32 v[112:113], v[112:113], v[16:17] op_sel_hi:[1,0]
    v_pk_mul_f32 v[114:115], v[114:115], v[16:17] op_sel_hi:[1,0]
    v_pk_mul_f32 v[116:117], v[116:117], v[16:17] op_sel_hi:[1,0]
    v_pk_mul_f32 v[118:119], v[118:119], v[16:17] op_sel_hi:[1,0]
    v_pk_mul_f32 v[120:121], v[120:121], v[16:17] op_sel_hi:[1,0]
    v_pk_mul_f32 v[122:123], v[122:123], v[16:17] op_sel_hi:[1,0]
    v_pk_mul_f32 v[124:125], v[124:125], v[16:17] op_sel_hi:[1,0]
    v_pk_mul_f32 v[126:127], v[126:127], v[16:17] op_sel_hi:[1,0]
    v_cvt_pk_bf16_f32 v96, v112, v113
    v_cvt_pk_bf16_f32 v97, v114, v115
    v_cvt_pk_bf16_f32 v98, v116, v117
    v_cvt_pk_bf16_f32 v99, v118, v119
    v_cvt_pk_bf16_f32 v100, v120, v121
    v_cvt_pk_bf16_f32 v101, v122, v123
    v_cvt_pk_bf16_f32 v102, v124, v125
    v_cvt_pk_bf16_f32 v103, v126, v127
    s_mov_b32 s1, 3
    s_branch L_GATH
L_KVPOLL:
    s_add_u32 s1, s1, 1
    s_cmp_lg_u32 s1, 4
    s_cbranch_scc1 L_KQ3
    v_max3_f32 v16, v128, v129, v130
    v_max3_f32 v17, v131, v132, v133
    v_max3_f32 v18, v134, v135, v136
    v_max3_f32 v16, v16, v137, v138
    v_max3_f32 v17, v17, v139, v140
    v_max3_f32 v18, v18, v141, v142
    v_max3_f32 v16, v16, v17, v143
SEG_B0_2:
    s_cbranch_execz PAD_B2_1
    v_max_f32 v16, v16, v18
    v_mul_f32 v16, -v28, v16
    v_pk_fma_f32 v[128:129], v[128:129], v[28:29], v[16:17] op_sel_hi:[1,0,0]
    v_pk_fma_f32 v[130:131], v[130:131], v[28:29], v[16:17] op_sel_hi:[1,0,0]
    v_pk_fma_f32 v[132:133], v[132:133], v[28:29], v[16:17] op_sel_hi:[1,0,0]
    v_pk_fma_f32 v[134:135], v[134:135], v[28:29], v[16:17] op_sel_hi:[1,0,0]
    v_pk_fma_f32 v[136:137], v[136:137], v[28:29], v[16:17] op_sel_hi:[1,0,0]
    v_pk_fma_f32 v[138:139], v[138:139], v[28:29], v[16:17] op_sel_hi:[1,0,0]
    v_pk_fma_f32 v[140:141], v[140:141], v[28:29], v[16:17] op_sel_hi:[1,0,0]
    v_pk_fma_f32 v[142:143], v[142:143], v[28:29], v[16:17] op_sel_hi:[1,0,0]
    v_exp_f32 v128, v128
    v_exp_f32 v129, v129
    v_exp_f32 v130, v130
    v_exp_f32 v131, v131
    v_exp_f32 v132, v132
    v_exp_f32 v133, v133
    v_exp_f32 v134, v134
    v_exp_f32 v135, v135
    v_exp_f32 v136, v136
    v_exp_f32 v137, v137
    v_exp_f32 v138, v138
    v_exp_f32 v139, v139
    v_exp_f32 v140, v140
    v_exp_f32 v141, v141
    v_exp_f32 v142, v142
    v_exp_f32 v143, v143
    v_pk_add_f32 v[16:17], v[128:129], v[130:131]
    v_pk_add_f32 v[18:19], v[132:133], v[134:135]
    v_pk_add_f32 v[16:17], v[16:17], v[136:137]
    v_pk_add_f32 v[18:19], v[18:19], v[138:139]
    v_pk_add_f32 v[16:17], v[16:17], v[140:141]
    v_pk_add_f32 v[18:19], v[18:19], v[142:143]
    v_pk_add_f32 v[16:17], v[16:17], v[18:19]
    v_add_f32 v16, v16, v17
    v_rcp_f32 v16, v16
    s_nop 0
    v_pk_mul_f32 v[128:129], v[128:129], v[16:17] op_sel_hi:[1,0]
    v_pk_mul_f32 v[130:131], v[130:131], v[16:17] op_sel_hi:[1,0]
    v_pk_mul_f32 v[132:133], v[132:133], v[16:17] op_sel_hi:[1,0]
    v_pk_mul_f32 v[134:135], v[134:135], v[16:17] op_sel_hi:[1,0]
    v_pk_mul_f32 v[136:137], v[136:137], v[16:17] op_sel_hi:[1,0]
PAD_B2_1:
    s_cbranch_execz PAD_B2_2
    v_pk_mul_f32 v[138:139], v[138:139], v[16:17] op_sel_hi:[1,0]
    v_pk_mul_f32 v[140:141], v[140:141], v[16:17] op_sel_hi:[1,0]
    v_pk_mul_f32 v[142:143], v[142:143], v[16:17] op_sel_hi:[1,0]
    v_cvt_pk_bf16_f32 v104, v128, v129
    v_cvt_pk_bf16_f32 v105, v130, v131
    v_cvt_pk_bf16_f32 v106, v132, v133
    v_cvt_pk_bf16_f32 v107, v134, v135
    v_cvt_pk_bf16_f32 v108, v136, v137
    v_cvt_pk_bf16_f32 v109, v138, v139
    v_cvt_pk_bf16_f32 v110, v140, v141
    v_cvt_pk_bf16_f32 v111, v142, v143
    v_lshl_add_u32 v32, v21, 2, v32
    v_cmp_eq_u32 vcc, 0, v32
    s_nop 1
    v_cndmask_b32 v72, 0, v33, vcc
    v_cmp_eq_u32 vcc, 1, v32
    s_nop 1
    v_cndmask_b32 v73, 0, v33, vcc
    v_cmp_eq_u32 vcc, 2, v32
    s_nop 1
    v_cndmask_b32 v74, 0, v33, vcc
    v_cmp_eq_u32 vcc, 3, v32
    s_nop 1
    v_cndmask_b32 v75, 0, v33, vcc
    s_branch L_KVCHK
L_KQ3:
    s_waitcnt lgkmcnt(0)
L_KVCHK:
    s_cmp_eq_u64 s[46:47], s[20:21]
    s_addc_u32 s0, s0, s0
    s_cmp_eq_u64 s[44:45], s[20:21]
    s_addc_u32 s0, s0, s0
    s_cmp_eq_u64 s[42:43], s[20:21]
    s_addc_u32 s0, s0, s0
    s_cmp_eq_u64 s[40:41], s[20:21]
    s_addc_u32 s0, s0, s0
    s_cmp_eq_u64 s[38:39], s[20:21]
    s_addc_u32 s0, s0, s0
    s_cmp_eq_u64 s[36:37], s[20:21]
    s_addc_u32 s0, s0, s0
    s_cmp_eq_u64 s[34:35], s[20:21]
    s_addc_u32 s0, s0, s0
    s_cmp_eq_u64 s[32:33], s[20:21]
    s_addc_u32 s0, s0, s0
    s_buffer_load_dwordx16 s[32:47], s[24:27], s6 glc
    s_cmp_gt_u32 s1, SPIN_MAX
    s_cselect_b32 s50, -1, 0
    s_or_b32 s0, s0, s50
    s_and_b32 s48, s0, s59
    s_cbranch_scc0 L_KVPOLL
    s_setpc_b64 s[22:23]
L_GATH:
PAD_B2_2:
    s_cbranch_execz PAD_B2_3
    s_and_b32 s48, s0, s59
    s_cbranch_scc1 L_KVR0
    s_call_b64 s[22:23], L_KVPOLL
L_KVR0:
    s_ff1_i32_b32 s50, s48
    s_bitset0_b32 s59, s50
    s_mul_i32 s51, s50, 9216
    s_add_u32 s51, s51, s58
    s_add_u32 s50, s51, 4608
    buffer_load_dwordx4 v[144:147], v6, s[24:27], s51 offen sc1
    buffer_load_dword v56, v8, s[24:27], s51 offen sc1
    buffer_load_dwordx4 v[148:151], v6, s[24:27], s50 offen sc1
    buffer_load_dword v57, v8, s[24:27], s50 offen sc1
    s_and_b32 s48, s0, s59
    s_cbranch_scc1 L_KVR2
    s_call_b64 s[22:23], L_KVPOLL
L_KVR2:
    s_ff1_i32_b32 s50, s48
    s_bitset0_b32 s59, s50
    s_mul_i32 s51, s50, 9216
    s_add_u32 s51, s51, s58
    s_add_u32 s50, s51, 4608
    buffer_load_dwordx4 v[152:155], v6, s[24:27], s51 offen sc1
    buffer_load_dword v58, v8, s[24:27], s51 offen sc1
    buffer_load_dwordx4 v[156:159], v6, s[24:27], s50 offen sc1
    buffer_load_dword v59, v8, s[24:27], s50 offen sc1
    s_and_b32 s48, s0, s59
    s_cbranch_scc1 L_KVR4
    s_call_b64 s[22:23], L_KVPOLL
L_KVR4:
    s_ff1_i32_b32 s50, s48
    s_bitset0_b32 s59, s50
    s_mul_i32 s51, s50, 9216
    s_add_u32 s51, s51, s58
    s_add_u32 s50, s51, 4608
    buffer_load_dwordx4 v[160:163], v6, s[24:27], s51 offen sc1
    buffer_load_dword v60, v8, s[24:27], s51 offen sc1
    buffer_load_dwordx4 v[164:167], v6, s[24:27], s50 offen sc1
    buffer_load_dword v61, v8, s[24:27], s50 offen sc1
    s_and_b32 s48, s0, s59
    s_cbranch_scc1 L_KVR6
    s_call_b64 s[22:23], L_KVPOLL
L_KVR6:
    s_ff1_i32_b32 s50, s48
    s_bitset0_b32 s59, s50
    s_mul_i32 s51, s50, 9216
    s_add_u32 s51, s51, s58
    s_add_u32 s50, s51, 4608
PAD_B2_3:
    s_cbranch_execz RET0_B
    buffer_load_dwordx4 v[168:171], v6, s[24:27], s51 offen sc1
    buffer_load_dword v62, v8, s[24:27], s51 offen sc1
    buffer_load_dwordx4 v[172:175], v6, s[24:27], s50 offen sc1
    buffer_load_dword v63, v8, s[24:27], s50 offen sc1
    s_and_b32 s48, s0, s59
    s_cbranch_scc1 L_KVR8
    s_call_b64 s[22:23], L_KVPOLL
L_KVR8:
    s_ff1_i32_b32 s50, s48
    s_bitset0_b32 s59, s50
    s_mul_i32 s51, s50, 9216
    s_add_u32 s51, s51, s58
    s_add_u32 s50, s51, 4608
    buffer_load_dwordx4 v[176:179], v6, s[24:27], s51 offen sc1
    buffer_load_dword v64, v8, s[24:27], s51 offen sc1
    buffer_load_dwordx4 v[180:183], v6, s[24:27], s50 offen sc1
    buffer_load_dword v65, v8, s[24:27], s50 offen sc1
    s_and_b32 s48, s0, s59
    s_cbranch_scc1 L_KVR10
    s_call_b64 s[22:23], L_KVPOLL
L_KVR10:
    s_ff1_i32_b32 s50, s48
    s_bitset0_b32 s59, s50
    s_mul_i32 s51, s50, 9216
    s_add_u32 s51, s51, s58
    s_add_u32 s50, s51, 4608
    buffer_load_dwordx4 v[184:187], v6, s[24:27], s51 offen sc1
    buffer_load_dword v66, v8, s[24:27], s51 offen sc1
    buffer_load_dwordx4 v[188:191], v6, s[24:27], s50 offen sc1
    buffer_load_dword v67, v8, s[24:27], s50 offen sc1
    s_and_b32 s48, s0, s59
    s_cbranch_scc1 L_KVR12
    s_call_b64 s[22:23], L_KVPOLL
L_KVR12:
    s_ff1_i32_b32 s50, s48
    s_bitset0_b32 s59, s50
    s_mul_i32 s51, s50, 9216
    s_add_u32 s51, s51, s58
    s_add_u32 s50, s51, 4608
    buffer_load_dwordx4 v[192:195], v6, s[24:27], s51 offen sc1
    buffer_load_dword v68, v8, s[24:27], s51 offen sc1
    buffer_load_dwordx4 v[196:199], v6, s[24:27], s50 offen sc1
    buffer_load_dword v69, v8, s[24:27], s50 offen sc1
SEG_B0_3:
    s_cbranch_execz PAD_B3_1
    s_and_b32 s48, s0, s59
    s_cbranch_scc1 L_KVR14
    s_call_b64 s[22:23], L_KVPOLL
L_KVR14:
    s_ff1_i32_b32 s50, s48
    s_bitset0_b32 s59, s50
    s_mul_i32 s51, s50, 9216
    s_add_u32 s51, s51, s58
    s_add_u32 s50, s51, 4608
    buffer_load_dwordx4 v[200:203], v6, s[24:27], s51 offen sc1
    buffer_load_dword v70, v8, s[24:27], s51 offen sc1
    buffer_load_dwordx4 v[204:207], v6, s[24:27], s50 offen sc1
    buffer_load_dword v71, v8, s[24:27], s50 offen sc1
    s_mov_b32 s59, -1
L_QREST:
    s_cmp_ge_u32 s1, 4
    s_cbranch_scc1 L_QDONE
    s_call_b64 s[22:23], L_KVPOLL
    s_branch L_QREST
L_QDONE:
    s_lshl_b32 s48, s100, 2
    s_add_u32 s48, s48, 161808
    v_mov_b32 v14, s48
    v_xor_b32 v15, 8, v14
L_GPROC:
    s_waitcnt vmcnt(30)
    v_mfma_f32_32x32x16_bf16 v[112:127], v[72:75], v[144:147], 0
    s_waitcnt vmcnt(28)
    v_mfma_f32_32x32x16_bf16 v[112:127], v[72:75], v[148:151], v[112:127]
    v_add_f32 v56, v56, v57
    s_waitcnt vmcnt(26)
    v_mfma_f32_32x32x16_bf16 v[112:127], v[72:75], v[152:155], v[112:127]
    v_add_f32 v56, v56, v58
    s_waitcnt vmcnt(24)
    v_mfma_f32_32x32x16_bf16 v[112:127], v[72:75], v[156:159], v[112:127]
    v_add_f32 v56, v56, v59
    s_waitcnt vmcnt(22)
    v_mfma_f32_32x32x16_bf16 v[112:127], v[72:75], v[160:163], v[112:127]
    v_add_f32 v56, v56, v60
    s_waitcnt vmcnt(20)
    v_mfma_f32_32x32x16_bf16 v[112:127], v[72:75], v[164:167], v[112:127]
    v_add_f32 v56, v56, v61
    s_waitcnt vmcnt(18)
    v_mfma_f32_32x32x16_bf16 v[112:127], v[72:75], v[168:171], v[112:127]
    v_add_f32 v56, v56, v62
    s_waitcnt vmcnt(16)
    v_mfma_f32_32x32x16_bf16 v[112:127], v[72:75], v[172:175], v[112:127]
    v_add_f32 v56, v56, v63
    s_waitcnt vmcnt(14)
    v_mfma_f32_32x32x16_bf16 v[112:127], v[72:75], v[176:179], v[112:127]
    v_add_f32 v56, v56, v64
PAD_B3_1:
    s_cbranch_execz PAD_B3_2
    s_waitcnt vmcnt(12)
    v_mfma_f32_32x32x16_bf16 v[112:127], v[72:75], v[180:183], v[112:127]
    v_add_f32 v56, v56, v65
    s_waitcnt vmcnt(10)
    v_mfma_f32_32x32x16_bf16 v[112:127], v[72:75], v[184:187], v[112:127]
    v_add_f32 v56, v56, v66
    s_waitcnt vmcnt(8)
    v_mfma_f32_32x32x16_bf16 v[112:127], v[72:75], v[188:191], v[112:127]
    v_add_f32 v56, v56, v67
    s_waitcnt vmcnt(6)
    v_mfma_f32_32x32x16_bf16 v[112:127], v[72:75], v[192:195], v[112:127]
    v_add_f32 v56, v56, v68
    s_waitcnt vmcnt(4)
    v_mfma_f32_32x32x16_bf16 v[112:127], v[72:75], v[196:199], v[112:127]
    v_add_f32 v56, v56, v69
    s_waitcnt vmcnt(2)
    v_mfma_f32_32x32x16_bf16 v[112:127], v[72:75], v[200:203], v[112:127]
    v_add_f32 v56, v56, v70
    s_waitcnt vmcnt(0)
    v_mfma_f32_32x32x16_bf16 v[112:127], v[72:75], v[204:207], v[112:127]
    v_add_f32 v56, v56, v71
    v_cvt_pk_bf16_f32 v28, v56, v56
    ds_write_b16 v10, v28 offset:1280
    s_nop 8
    v_cvt_pk_bf16_f32 v24, v112, v113
    v_cvt_pk_bf16_f32 v25, v114, v115
    v_cvt_pk_bf16_f32 v26, v116, v117
    v_cvt_pk_bf16_f32 v27, v118, v119
    ds_write_b128 v9, v[24:27]
    v_cmp_u_f32 vcc, v56, v112
    s_cbranch_vccnz L_GRETRY
L_GOK:
    ds_write_b32 v14, v14
    ds_read_b128 v[40:43], v12
    ds_read_b128 v[44:47], v12 offset:16
    ds_read_b32 v29, v15
    ds_read_b128 v[48:51], v13
    ds_read_b128 v[52:55], v13 offset:16
    s_waitcnt lgkmcnt(3)
    v_mfma_f32_32x32x16_bf16 v[128:143], v[40:43], v[80:83], 0
    v_mfma_f32_32x32x16_bf16 v[128:143], v[44:47], v[84:87], v[128:143]
    v_mfma_f32_32x32x16_bf16 v[144:159], v[40:43], v[88:91], 0
PAD_B3_2:
    s_cbranch_execz PAD_B3_3
    v_mfma_f32_32x32x16_bf16 v[144:159], v[44:47], v[92:95], v[144:159]
    s_waitcnt lgkmcnt(0)
    v_cmp_eq_u32 vcc, 0, v29
    s_cbranch_vccnz SL_53
SE_54:
    v_mfma_f32_32x32x16_bf16 v[160:175], v[48:51], v[96:99], 0
    s_nop 5
    v_add_f32 v136, 0x358637bd, v136
    v_rcp_f32 v136, v136
    s_nop 0
    v_mul_f32 v128, v128, v136
    v_mul_f32 v129, v129, v136
    v_mul_f32 v130, v130, v136
    v_mul_f32 v131, v131, v136
    v_mfma_f32_32x32x16_bf16 v[160:175], v[52:55], v[100:103], v[160:175]
    v_mul_f32 v132, v132, v136
    v_mul_f32 v133, v133, v136
    v_mul_f32 v134, v134, v136
    v_mul_f32 v135, v135, v136
    v_cvt_pk_bf16_f32 v64, v128, v129
    v_cvt_pk_bf16_f32 v65, v130, v131
    v_cvt_pk_bf16_f32 v66, v132, v133
    v_cvt_pk_bf16_f32 v67, v134, v135
    buffer_store_dwordx4 v[64:67], v6, s[24:27], s63 offen sc1
    v_mfma_f32_32x32x16_bf16 v[176:191], v[48:51], v[104:107], 0
    v_add_f32 v152, 0x358637bd, v152
    v_rcp_f32 v152, v152
    s_nop 0
    v_mul_f32 v144, v144, v152
    v_mul_f32 v145, v145, v152
    v_mul_f32 v146, v146, v152
    v_mul_f32 v147, v147, v152
    v_mfma_f32_32x32x16_bf16 v[176:191], v[52:55], v[108:111], v[176:191]
    v_mul_f32 v148, v148, v152
    v_mul_f32 v149, v149, v152
    v_mul_f32 v150, v150, v152
    v_mul_f32 v151, v151, v152
    v_cvt_pk_bf16_f32 v68, v144, v145
    v_cvt_pk_bf16_f32 v69, v146, v147
    v_cvt_pk_bf16_f32 v70, v148, v149
    v_cvt_pk_bf16_f32 v71, v150, v151
    buffer_store_dwordx4 v[68:71], v6, s[24:27], s64 offen sc1
    v_add_f32 v168, 0x358637bd, v168
    v_rcp_f32 v168, v168
    s_nop 0
PAD_B3_3:
    s_cbranch_execz RET0_B
    v_mul_f32 v160, v160, v168
    v_mul_f32 v161, v161, v168
    v_mul_f32 v162, v162, v168
    v_mul_f32 v163, v163, v168
    v_mul_f32 v164, v164, v168
    v_mul_f32 v165, v165, v168
    v_mul_f32 v166, v166, v168
    v_mul_f32 v167, v167, v168
    v_cvt_pk_bf16_f32 v72, v160, v161
    v_cvt_pk_bf16_f32 v73, v162, v163
    v_cvt_pk_bf16_f32 v74, v164, v165
    v_cvt_pk_bf16_f32 v75, v166, v167
    buffer_store_dwordx4 v[72:75], v6, s[24:27], s57 offen sc1
    v_add_f32 v184, 0x358637bd, v184
    v_rcp_f32 v184, v184
    s_nop 0
    v_mul_f32 v176, v176, v184
    v_mul_f32 v177, v177, v184
    v_mul_f32 v178, v178, v184
    v_mul_f32 v179, v179, v184
    v_mul_f32 v180, v180, v184
    v_mul_f32 v181, v181, v184
    v_mul_f32 v182, v182, v184
    v_mul_f32 v183, v183, v184
    v_cvt_pk_bf16_f32 v76, v176, v177
    v_cvt_pk_bf16_f32 v77, v178, v179
    v_cvt_pk_bf16_f32 v78, v180, v181
    v_cvt_pk_bf16_f32 v79, v182, v183
    buffer_store_dwordx4 v[76:79], v6, s[24:27], s62 offen sc1
L_PH2M:
PAD_S1_1:
    s_cbranch_execz RET1_S
    v_mov_b32 v11, 161792
    ds_read_b32 v10, v11 offset:4
    s_cmp_eq_u32 s52, 0
    s_cselect_b32 s48, 114688, 0
    v_add_u32 v8, s48, v7
    v_xor_b32 v9, 64, v8
    s_waitcnt lgkmcnt(0)
    v_cmp_gt_u32 vcc, 4, v10
    s_cbranch_vccnz SL_55
SE_56:
    ds_read_b64_tr_b16 v[128:129], v8 offset:0
    ds_read_b64_tr_b16 v[130:131], v8 offset:512
    ds_read_b64_tr_b16 v[132:133], v9 offset:0
    ds_read_b64_tr_b16 v[134:135], v9 offset:512
    ds_read_b64_tr_b16 v[136:137], v8 offset:2048
SEG_S1_2:
    s_cbranch_execz PAD_S2_1
    ds_read_b64_tr_b16 v[138:139], v8 offset:2560
    ds_read_b64_tr_b16 v[140:141], v9 offset:2048
    ds_read_b64_tr_b16 v[142:143], v9 offset:2560
    ds_read_b64_tr_b16 v[144:145], v8 offset:4096
    ds_read_b64_tr_b16 v[146:147], v8 offset:4608
    ds_read_b64_tr_b16 v[148:149], v9 offset:4096
    ds_read_b64_tr_b16 v[150:151], v9 offset:4608
    s_waitcnt lgkmcnt(8)
    ds_read_b64_tr_b16 v[152:153], v8 offset:6144
    ds_read_b64_tr_b16 v[154:155], v8 offset:6656
    ds_read_b64_tr_b16 v[156:157], v9 offset:6144
    ds_read_b64_tr_b16 v[158:159], v9 offset:6656
    s_waitcnt lgkmcnt(8)
    ds_read_b64_tr_b16 v[160:161], v8 offset:8192
    ds_read_b64_tr_b16 v[162:163], v8 offset:8704
    ds_read_b64_tr_b16 v[164:165], v9 offset:8192
    ds_read_b64_tr_b16 v[166:167], v9 offset:8704
    s_waitcnt lgkmcnt(8)
    ds_read_b64_tr_b16 v[168:169], v8 offset:10240
    ds_read_b64_tr_b16 v[170:171], v8 offset:10752
    ds_read_b64_tr_b16 v[172:173], v9 offset:10240
    ds_read_b64_tr_b16 v[174:175], v9 offset:10752
    s_waitcnt lgkmcnt(8)
    ds_read_b64_tr_b16 v[176:177], v8 offset:12288
    ds_read_b64_tr_b16 v[178:179], v8 offset:12800
    ds_read_b64_tr_b16 v[180:181], v9 offset:12288
    ds_read_b64_tr_b16 v[182:183], v9 offset:12800
    s_waitcnt lgkmcnt(8)
    ds_read_b64_tr_b16 v[184:185], v8 offset:14336
    ds_read_b64_tr_b16 v[186:187], v8 offset:14848
    ds_read_b64_tr_b16 v[188:189], v9 offset:14336
    ds_read_b64_tr_b16 v[190:191], v9 offset:14848
    s_waitcnt lgkmcnt(8)
    ds_read_b64_tr_b16 v[192:193], v8 offset:16384
    ds_read_b64_tr_b16 v[194:195], v8 offset:16896
PAD_S2_1:
    s_cbranch_execz RET1_S
    ds_read_b64_tr_b16 v[196:197], v9 offset:16384
    ds_read_b64_tr_b16 v[198:199], v9 offset:16896
    s_waitcnt lgkmcnt(8)
    ds_read_b64_tr_b16 v[200:201], v8 offset:18432
    ds_read_b64_tr_b16 v[202:203], v8 offset:18944
    ds_read_b64_tr_b16 v[204:205], v9 offset:18432
    ds_read_b64_tr_b16 v[206:207], v9 offset:18944
    s_waitcnt lgkmcnt(8)
    ds_read_b64_tr_b16 v[208:209], v8 offset:20480
    ds_read_b64_tr_b16 v[210:211], v8 offset:20992
    ds_read_b64_tr_b16 v[212:213], v9 offset:20480
    ds_read_b64_tr_b16 v[214:215], v9 offset:20992
    s_waitcnt lgkmcnt(8)
    ds_read_b64_tr_b16 v[216:217], v8 offset:22528
    ds_read_b64_tr_b16 v[218:219], v8 offset:23040
    ds_read_b64_tr_b16 v[220:221], v9 offset:22528
    ds_read_b64_tr_b16 v[222:223], v9 offset:23040
    v_mov_b32 v37, s60
    v_lshlrev_b32 v38, 7, v1
    s_waitcnt vmcnt(0)
    s_mov_b64 exec, 0x3
    buffer_store_dword v37, v38, s[24:27], s70 offen offset:0 sc1
    s_mov_b64 exec, -1
    s_waitcnt lgkmcnt(0)
    ds_read_b64_tr_b16 v[224:225], v8 offset:24576
    ds_read_b64_tr_b16 v[226:227], v8 offset:25088
    ds_read_b64_tr_b16 v[228:229], v9 offset:24576
    ds_read_b64_tr_b16 v[230:231], v9 offset:25088
    ds_read_b64_tr_b16 v[232:233], v8 offset:26624
    ds_read_b64_tr_b16 v[234:235], v8 offset:27136
    ds_read_b64_tr_b16 v[236:237], v9 offset:26624
    ds_read_b64_tr_b16 v[238:239], v9 offset:27136
    ds_read_b64_tr_b16 v[240:241], v8 offset:28672
    ds_read_b64_tr_b16 v[242:243], v8 offset:29184
    ds_read_b64_tr_b16 v[244:245], v9 offset:28672
    ds_read_b64_tr_b16 v[246:247], v9 offset:29184
SEG_S1_3:
    s_cbranch_execz PAD_S3_1
    s_waitcnt lgkmcnt(8)
    ds_read_b64_tr_b16 v[248:249], v8 offset:30720
    ds_read_b64_tr_b16 v[250:251], v8 offset:31232
    ds_read_b64_tr_b16 v[252:253], v9 offset:30720
    ds_read_b64_tr_b16 v[254:255], v9 offset:31232
    v_mov_b32 v13, 1
    s_mov_b64 exec, 1
    ds_add_u32 v11, v13 offset:12
    s_mov_b64 exec, -1
    s_setprio 0
    ds_read_b32 v13, v11 offset:12
    s_waitcnt lgkmcnt(0)
    v_cmp_gt_u32 vcc, 8, v13
    s_cbranch_vccnz SL_57
SE_58:
WMN_59:
    s_mov_b32 s20, s60
    s_mov_b32 s21, s60
    s_buffer_load_dwordx8 s[12:19], s[24:27], s71 offset:0 glc
    s_lshl_b32 s48, s100, 13
    v_add_u32 v14, s48, v6
    s_waitcnt lgkmcnt(0)
    s_xor_b64 vcc, s[12:13], s[20:21]
    s_xor_b64 s[22:23], s[14:15], s[20:21]
    s_or_b64 vcc, vcc, s[22:23]
    s_xor_b64 s[22:23], s[16:17], s[20:21]
    s_or_b64 vcc, vcc, s[22:23]
    s_xor_b64 s[22:23], s[18:19], s[20:21]
    s_or_b64 vcc, vcc, s[22:23]
    s_cbranch_vccnz SL_60
SE_61:
    s_setprio 1
    buffer_load_dwordx4 v[64:67], v6, s[24:27], s4 offen offset:0 sc1
    buffer_load_dwordx4 v[68:71], v6, s[24:27], s4 offen offset:1024 sc1
    buffer_load_dwordx4 v[72:75], v6, s[24:27], s4 offen offset:2048 sc1
    buffer_load_dwordx4 v[76:79], v6, s[24:27], s4 offen offset:3072 sc1
    s_add_u32 s4, s4, 4096
    buffer_load_dwordx4 v[80:83], v6, s[24:27], s4 offen offset:0 sc1
    buffer_load_dwordx4 v[84:87], v6, s[24:27], s4 offen offset:1024 sc1
    s_waitcnt vmcnt(5)
    v_mfma_f32_32x32x16_bf16 v[16:31], v[128:131], v[64:67], 0
    v_mfma_f32_32x32x16_bf16 v[32:47], v[132:135], v[64:67], 0
    s_waitcnt vmcnt(4)
    v_mfma_f32_32x32x16_bf16 v[16:31], v[136:139], v[68:71], v[16:31]
    v_mfma_f32_32x32x16_bf16 v[32:47], v[140:143], v[68:71], v[32:47]
    s_waitcnt vmcnt(3)
    v_mfma_f32_32x32x16_bf16 v[16:31], v[144:147], v[72:75], v[16:31]
    v_mfma_f32_32x32x16_bf16 v[32:47], v[148:151], v[72:75], v[32:47]
    s_waitcnt vmcnt(2)
    v_mfma_f32_32x32x16_bf16 v[16:31], v[152:155], v[76:79], v[16:31]
    v_mfma_f32_32x32x16_bf16 v[32:47], v[156:159], v[76:79], v[32:47]
    s_waitcnt vmcnt(1)
    v_mfma_f32_32x32x16_bf16 v[16:31], v[160:163], v[80:83], v[16:31]
    v_mfma_f32_32x32x16_bf16 v[32:47], v[164:167], v[80:83], v[32:47]
    s_waitcnt vmcnt(0)
    v_mfma_f32_32x32x16_bf16 v[16:31], v[168:171], v[84:87], v[16:31]
    v_mfma_f32_32x32x16_bf16 v[32:47], v[172:175], v[84:87], v[32:47]
    ds_read_b32 v13, v11 offset:8
    s_waitcnt lgkmcnt(0)
    v_cmp_gt_u32 vcc, 2, v13
    s_cbranch_vccnz SL_62
SE_63:
    buffer_load_dwordx4 v[88:91], v6, s[24:27], s4 offen offset:2048 sc1
    buffer_load_dwordx4 v[92:95], v6, s[24:27], s4 offen offset:3072 sc1
    s_add_u32 s4, s4, 4096
    buffer_load_dwordx4 v[96:99], v6, s[24:27], s4 offen offset:0 sc1
    buffer_load_dwordx4 v[100:103], v6, s[24:27], s4 offen offset:1024 sc1
    buffer_load_dwordx4 v[104:107], v6, s[24:27], s4 offen offset:2048 sc1
    buffer_load_dwordx4 v[108:111], v6, s[24:27], s4 offen offset:3072 sc1
    s_add_u32 s4, s4, 4096
    buffer_load_dwordx4 v[112:115], v6, s[24:27], s4 offen offset:0 sc1
    buffer_load_dwordx4 v[116:119], v6, s[24:27], s4 offen offset:1024 sc1
    buffer_load_dwordx4 v[120:123], v6, s[24:27], s4 offen offset:2048 sc1
    buffer_load_dwordx4 v[124:127], v6, s[24:27], s4 offen offset:3072 sc1
    s_waitcnt vmcnt(9)
    v_mfma_f32_32x32x16_bf16 v[16:31], v[176:179], v[88:91], v[16:31]
    v_mfma_f32_32x32x16_bf16 v[32:47], v[180:183], v[88:91], v[32:47]
    s_waitcnt vmcnt(8)
    v_mfma_f32_32x32x16_bf16 v[16:31], v[184:187], v[92:95], v[16:31]
    v_mfma_f32_32x32x16_bf16 v[32:47], v[188:191], v[92:95], v[32:47]
    s_waitcnt vmcnt(7)
    v_mfma_f32_32x32x16_bf16 v[16:31], v[192:195], v[96:99], v[16:31]
    v_mfma_f32_32x32x16_bf16 v[32:47], v[196:199], v[96:99], v[32:47]
    s_waitcnt vmcnt(6)
    v_mfma_f32_32x32x16_bf16 v[16:31], v[200:203], v[100:103], v[16:31]
    v_mfma_f32_32x32x16_bf16 v[32:47], v[204:207], v[100:103], v[32:47]
    s_waitcnt vmcnt(5)
    v_mfma_f32_32x32x16_bf16 v[16:31], v[208:211], v[104:107], v[16:31]
    v_mfma_f32_32x32x16_bf16 v[32:47], v[212:215], v[104:107], v[32:47]
    s_waitcnt vmcnt(4)
    v_mfma_f32_32x32x16_bf16 v[16:31], v[216:219], v[108:111], v[16:31]
    v_mfma_f32_32x32x16_bf16 v[32:47], v[220:223], v[108:111], v[32:47]
    s_waitcnt vmcnt(3)
    v_mfma_f32_32x32x16_bf16 v[16:31], v[224:227], v[112:115], v[16:31]
    s_waitcnt vmcnt(2)
    v_mfma_f32_32x32x16_bf16 v[16:31], v[232:235], v[116:119], v[16:31]
    s_waitcnt vmcnt(1)
    v_mfma_f32_32x32x16_bf16 v[16:31], v[240:243], v[120:123], v[16:31]
    s_waitcnt vmcnt(0)
    v_mfma_f32_32x32x16_bf16 v[16:31], v[248:251], v[124:127], v[16:31]
    s_setprio 3
    v_mfma_f32_32x32x16_bf16 v[32:47], v[228:231], v[112:115], v[32:47]
    v_mfma_f32_32x32x16_bf16 v[32:47], v[236:239], v[116:119], v[32:47]
    s_nop 8
    ds_write_b128 v14, v[16:19] offset:0
    ds_write_b128 v14, v[20:23] offset:1024
    v_mfma_f32_32x32x16_bf16 v[32:47], v[244:247], v[120:123], v[32:47]
    ds_write_b128 v14, v[24:27] offset:2048
    ds_write_b128 v14, v[28:31] offset:3072
    v_mfma_f32_32x32x16_bf16 v[32:47], v[252:255], v[124:127], v[32:47]
    s_setprio 3
    s_nop 10
    ds_write_b128 v14, v[32:35] offset:4096
    ds_write_b128 v14, v[36:39] offset:5120
    ds_write_b128 v14, v[40:43] offset:6144
    ds_write_b128 v14, v[44:47] offset:7168
    s_waitcnt lgkmcnt(0)
    s_barrier
L_FIN:
WMN_64:
L_END:
    s_endpgm
WMS_65:
SL_22:
PAD_S3_1:
    s_cbranch_execz PAD_S3_2
    s_mov_b32 s65, 0
SLL_66:
    s_buffer_load_dwordx8 s[12:19], s[24:27], s71 offset:0 glc
    s_add_u32 s65, s65, 1
    s_waitcnt lgkmcnt(0)
    s_xor_b64 vcc, s[12:13], s[20:21]
    s_xor_b64 s[22:23], s[14:15], s[20:21]
PAD_S3_2:
    s_cbranch_execz RET1_S
    s_or_b64 vcc, vcc, s[22:23]
    s_xor_b64 s[22:23], s[16:17], s[20:21]
    s_or_b64 vcc, vcc, s[22:23]
    s_xor_b64 s[22:23], s[18:19], s[20:21]
    s_or_b64 vcc, vcc, s[22:23]
    s_cmp_gt_u32 s65, SPIN_MAX
    s_cbranch_scc1 SLP_67
    s_cbranch_vccnz SLL_66
SLP_67:
    s_branch SE_23
SL_24:
    s_mov_b32 s65, 0
SLL_68:
    s_buffer_load_dwordx8 s[12:19], s[24:27], s71 offset:32 glc
    s_add_u32 s65, s65, 1
    s_waitcnt lgkmcnt(0)
    s_xor_b64 vcc, s[12:13], s[20:21]
    s_xor_b64 s[22:23], s[14:15], s[20:21]
    s_or_b64 vcc, vcc, s[22:23]
    s_xor_b64 s[22:23], s[16:17], s[20:21]
    s_or_b64 vcc, vcc, s[22:23]
    s_xor_b64 s[22:23], s[18:19], s[20:21]
    s_or_b64 vcc, vcc, s[22:23]
    s_cmp_gt_u32 s65, SPIN_MAX
    s_cbranch_scc1 SLP_69
    s_cbranch_vccnz SLL_68
SLP_69:
    s_branch SE_25
SL_53:
    s_mov_b32 s65, 0
SLL_70:
    ds_read_b32 v29, v15
    ds_read_b128 v[48:51], v13
    ds_read_b128 v[52:55], v13 offset:16
    s_add_u32 s65, s65, 1
    s_waitcnt lgkmcnt(0)
    v_cmp_eq_u32 vcc, 0, v29
    s_cmp_gt_u32 s65, SPIN_MAX
    s_cbranch_scc1 SLP_71
    s_cbranch_vccnz SLL_70
SLP_71:
    s_branch SE_54
SL_57:
    s_mov_b32 s65, 0
SLL_72:
    ds_read_b32 v13, v11 offset:12
    s_add_u32 s65, s65, 1
    s_waitcnt lgkmcnt(0)
    v_cmp_gt_u32 vcc, 8, v13
    s_cmp_gt_u32 s65, SPIN_MAX
    s_cbranch_scc1 SLP_73
    s_cbranch_vccnz SLL_72
SLP_73:
    s_branch SE_58
WMN_74:
SL_2:
    s_mov_b32 s65, 0
SLL_75:
    v_mov_b32 v38, 0
    global_load_dword v38, v38, s[34:35] sc1
    s_waitcnt vmcnt(0)
    v_readfirstlane_b32 s60, v38
    s_add_u32 s65, s65, 1
    s_waitcnt vmcnt(0) lgkmcnt(0)
    s_cmp_eq_u32 s60, 0
    s_cselect_b64 vcc, -1, 0
    s_cmp_gt_u32 s65, SPIN_MAX
    s_cbranch_scc1 SLP_76
    s_cbranch_vccnz SLL_75
SLP_76:
    s_branch SE_3
SL_7:
    s_mov_b32 s65, 0
SLL_77:
    buffer_load_dwordx2 v[84:85], v14, s[24:27], s42 offen offset:0 sc1
    buffer_load_dwordx2 v[86:87], v14, s[24:27], s42 offen offset:512 sc1
    buffer_load_dwordx2 v[88:89], v14, s[24:27], s42 offen offset:1024 sc1
    buffer_load_dwordx2 v[90:91], v14, s[24:27], s42 offen offset:1536 sc1
    s_add_u32 s65, s65, 1
    s_waitcnt vmcnt(0) lgkmcnt(0)
    v_xor_b32 v39, s60, v85
    v_xor_b32 v38, s60, v87
    v_or_b32 v39, v39, v38
    v_xor_b32 v38, s60, v89
    v_or_b32 v39, v39, v38
    v_xor_b32 v38, s60, v91
    v_or_b32 v39, v39, v38
    v_cmp_ne_u32 vcc, 0, v39
    s_cmp_gt_u32 s65, SPIN_MAX
    s_cbranch_scc1 SLP_78
    s_cbranch_vccnz SLL_77
SLP_78:
    s_branch SE_8
SL_11:
    s_mov_b32 s65, 0
SLL_79:
    v_mov_b32 v38, 0
    global_load_dword v38, v38, s[34:35] sc1
    s_waitcnt vmcnt(0)
    v_readfirstlane_b32 s60, v38
    s_add_u32 s65, s65, 1
    s_waitcnt vmcnt(0) lgkmcnt(0)
    s_cmp_eq_u32 s60, 0
    s_cselect_b64 vcc, -1, 0
    s_cmp_gt_u32 s65, SPIN_MAX
    s_cbranch_scc1 SLP_80
    s_cbranch_vccnz SLL_79
SLP_80:
    s_branch SE_12
SL_15:
    s_mov_b32 s65, 0
SLL_81:
    buffer_load_dwordx2 v[84:85], v14, s[24:27], s42 offen offset:0 sc1
    buffer_load_dwordx2 v[86:87], v14, s[24:27], s42 offen offset:512 sc1
    buffer_load_dwordx2 v[88:89], v14, s[24:27], s42 offen offset:1024 sc1
    buffer_load_dwordx2 v[90:91], v14, s[24:27], s42 offen offset:1536 sc1
    s_add_u32 s65, s65, 1
    s_waitcnt vmcnt(0) lgkmcnt(0)
    v_xor_b32 v39, s60, v85
    v_xor_b32 v38, s60, v87
    v_or_b32 v39, v39, v38
    v_xor_b32 v38, s60, v89
    v_or_b32 v39, v39, v38
    v_xor_b32 v38, s60, v91
    v_or_b32 v39, v39, v38
    v_cmp_ne_u32 vcc, 0, v39
    s_cmp_gt_u32 s65, SPIN_MAX
    s_cbranch_scc1 SLP_82
    s_cbranch_vccnz SLL_81
SLP_82:
    s_branch SE_16
SL_27:
    s_mov_b32 s65, 0
SLL_83:
    s_buffer_load_dwordx8 s[12:19], s[24:27], s71 offset:64 glc
    s_add_u32 s65, s65, 1
    s_waitcnt lgkmcnt(0)
    s_xor_b64 vcc, s[12:13], s[20:21]
    s_xor_b64 s[22:23], s[14:15], s[20:21]
    s_or_b64 vcc, vcc, s[22:23]
    s_xor_b64 s[22:23], s[16:17], s[20:21]
    s_or_b64 vcc, vcc, s[22:23]
    s_xor_b64 s[22:23], s[18:19], s[20:21]
    s_or_b64 vcc, vcc, s[22:23]
    s_cmp_gt_u32 s65, SPIN_MAX
    s_cbranch_scc1 SLP_84
    s_cbranch_vccnz SLL_83
SLP_84:
    s_branch SE_28
SL_29:
    s_mov_b32 s65, 0
SLL_85:
    ds_read_b32 v13, v11 offset:4
    s_add_u32 s65, s65, 1
    s_waitcnt lgkmcnt(0)
    v_cmp_gt_u32 vcc, 4, v13
    s_cmp_gt_u32 s65, SPIN_MAX
    s_cbranch_scc1 SLP_86
    s_cbranch_vccnz SLL_85
SLP_86:
    s_branch SE_30
SL_31:
    s_mov_b32 s65, 0
SLL_87:
    s_buffer_load_dwordx8 s[12:19], s[24:27], s71 offset:96 glc
    s_add_u32 s65, s65, 1
    s_waitcnt lgkmcnt(0)
    s_xor_b64 vcc, s[12:13], s[20:21]
    s_xor_b64 s[22:23], s[14:15], s[20:21]
    s_or_b64 vcc, vcc, s[22:23]
    s_xor_b64 s[22:23], s[16:17], s[20:21]
    s_or_b64 vcc, vcc, s[22:23]
    s_xor_b64 s[22:23], s[18:19], s[20:21]
    s_or_b64 vcc, vcc, s[22:23]
    s_cmp_gt_u32 s65, SPIN_MAX
    s_cbranch_scc1 SLP_88
    s_cbranch_vccnz SLL_87
SLP_88:
    s_branch SE_32
SL_33:
    s_mov_b32 s65, 0
SLL_89:
    ds_read_b32 v13, v14 offset:32
    ds_read_b128 v[16:19], v12 offset:0
    ds_read_b128 v[20:23], v12 offset:1024
    ds_read_b128 v[24:27], v12 offset:2048
    ds_read_b128 v[28:31], v12 offset:3072
    s_add_u32 s65, s65, 1
    s_waitcnt lgkmcnt(0)
    v_cmp_eq_u32 vcc, 0, v13
    s_cmp_gt_u32 s65, SPIN_MAX
    s_cbranch_scc1 SLP_90
    s_cbranch_vccnz SLL_89
SLP_90:
    s_branch SE_34
SL_35:
    s_mov_b32 s65, 0
SLL_91:
    ds_read_b32 v13, v11 offset:12
    s_add_u32 s65, s65, 1
    s_waitcnt lgkmcnt(0)
    v_cmp_gt_u32 vcc, 8, v13
    s_cmp_gt_u32 s65, SPIN_MAX
    s_cbranch_scc1 SLP_92
    s_cbranch_vccnz SLL_91
SLP_92:
    s_branch SE_36
SL_37:
    s_mov_b32 s65, 0
SLL_93:
    s_buffer_load_dword s12, s[24:27], s4 offset:3064 glc
    s_add_u32 s65, s65, 1
    s_waitcnt lgkmcnt(0)
    s_cmp_lg_u32 s12, s60
    s_cselect_b64 vcc, -1, 0
    s_cmp_gt_u32 s65, SPIN_MAX
    s_cbranch_scc1 SLP_94
    s_cbranch_vccnz SLL_93
SLP_94:
    s_branch SE_38
SL_39:
    s_mov_b32 s65, 0
SLL_95:
    buffer_load_dwordx4 v[216:219], v6, s[24:27], s4 offen offset:0 sc1
    buffer_load_dwordx4 v[220:223], v6, s[24:27], s4 offen offset:1024 sc1
    buffer_load_dwordx4 v[224:227], v6, s[24:27], s4 offen offset:2048 sc1
    s_add_u32 s65, s65, 1
    s_waitcnt vmcnt(0) lgkmcnt(0)
    v_xor_b32 v13, s60, v219
    v_xor_b32 v14, s60, v223
    v_xor_b32 v15, s60, v227
    v_or3_b32 v13, v13, v14, v15
    v_cmp_ne_u32 vcc, 0, v13
    s_cmp_gt_u32 s65, SPIN_MAX
    s_cbranch_scc1 SLP_96
    s_cbranch_vccnz SLL_95
SLP_96:
    s_branch SE_40
SL_41:
    s_mov_b32 s65, 0
SLL_97:
    v_mov_b32 v38, 0
    global_load_dword v38, v38, s[34:35] sc1
    s_waitcnt vmcnt(0)
    v_readfirstlane_b32 s60, v38
    s_add_u32 s65, s65, 1
    s_waitcnt vmcnt(0) lgkmcnt(0)
    s_cmp_eq_u32 s60, 0
    s_cselect_b64 vcc, -1, 0
    s_cmp_gt_u32 s65, SPIN_MAX
    s_cbranch_scc1 SLP_98
    s_cbranch_vccnz SLL_97
SLP_98:
    s_branch SE_42
SL_43:
    s_mov_b32 s65, 0
SLL_99:
    buffer_load_dwordx4 v[34:37], v2, s[24:27], s67 offen offset:0 sc1
    buffer_load_dwordx4 v[8:11], v2, s[24:27], s67 offen offset:256 sc1
    buffer_load_dwordx4 v[28:31], v2, s[24:27], s5 offen offset:0 sc1
    buffer_load_dwordx4 v[16:19], v2, s[24:27], s5 offen offset:256 sc1
    s_add_u32 s65, s65, 1
    s_waitcnt vmcnt(0) lgkmcnt(0)
    v_xor_b32 v32, s60, v37
    v_xor_b32 v33, s60, v11
    v_xor_b32 v25, s60, v31
    v_xor_b32 v5, s60, v19
    v_or3_b32 v32, v32, v33, v25
    v_or_b32 v32, v32, v5
    v_cmp_ne_u32 vcc, 0, v32
    s_cmp_gt_u32 s65, SPIN_MAX
    s_cbranch_scc1 SLP_100
    s_cbranch_vccnz SLL_99
SLP_100:
    ds_write_b128 v26, v[34:37] offset:0
    ds_write_b128 v26, v[8:11] offset:256
    ds_write_b128 v27, v[28:31] offset:0
    ds_write_b128 v27, v[16:19] offset:256
    s_waitcnt lgkmcnt(0)
    s_branch SE_44
SL_46:
    s_mov_b32 s65, 0
SLL_101:
    v_mov_b32 v38, 0
    global_load_dword v38, v38, s[34:35] sc1
    s_waitcnt vmcnt(0)
    v_readfirstlane_b32 s60, v38
    s_add_u32 s65, s65, 1
    s_waitcnt vmcnt(0) lgkmcnt(0)
    s_cmp_eq_u32 s60, 0
    s_cselect_b64 vcc, -1, 0
    s_cmp_gt_u32 s65, SPIN_MAX
    s_cbranch_scc1 SLP_102
    s_cbranch_vccnz SLL_101
SLP_102:
    s_branch SE_47
SL_48:
    s_mov_b32 s65, 0
SLL_103:
    buffer_load_dwordx4 v[34:37], v38, s[24:27], s67 offen sc1
    buffer_load_dwordx4 v[28:31], v38, s[24:27], s5 offen sc1
    s_add_u32 s65, s65, 1
    s_waitcnt vmcnt(0) lgkmcnt(0)
    v_cmp_ne_u32 vcc, s60, v37
    v_cmp_ne_u32 s[68:69], s60, v31
    s_or_b64 vcc, vcc, s[68:69]
    s_cmp_gt_u32 s65, SPIN_MAX
    s_cbranch_scc1 SLP_104
    s_cbranch_vccnz SLL_103
SLP_104:
    ds_write_b128 v26, v[34:37]
    ds_write_b128 v27, v[28:31]
    s_waitcnt lgkmcnt(0)
    s_branch SE_49
SL_51:
    s_mov_b32 s65, 0
SLL_105:
    ds_read_b64 v[22:23], v2
    ds_read_b128 v[160:163], v5 offset:0
    ds_read_b128 v[164:167], v5 offset:1024
    ds_read_b128 v[168:171], v5 offset:256
    ds_read_b128 v[172:175], v5 offset:1280
    s_add_u32 s65, s65, 1
    s_waitcnt lgkmcnt(0)
    v_cmp_eq_u32 vcc, 0, v23
    s_cmp_gt_u32 s65, SPIN_MAX
    s_cbranch_scc1 SLP_106
    s_cbranch_vccnz SLL_105
SLP_106:
    s_branch SE_52
SL_55:
    s_mov_b32 s65, 0
SLL_107:
    ds_read_b32 v10, v11 offset:4
    s_add_u32 s65, s65, 1
    s_waitcnt lgkmcnt(0)
    v_cmp_gt_u32 vcc, 4, v10
    s_cmp_gt_u32 s65, SPIN_MAX
    s_cbranch_scc1 SLP_108
    s_cbranch_vccnz SLL_107
SLP_108:
    s_branch SE_56
SL_60:
    s_mov_b32 s65, 0
SLL_109:
    s_buffer_load_dwordx8 s[12:19], s[24:27], s71 offset:0 glc
    s_add_u32 s65, s65, 1
    s_waitcnt lgkmcnt(0)
    s_xor_b64 vcc, s[12:13], s[20:21]
    s_xor_b64 s[22:23], s[14:15], s[20:21]
    s_or_b64 vcc, vcc, s[22:23]
    s_xor_b64 s[22:23], s[16:17], s[20:21]
    s_or_b64 vcc, vcc, s[22:23]
    s_xor_b64 s[22:23], s[18:19], s[20:21]
    s_or_b64 vcc, vcc, s[22:23]
    s_cmp_gt_u32 s65, SPIN_MAX
    s_cbranch_scc1 SLP_110
    s_cbranch_vccnz SLL_109
SLP_110:
    s_branch SE_61
SL_62:
    s_mov_b32 s65, 0
SLL_111:
    ds_read_b32 v13, v11 offset:8
    s_add_u32 s65, s65, 1
    s_waitcnt lgkmcnt(0)
    v_cmp_gt_u32 vcc, 2, v13
    s_cmp_gt_u32 s65, SPIN_MAX
    s_cbranch_scc1 SLP_112
    s_cbranch_vccnz SLL_111
SLP_112:
    s_branch SE_63
L_STUBS:
L_GRETRY:
    s_add_u32 s3, s3, 1
    s_cmp_gt_u32 s3, 1000
    s_cbranch_scc1 L_GOK
    s_add_u32 s51, s58, 0
    buffer_load_dwordx4 v[144:147], v6, s[24:27], s51 offen sc1
    buffer_load_dword v56, v8, s[24:27], s51 offen sc1
    s_add_u32 s51, s58, 4608
    buffer_load_dwordx4 v[148:151], v6, s[24:27], s51 offen sc1
    buffer_load_dword v57, v8, s[24:27], s51 offen sc1
    s_add_u32 s51, s58, 9216
    buffer_load_dwordx4 v[152:155], v6, s[24:27], s51 offen sc1
    buffer_load_dword v58, v8, s[24:27], s51 offen sc1
    s_add_u32 s51, s58, 13824
    buffer_load_dwordx4 v[156:159], v6, s[24:27], s51 offen sc1
    buffer_load_dword v59, v8, s[24:27], s51 offen sc1
    s_add_u32 s51, s58, 18432
    buffer_load_dwordx4 v[160:163], v6, s[24:27], s51 offen sc1
    buffer_load_dword v60, v8, s[24:27], s51 offen sc1
    s_add_u32 s51, s58, 23040
    buffer_load_dwordx4 v[164:167], v6, s[24:27], s51 offen sc1
    buffer_load_dword v61, v8, s[24:27], s51 offen sc1
    s_add_u32 s51, s58, 27648
    buffer_load_dwordx4 v[168:171], v6, s[24:27], s51 offen sc1
    buffer_load_dword v62, v8, s[24:27], s51 offen sc1
    s_add_u32 s51, s58, 32256
    buffer_load_dwordx4 v[172:175], v6, s[24:27], s51 offen sc1
    buffer_load_dword v63, v8, s[24:27], s51 offen sc1
    s_add_u32 s51, s58, 36864
    buffer_load_dwordx4 v[176:179], v6, s[24:27], s51 offen sc1
    buffer_load_dword v64, v8, s[24:27], s51 offen sc1
    s_add_u32 s51, s58, 41472
    buffer_load_dwordx4 v[180:183], v6, s[24:27], s51 offen sc1
    buffer_load_dword v65, v8, s[24:27], s51 offen sc1
    s_add_u32 s51, s58, 46080
    buffer_load_dwordx4 v[184:187], v6, s[24:27], s51 offen sc1
    buffer_load_dword v66, v8, s[24:27], s51 offen sc1
    s_add_u32 s51, s58, 50688
    buffer_load_dwordx4 v[188:191], v6, s[24:27], s51 offen sc1
    buffer_load_dword v67, v8, s[24:27], s51 offen sc1
    s_add_u32 s51, s58, 55296
    buffer_load_dwordx4 v[192:195], v6, s[24:27], s51 offen sc1
    buffer_load_dword v68, v8, s[24:27], s51 offen sc1
    s_add_u32 s51, s58, 59904
    buffer_load_dwordx4 v[196:199], v6, s[24:27], s51 offen sc1
    buffer_load_dword v69, v8, s[24:27], s51 offen sc1
    s_add_u32 s51, s58, 64512
    buffer_load_dwordx4 v[200:203], v6, s[24:27], s51 offen sc1
    buffer_load_dword v70, v8, s[24:27], s51 offen sc1
    s_add_u32 s51, s58, 69120
    buffer_load_dwordx4 v[204:207], v6, s[24:27], s51 offen sc1
    buffer_load_dword v71, v8, s[24:27], s51 offen sc1
    s_waitcnt vmcnt(0)
    s_branch L_GPROC
.rept 512
s_nop 0
.endr
L_CODE_END:
s_endpgm
.section .rodata,"a"
.p2align 6
.amdhsa_kernel recurrent_scan__linear_kernel_hedgehog__dense_activation_silu__prompt_kernel
  .amdhsa_next_free_vgpr 256
  .amdhsa_next_free_sgpr 102
  .amdhsa_accum_offset 256
  .amdhsa_group_segment_fixed_size 0
  .amdhsa_kernarg_size 80
  .amdhsa_user_sgpr_count 2
  .amdhsa_user_sgpr_kernarg_segment_ptr 1
  .amdhsa_system_sgpr_workgroup_id_x 1
.end_amdhsa_kernel
```
